```python
import torch

def _softmax(x, axis=-1):
    return torch.softmax(x, dim=axis)
def _gelu(x):
    return torch.nn.functional.gelu(x, approximate="tanh")
def _silu(x):
    return torch.nn.functional.silu(x)
def _sigmoid(x):
    return torch.sigmoid(x)
def _layernorm(x, axis=-1, eps=1e-5):
    m = x.mean(dim=axis, keepdim=True)
    v = x.var(dim=axis, keepdim=True, unbiased=False)
    return (x - m) / torch.sqrt(v + eps)
def _scatter_add(tgt, idx, src, axis=0):
    return tgt.clone().index_add_(axis, idx, src)
def _segment_sum(src, seg, n):
    out = torch.zeros((n,) + src.shape[1:], dtype=src.dtype)
    return out.index_add_(0, seg, src)
def _pad(x, pw):
    flat = tuple(v for pair in reversed(pw) for v in pair)
    return torch.nn.functional.pad(x, flat)

kernel_name = 'interleave_layers__mha_block__glu_gated_swiglu__prompt'

def setup_inputs():

    _w = (lambda a: (lambda t: t.to(torch.bfloat16) if t.is_floating_point() else t)(torch.as_tensor(a)))
    def _A_setup():
        B, S, D, H = 1, 2048, 576, 32
        return {
            "x": _w((lambda *s: torch.randn(*s, dtype=torch.bfloat16) * 0.05)(B, S, D)),
            "wqkv": _w((lambda *s: torch.randn(*s, dtype=torch.bfloat16) * 0.05)(D, 3 * D)),
            "wo": _w((lambda *s: torch.randn(*s, dtype=torch.bfloat16) * 0.05)(D, D)),
        }
    _A_in = _A_setup()

    def _B_setup():
        B, S, D, F = 1, 2048, 576, 4608
        return {
            "x": _w((lambda *s: torch.randn(*s, dtype=torch.bfloat16) * 0.05)(B, S, D)),
            "w1": _w((lambda *s: torch.randn(*s, dtype=torch.bfloat16) * 0.4)(D, F) * (2.0 / D) ** 0.5),
            "w3": _w((lambda *s: torch.randn(*s, dtype=torch.bfloat16) * 0.4)(D, F) * (2.0 / D) ** 0.5),
            "w2": _w((lambda *s: torch.randn(*s, dtype=torch.bfloat16) * 0.4)(F, D) * (2.0 / F) ** 0.5),
        }
    _B_in = _B_setup()

    return {
        "A_x": _A_in["x"],
        "A_wqkv": _A_in["wqkv"],
        "A_wo": _A_in["wo"],
        "B_x": _B_in["x"],
        "B_w1": _B_in["w1"],
        "B_w3": _B_in["w3"],
        "B_w2": _B_in["w2"],
    }

def reference(A_x, A_wqkv, A_wo, B_x, B_w1, B_w3, B_w2):
    def _A_ref(x, wqkv, wo):
        B, S, D = x.shape
        H = 32
        Dh = D // H
        qkv = (lambda x, *d: x.permute(*d))((x @ wqkv).reshape(B, S, 3, H, Dh), 2, 0, 3, 1, 4)
        q, k, v = qkv[0], qkv[1], qkv[2]
        scores = torch.einsum("bhqd,bhkd->bhqk", q, k) * (Dh ** -0.5)
        p = _softmax(scores, axis=-1)
        o = torch.einsum("bhqk,bhkd->bhqd", p, v)
        return (lambda x, *d: x.permute(*d))(o, 0, 2, 1, 3).reshape(B, S, D) @ wo

    def _B_ref(x, w1, w3, w2):
        gate = torch.einsum("bsd,df->bsf", x, w1)
        up = torch.einsum("bsd,df->bsf", x, w3)
        h = _silu(gate) * up
        out = torch.einsum("bsf,fd->bsd", h, w2)
        return out

    x = A_x
    x = x + _A_ref(_layernorm(x, axis=-1), A_wqkv, A_wo)
    x = x + _B_ref(_layernorm(x, axis=-1), B_w1, B_w3, B_w2)
    x = x + _A_ref(_layernorm(x, axis=-1), A_wqkv, A_wo)
    x = x + _B_ref(_layernorm(x, axis=-1), B_w1, B_w3, B_w2)
    return x
```

```asm
; @launch grid=(256,1,1) block=(256,1,1) lds=163840
.amdgcn_target "amdgcn-amd-amdhsa--gfx950"
.text
.globl interleave_layers__mha_block__glu_gated_swiglu__prompt_kernel
.p2align 8
.type interleave_layers__mha_block__glu_gated_swiglu__prompt_kernel,@function
interleave_layers__mha_block__glu_gated_swiglu__prompt_kernel:
  s_cmp_ge_u32 s2, 256
  s_cbranch_scc1 interleave_layers__mha_block__glu_gated_swiglu__prompt_kernel_end
  s_load_dwordx2 s[4:5], s[0:1], 72
  s_load_dwordx2 s[6:7], s[0:1], 56
  s_load_dwordx2 s[100:101], s[0:1], 0
  s_load_dwordx4 s[40:43], s[0:1], 8
  s_load_dwordx2 s[44:45], s[0:1], 64
  v_lshrrev_b32 v5, 6, v0
  v_and_b32 v4, 63, v0
  s_lshl_b32 s35, s2, 2
  v_readfirstlane_b32 s33, v5
  v_and_b32 v5, 7, v0
  v_lshrrev_b32 v6, 3, v0
  s_add_u32 s35, s35, s33
  s_and_b32 s37, s35, 7
  s_lshr_b32 s38, s35, 3
  s_mul_i32 s36, s38, 171
  s_lshr_b32 s36, s36, 9
  s_mul_i32 s39, s36, 3
  s_sub_u32 s38, s38, s39
  s_mul_i32 s46, s36, 55296
  s_mul_i32 s39, s38, 1152
  s_add_u32 s46, s46, s39
  s_mul_i32 s39, s37, 144
  s_add_u32 s46, s46, s39
  v_and_b32 v56, 15, v0
  v_lshrrev_b32 v57, 5, v4
  v_bfe_u32 v58, v0, 4, 1
  v_bfe_u32 v59, v0, 3, 1
  v_bfe_u32 v60, v0, 2, 1
  s_cmp_eq_u32 s38, 2
  s_cselect_b32 s48, 36, 8
  s_cselect_b32 s49, 16, 36
  s_cselect_b32 s50, 8, 16
  v_mul_u32_u24 v10, 72, v57
  v_mad_u32_u24 v10, v58, s48, v10
  v_mad_u32_u24 v10, v59, s49, v10
  v_mad_u32_u24 v10, v60, s50, v10
  v_and_b32 v61, 3, v0
  v_lshl_add_u32 v10, v61, 1, v10
  v_mul_u32_u24 v7, 1152, v5
  v_lshl_add_u32 v7, v6, 4, v7
  v_mov_b32 v9, 1073741824
  v_cmp_gt_u32 vcc, 64, v0
  s_mul_i32 s34, s2, 9216
  s_mov_b32 s22, 1990656
  v_cndmask_b32 v8, v9, v7, vcc
  s_mov_b32 s23, 0x20000
  s_mov_b32 s18, 2359296
  s_mov_b32 s19, 0x20000
  s_mov_b32 s39, s46
  s_waitcnt lgkmcnt(0)
  s_mov_b32 s16, s100
  s_mov_b32 s17, s101
  s_mov_b32 s20, s40
  s_mov_b32 s21, s41
  s_cmp_eq_u32 s35, 3
  s_cbranch_scc1 p_clear
p_x:
  buffer_load_dwordx4 v[16:19], v7, s[16:19], s34 offen
  buffer_load_dwordx4 v[20:23], v7, s[16:19], s34 offen offset:512
  buffer_load_dwordx4 v[24:27], v8, s[16:19], s34 offen offset:1024
  buffer_load_ushort v64, v10, s[20:23], s39 offen
  buffer_load_ushort v65, v10, s[20:23], s39 offen offset:3456
  s_add_u32 s39, s39, 6912
  buffer_load_ushort v66, v10, s[20:23], s39 offen
  buffer_load_ushort v67, v10, s[20:23], s39 offen offset:3456
  s_add_u32 s39, s39, 6912
  buffer_load_ushort v68, v10, s[20:23], s39 offen
  buffer_load_ushort v69, v10, s[20:23], s39 offen offset:3456
  s_add_u32 s39, s39, 6912
  buffer_load_ushort v70, v10, s[20:23], s39 offen
  buffer_load_ushort v71, v10, s[20:23], s39 offen offset:3456
  s_add_u32 s39, s39, 6912
  buffer_load_ushort v72, v10, s[20:23], s39 offen
  buffer_load_ushort v73, v10, s[20:23], s39 offen offset:3456
  s_add_u32 s39, s39, 6912
  buffer_load_ushort v74, v10, s[20:23], s39 offen
  buffer_load_ushort v75, v10, s[20:23], s39 offen offset:3456
  s_add_u32 s39, s39, 6912
  buffer_load_ushort v76, v10, s[20:23], s39 offen
  buffer_load_ushort v77, v10, s[20:23], s39 offen offset:3456
  s_add_u32 s39, s39, 6912
  buffer_load_ushort v78, v10, s[20:23], s39 offen
  buffer_load_ushort v79, v10, s[20:23], s39 offen offset:3456
  v_bfe_u32 v10, v0, 1, 2
  v_mul_u32_u24 v10, 36, v10
  v_and_b32 v11, 1, v0
  v_lshl_add_u32 v10, v11, 1, v10
  v_mul_u32_u24 v11, 27648, v59
  v_add3_u32 v10, v10, v11, 32
  v_cmp_gt_u32 vcc, 16, v4
  v_lshlrev_b32 v1, 4, v4
  v_mov_b32 v2, 0
  v_cndmask_b32 v10, v9, v10, vcc
  v_mov_b32 v3, 1
  buffer_load_ushort v80, v10, s[20:23], s46 offen
  buffer_load_ushort v81, v10, s[20:23], s46 offen offset:3456
  s_add_u32 s46, s46, 6912
  buffer_load_ushort v82, v10, s[20:23], s46 offen
  buffer_load_ushort v83, v10, s[20:23], s46 offen offset:3456
  s_add_u32 s46, s46, 6912
  buffer_load_ushort v84, v10, s[20:23], s46 offen
  buffer_load_ushort v85, v10, s[20:23], s46 offen offset:3456
  s_add_u32 s46, s46, 6912
  buffer_load_ushort v86, v10, s[20:23], s46 offen
  buffer_load_ushort v87, v10, s[20:23], s46 offen offset:3456
  s_mov_b32 s12, s4
  s_mov_b32 s13, s5
  s_mov_b32 s14, 100683776
  s_mov_b32 s15, 0x20000
  v_mov_b32 v12, 0
  v_mov_b32 v13, 0
  v_mov_b32 v14, 0
  v_mov_b32 v15, 0
  s_cmp_lg_u32 s35, 3
  s_cbranch_scc1 p_noboot
  s_mov_b32 s20, s44
  s_mov_b32 s21, s45
  s_mov_b32 s22, 256
  s_mov_b32 s23, 0x20000
  s_waitcnt vmcnt(27)
  s_mov_b64 exec, 1
  buffer_store_dword v3, v2, s[20:23], 0 offen sc1
  s_mov_b64 exec, -1
  s_branch p_noboot
p_clear:
  s_add_u32 s12, s4, 100646912
  s_addc_u32 s13, s5, 0
  s_mov_b32 s14, 36864
  s_mov_b32 s15, 0x20000
  v_lshrrev_b32 v1, 3, v4
  v_mul_u32_u24 v1, 1152, v1
  v_lshl_add_u32 v1, v5, 4, v1
  v_mov_b32 v12, 0
  v_mov_b32 v13, 0
  v_mov_b32 v14, 0
  v_mov_b32 v15, 0
  s_mov_b32 s47, 0
  buffer_store_dwordx4 v[12:15], v1, s[12:15], s47 offen sc1
  s_mov_b32 s47, 9216
  buffer_store_dwordx4 v[12:15], v1, s[12:15], s47 offen sc1
  s_mov_b32 s47, 18432
  buffer_store_dwordx4 v[12:15], v1, s[12:15], s47 offen sc1
  s_mov_b32 s47, 27648
  buffer_store_dwordx4 v[12:15], v1, s[12:15], s47 offen sc1
  s_branch p_x
p_noboot:
  s_and_b32 s47, s36, 1
  s_lshl_b32 s47, s47, 9
  s_mul_i32 s39, s37, 2248704
  s_add_u32 s47, s47, s39
  s_add_u32 s47, s47, 83193856
  s_cmp_ge_u32 s36, 36
  s_cselect_b32 s47, 1073741824, s47
  s_lshr_b32 s49, s36, 1
  s_mul_i32 s50, s49, 5120
  s_lshl_b32 s39, s38, 6
  s_add_u32 s48, s47, s39
  s_add_u32 s48, s48, s50
  s_add_u32 s48, s48, 4096
  s_lshl_b32 s39, s38, 11
  s_add_u32 s50, s50, s39
  s_sub_u32 s50, s50, 2048
  s_lshl_b32 s49, s49, 11
  s_add_u32 s49, s49, 92160
  s_cmp_eq_u32 s38, 0
  s_cselect_b32 s50, s49, s50
  s_add_u32 s47, s47, s50
  v_mul_u32_u24 v11, 1124352, v57
  v_lshl_add_u32 v11, v58, 10, v11
  v_lshl_add_u32 v11, v56, 4, v11
  v_mul_u32_u24 v62, 1124352, v60
  v_lshl_add_u32 v62, v59, 8, v62
  v_lshl_add_u32 v62, v61, 4, v62
  v_mul_u32_u24 v63, 192, v58
  s_cmp_eq_u32 s38, 0
  s_cselect_b32 s39, 32, 16
  v_cmp_gt_u32 vcc, s39, v4
  v_add_u32 v62, v62, v63
  s_nop 0
  v_cndmask_b32 v120, v9, v62, vcc
  s_getpc_b64 s[40:41]
p_pc:
  s_bfe_u32 s39, s2, 0x50003
  s_lshl_b32 s39, s39, 2
  s_add_u32 s39, s39, s33
  s_lshl_b32 s39, s39, 9
  v_and_b32 v60, 3, v0
  v_lshl_add_u32 v60, v60, 7, s39
  v_min_u32 v60, main_code_end-p_pc-4, v60
  v_mov_b32 v61, s41
  v_add_co_u32 v60, vcc, s40, v60
  s_nop 1
  v_addc_co_u32 v61, vcc, 0, v61, vcc
  global_load_dword v121, v[60:61], off
  v_lshlrev_b32 v58, 4, v0
  v_cmp_gt_u32 vcc, 112, v0
  s_mul_i32 s51, s2, 1792
  s_add_u32 s51, s51, 100188160
  v_cndmask_b32 v123, v9, v58, vcc
  v_cmp_gt_u32 vcc, 64, v0
  v_lshlrev_b32 v7, 8, v6
  v_lshl_add_u32 v7, v5, 4, v7
  v_cndmask_b32 v8, v9, v7, vcc
  s_lshr_b32 s34, s2, 1
  s_mul_i32 s34, s34, 18432
  s_and_b32 s36, s2, 1
  s_lshl_b32 s36, s36, 7
  s_add_u32 s34, s34, s36
  s_add_u32 s34, s34, 40763392
  v_lshlrev_b32 v5, 3, v5
  v_add_u32 v5, 147456, v5
  v_bfe_u32 v6, v0, 5, 1
  v_lshl_add_u32 v6, v6, 2, v5
  v_and_b32 v58, 0xc0, v0
  v_add_u32 v6, v6, v58
  s_waitcnt vmcnt(25)
  v_lshlrev_b32 v32, 16, v16
  v_and_b32 v33, 0xffff0000, v16
  v_lshlrev_b32 v34, 16, v17
  v_and_b32 v35, 0xffff0000, v17
  v_lshlrev_b32 v36, 16, v18
  v_and_b32 v37, 0xffff0000, v18
  v_lshlrev_b32 v38, 16, v19
  v_and_b32 v39, 0xffff0000, v19
  v_lshlrev_b32 v40, 16, v20
  v_and_b32 v41, 0xffff0000, v20
  v_lshlrev_b32 v42, 16, v21
  v_and_b32 v43, 0xffff0000, v21
  v_lshlrev_b32 v44, 16, v22
  v_and_b32 v45, 0xffff0000, v22
  v_lshlrev_b32 v46, 16, v23
  v_and_b32 v47, 0xffff0000, v23
  v_lshlrev_b32 v48, 16, v24
  v_and_b32 v49, 0xffff0000, v24
  v_lshlrev_b32 v50, 16, v25
  v_and_b32 v51, 0xffff0000, v25
  v_lshlrev_b32 v52, 16, v26
  v_and_b32 v53, 0xffff0000, v26
  v_lshlrev_b32 v54, 16, v27
  v_and_b32 v55, 0xffff0000, v27
  v_pk_add_f32 v[28:29], v[32:33], v[34:35]
  v_pk_mul_f32 v[30:31], v[32:33], v[32:33]
  v_pk_fma_f32 v[30:31], v[34:35], v[34:35], v[30:31]
  v_pk_add_f32 v[28:29], v[28:29], v[36:37]
  v_pk_fma_f32 v[30:31], v[36:37], v[36:37], v[30:31]
  v_pk_add_f32 v[28:29], v[28:29], v[38:39]
  v_pk_fma_f32 v[30:31], v[38:39], v[38:39], v[30:31]
  v_pk_add_f32 v[28:29], v[28:29], v[40:41]
  v_pk_fma_f32 v[30:31], v[40:41], v[40:41], v[30:31]
  v_pk_add_f32 v[28:29], v[28:29], v[42:43]
  v_pk_fma_f32 v[30:31], v[42:43], v[42:43], v[30:31]
  v_pk_add_f32 v[28:29], v[28:29], v[44:45]
  v_pk_fma_f32 v[30:31], v[44:45], v[44:45], v[30:31]
  v_pk_add_f32 v[28:29], v[28:29], v[46:47]
  v_pk_fma_f32 v[30:31], v[46:47], v[46:47], v[30:31]
  v_pk_add_f32 v[28:29], v[28:29], v[48:49]
  v_pk_fma_f32 v[30:31], v[48:49], v[48:49], v[30:31]
  v_pk_add_f32 v[28:29], v[28:29], v[50:51]
  v_pk_fma_f32 v[30:31], v[50:51], v[50:51], v[30:31]
  v_pk_add_f32 v[28:29], v[28:29], v[52:53]
  v_pk_fma_f32 v[30:31], v[52:53], v[52:53], v[30:31]
  v_pk_add_f32 v[28:29], v[28:29], v[54:55]
  v_pk_fma_f32 v[30:31], v[54:55], v[54:55], v[30:31]
  v_add_f32 v28, v28, v29
  v_add_f32 v29, v30, v31
  s_nop 1
  v_permlane32_swap_b32 v28, v29
  s_nop 0
  v_add_f32 v28, v28, v29
  v_mov_b32 v29, v28
  s_nop 1
  v_permlane16_swap_b32 v28, v29
  s_nop 0
  v_add_f32 v28, v28, v29
  s_nop 1
  v_add_f32 v28, v28, v28 row_ror:8 row_mask:0xf bank_mask:0xf
  ds_write_b32 v6, v28
  s_waitcnt lgkmcnt(0)
  s_barrier
  ds_read_b64 v[16:17], v5 offset:0
  ds_read_b64 v[18:19], v5 offset:64
  ds_read_b64 v[20:21], v5 offset:128
  ds_read_b64 v[22:23], v5 offset:192
  s_waitcnt lgkmcnt(0)
  v_pk_add_f32 v[16:17], v[16:17], v[18:19]
  v_pk_add_f32 v[16:17], v[16:17], v[20:21]
  v_pk_add_f32 v[16:17], v[16:17], v[22:23]
  v_mul_f32 v16, 0x3ae38e39, v16
  v_mul_f32 v17, 0x3ae38e39, v17
  v_fma_f32 v17, -v16, v16, v17
  v_max_f32 v17, 0, v17
  v_add_f32 v17, 0x3727c5ac, v17
  v_rsq_f32 v17, v17
  s_add_u32 s36, s34, 8192
  v_mul_f32 v16, v16, v17
  s_add_u32 s37, s34, 16384
  v_pk_fma_f32 v[32:33], v[32:33], v[16:17], v[16:17] op_sel:[0,1,0] op_sel_hi:[1,1,0] neg_lo:[0,0,1] neg_hi:[0,0,1]
  v_pk_fma_f32 v[34:35], v[34:35], v[16:17], v[16:17] op_sel:[0,1,0] op_sel_hi:[1,1,0] neg_lo:[0,0,1] neg_hi:[0,0,1]
  v_pk_fma_f32 v[36:37], v[36:37], v[16:17], v[16:17] op_sel:[0,1,0] op_sel_hi:[1,1,0] neg_lo:[0,0,1] neg_hi:[0,0,1]
  v_pk_fma_f32 v[38:39], v[38:39], v[16:17], v[16:17] op_sel:[0,1,0] op_sel_hi:[1,1,0] neg_lo:[0,0,1] neg_hi:[0,0,1]
  v_cvt_pk_bf16_f32 v96, v32, v33
  v_cvt_pk_bf16_f32 v97, v34, v35
  v_cvt_pk_bf16_f32 v98, v36, v37
  v_cvt_pk_bf16_f32 v99, v38, v39
  buffer_store_dwordx4 v[96:99], v7, s[12:15], s34 offen sc1
  v_pk_fma_f32 v[40:41], v[40:41], v[16:17], v[16:17] op_sel:[0,1,0] op_sel_hi:[1,1,0] neg_lo:[0,0,1] neg_hi:[0,0,1]
  v_pk_fma_f32 v[42:43], v[42:43], v[16:17], v[16:17] op_sel:[0,1,0] op_sel_hi:[1,1,0] neg_lo:[0,0,1] neg_hi:[0,0,1]
  v_pk_fma_f32 v[44:45], v[44:45], v[16:17], v[16:17] op_sel:[0,1,0] op_sel_hi:[1,1,0] neg_lo:[0,0,1] neg_hi:[0,0,1]
  v_pk_fma_f32 v[46:47], v[46:47], v[16:17], v[16:17] op_sel:[0,1,0] op_sel_hi:[1,1,0] neg_lo:[0,0,1] neg_hi:[0,0,1]
  v_cvt_pk_bf16_f32 v100, v40, v41
  v_cvt_pk_bf16_f32 v101, v42, v43
  v_cvt_pk_bf16_f32 v102, v44, v45
  v_cvt_pk_bf16_f32 v103, v46, v47
  buffer_store_dwordx4 v[100:103], v7, s[12:15], s36 offen sc1
  v_pk_fma_f32 v[48:49], v[48:49], v[16:17], v[16:17] op_sel:[0,1,0] op_sel_hi:[1,1,0] neg_lo:[0,0,1] neg_hi:[0,0,1]
  v_pk_fma_f32 v[50:51], v[50:51], v[16:17], v[16:17] op_sel:[0,1,0] op_sel_hi:[1,1,0] neg_lo:[0,0,1] neg_hi:[0,0,1]
  v_pk_fma_f32 v[52:53], v[52:53], v[16:17], v[16:17] op_sel:[0,1,0] op_sel_hi:[1,1,0] neg_lo:[0,0,1] neg_hi:[0,0,1]
  v_pk_fma_f32 v[54:55], v[54:55], v[16:17], v[16:17] op_sel:[0,1,0] op_sel_hi:[1,1,0] neg_lo:[0,0,1] neg_hi:[0,0,1]
  v_cvt_pk_bf16_f32 v104, v48, v49
  v_cvt_pk_bf16_f32 v105, v50, v51
  v_cvt_pk_bf16_f32 v106, v52, v53
  v_cvt_pk_bf16_f32 v107, v54, v55
  buffer_store_dwordx4 v[104:107], v8, s[12:15], s37 offen sc1
  s_waitcnt vmcnt(12)
  v_lshl_or_b32 v108, v65, 16, v64
  v_lshl_or_b32 v109, v67, 16, v66
  v_lshl_or_b32 v110, v69, 16, v68
  v_lshl_or_b32 v111, v71, 16, v70
  buffer_store_dwordx4 v[108:111], v11, s[12:15], s47 offen offset:0 sc1
  v_lshl_or_b32 v112, v73, 16, v72
  v_lshl_or_b32 v113, v75, 16, v74
  v_lshl_or_b32 v114, v77, 16, v76
  v_lshl_or_b32 v115, v79, 16, v78
  buffer_store_dwordx4 v[112:115], v11, s[12:15], s47 offen offset:256 sc1
  s_waitcnt vmcnt(6)
  v_lshl_or_b32 v64, v81, 16, v80
  v_lshl_or_b32 v65, v83, 16, v82
  v_lshl_or_b32 v66, v85, 16, v84
  v_lshl_or_b32 v67, v87, 16, v86
  buffer_store_dwordx4 v[64:67], v120, s[12:15], s48 offen sc1
  buffer_store_dwordx4 v[12:15], v123, s[12:15], s51 offen sc1
  s_bfe_u32 s52, s2, 131072
  s_lshl_b32 s52, s52, 2
  s_bfe_u32 s53, s2, 131075
  s_add_u32 s25, s52, s53
  s_bfe_u32 s52, s2, 65538
  s_lshl_b32 s52, s52, 3
  s_lshr_b32 s53, s2, 5
  s_add_u32 s24, s52, s53
  s_lshl_b32 s52, s24, 2
  s_add_u32 s28, s52, s33
  s_lshr_b32 s53, s25, 2
  s_add_u32 s29, s52, s53
  s_mov_b32 s26, 0
  s_mov_b32 s27, 100253696
  s_mov_b32 s30, 0x3f80
  s_mov_b32 s31, 0x3f800000
  s_lshl_b32 s10, s33, 10
  s_mov_b32 s20, s44
  s_mov_b32 s21, s45
  s_mov_b32 s22, 256
  s_mov_b32 s23, 0x20000
  s_mov_b32 s61, 0x40000
  s_cmp_lg_u32 s33, 3
  s_cbranch_scc1 p_boot
p_wait:
  buffer_load_dword v4, v2, s[20:23], 0 offen sc1
  s_sub_u32 s61, s61, 1
  s_waitcnt vmcnt(0)
  v_cmp_eq_u32 vcc, 0, v4
  s_cbranch_scc1 p_boot
  s_cbranch_vccnz p_wait
p_boot:
  s_lshr_b32 s34, s2, 3
  s_mul_i32 s34, s34, 9
  s_lshl_b32 s60, s34, 7
  s_add_u32 s60, s60, s27
  s_add_u32 s60, s60, 393216
  s_waitcnt vmcnt(0) lgkmcnt(0)
p_bar:
  s_barrier
  s_cmp_lg_u32 s33, 3
  s_cbranch_scc1 p_sig
  s_mov_b64 exec, 1
  buffer_atomic_add v3, v2, s[12:15], s60 offen sc1
  s_mov_b64 exec, -1
p_sig:
  s_mul_i32 s35, s2, 3
  s_add_u32 s35, s35, s33
  s_cmp_eq_u32 s33, 3
  s_cselect_b32 s35, 1000, s35
  v_and_b32 v4, 63, v0
  s_mul_i32 s36, s35, 911
  s_lshr_b32 s36, s36, 13
  s_mul_i32 s37, s36, 9
  s_sub_u32 s37, s35, s37
  s_lshr_b32 s46, s36, 1
  s_mul_i32 s46, s46, 20736
  s_and_b32 s39, s36, 1
  s_mul_i32 s39, s39, 4608
  s_add_u32 s46, s46, s39
  s_mov_b32 s50, 9216
  s_mov_b32 s51, 2304
  s_cmp_lt_u32 s36, 64
  s_cbranch_scc1 p_wo2
  s_sub_u32 s46, s36, 64
  s_mul_i32 s46, s46, 82944
  s_add_u32 s46, s46, 18432
  s_mov_b32 s50, 41472
  s_mov_b32 s51, 20736
p_wo2:
  s_lshl_b32 s39, s37, 7
  s_add_u32 s46, s46, s39
  s_and_b32 s53, s36, 3
  s_lshl_b32 s53, s53, 8
  s_add_u32 s53, s53, 81526784
  s_cmp_lt_u32 s35, 648
  s_cselect_b32 s46, s46, 1073741824
  s_cmp_lt_u32 s35, 648
  s_cselect_b32 s53, s53, 1073741824
  v_lshlrev_b32 v59, 1, v4
  s_mov_b32 s20, s42
  s_mov_b32 s21, s43
  s_mov_b32 s22, 663552
  s_mov_b32 s23, 0x20000
  s_mov_b32 s39, s46
  buffer_load_ushort v88, v59, s[20:23], s39 offen
  buffer_load_ushort v89, v59, s[20:23], s39 offen offset:1152
  s_mov_b32 s39, s46
  s_add_u32 s39, s39, s51
  buffer_load_ushort v90, v59, s[20:23], s39 offen
  buffer_load_ushort v91, v59, s[20:23], s39 offen offset:1152
  s_mov_b32 s39, s46
  s_add_u32 s39, s39, s50
  buffer_load_ushort v92, v59, s[20:23], s39 offen
  buffer_load_ushort v93, v59, s[20:23], s39 offen offset:1152
  s_mov_b32 s39, s46
  s_add_u32 s39, s39, s50
  s_add_u32 s39, s39, s51
  buffer_load_ushort v94, v59, s[20:23], s39 offen
  buffer_load_ushort v95, v59, s[20:23], s39 offen offset:1152
  s_lshr_b32 s36, s36, 2
  s_lshl_b32 s37, s37, 2
  v_lshrrev_b32 v57, 4, v4
  v_add_u32 v57, s37, v57
  v_mul_u32_u24 v58, 43, v57
  v_lshrrev_b32 v58, 7, v58
  v_mul_u32_u24 v59, 3, v58
  v_sub_u32 v59, v57, v59
  v_mad_u32_u24 v59, v59, 18, s36
  v_mul_u32_u24 v57, 43, v58
  v_lshrrev_b32 v57, 7, v57
  v_mul_u32_u24 v60, 3, v57
  v_sub_u32 v58, v58, v60
  v_mad_u32_u24 v60, v58, 12, v59
  v_mad_u32_u24 v61, v58, 26, v59
  v_add_u32 v61, 24, v61
  v_lshl_add_u32 v63, v58, 4, v59
  v_add_u32 v63, 76, v63
  v_cmp_gt_u32 vcc, 12, v59
  v_cmp_gt_u32 s[40:41], 38, v59
  v_mul_u32_u24 v57, 167936, v57
  v_lshl_add_u32 v57, v56, 4, v57
  v_cndmask_b32 v61, v63, v61, s[40:41]
  v_cndmask_b32 v60, v61, v60, vcc
  v_lshl_add_u32 v57, v60, 10, v57
  v_bfe_u32 v8, v0, 4, 2
  v_bfe_u32 v9, v0, 2, 2
  v_and_b32 v12, 3, v0
  v_lshlrev_b32 v12, 3, v12
  v_lshl_add_u32 v12, v9, 7, v12
  v_bfe_u32 v13, v0, 3, 2
  v_xor_b32 v13, s33, v13
  v_lshrrev_b32 v78, 1, v1
  s_mov_b32 s11, 5308416
  s_cmp_ge_u32 s2, 216
  s_cbranch_scc1 a_rawq
  s_cmp_ge_u32 s2, 144
  s_cbranch_scc1 a_raw2
  s_and_b32 s38, s2, 1
  s_lshl_b32 s39, s38, 3
  s_add_u32 s44, s0, s39
  s_addc_u32 s45, s1, 0
  s_load_dwordx2 s[54:55], s[44:45], 32
  s_lshr_b32 s39, s2, 1
  s_lshl_b32 s56, s39, 7
  s_mov_b32 s41, 9216
  s_mov_b32 s59, 2048
  s_mov_b32 s9, 0
  s_lshl_b32 s39, s39, 2
  s_add_u32 s39, s39, s33
  s_mul_i32 s44, s39, 57
  s_lshr_b32 s44, s44, 10
  s_lshl_b32 s8, s39, 7
  s_mul_i32 s45, s44, 1792
  s_add_u32 s8, s8, s45
  s_lshl_b32 s45, s38, 2
  s_add_u32 s8, s8, s45
  s_add_u32 s8, s8, 100188160
  s_mul_i32 s44, s44, 460800
  s_mul_i32 s39, s39, 36864
  s_add_u32 s58, s39, s44
  s_lshl_b32 s38, s38, 10
  s_add_u32 s58, s58, s38
  s_add_u32 s58, s58, 82198528
a_rawn:
  v_lshl_add_u32 v12, v8, 10, v12
  v_lshl_add_u32 v76, v13, 5, v12
  v_xor_b32 v77, 576, v76
  s_branch a_raw3
a_rawq:
  s_load_dwordx2 s[54:55], s[0:1], 8
  s_sub_u32 s38, s2, 216
  s_lshl_b32 s56, s38, 7
  s_mov_b32 s41, 3456
  s_mov_b32 s58, 1073741824
  s_mov_b32 s59, 0
  s_mov_b32 s9, 0
  s_mov_b32 s8, 100190464
  s_mov_b32 s11, 1990656
  s_cmp_ge_u32 s38, 27
  s_cselect_b32 s8, s58, s8
  s_cselect_b32 s11, 0, s11
  s_mul_i32 s39, s38, 57
  s_lshr_b32 s39, s39, 9
  s_mul_i32 s44, s39, 9
  s_sub_u32 s38, s38, s44
  s_lshl_b32 s38, s38, 2
  s_add_u32 s38, s38, s33
  s_lshl_b32 s38, s38, 4
  v_and_b32 v14, 15, v0
  v_add_u32 v14, s38, v14
  v_mul_u32_u24 v15, 3641, v14
  v_lshrrev_b32 v15, 16, v15
  v_mul_u32_u24 v16, 18, v15
  v_sub_u32 v14, v14, v16
  v_and_b32 v16, 1, v15
  v_lshrrev_b32 v15, 1, v15
  v_bfe_u32 v17, v14, 2, 1
  v_bfe_u32 v18, v14, 3, 1
  v_lshl_add_u32 v18, v16, 1, v18
  v_and_b32 v19, 3, v14
  v_lshl_add_u32 v18, v18, 2, v19
  s_cmp_eq_u32 s39, 0
  s_cselect_b32 s44, 5, 0
  v_add_u32 v17, s44, v17
  s_cmp_eq_u32 s39, 2
  s_cselect_b64 vcc, -1, 0
  v_add_u32 v19, 2, v16
  v_cndmask_b32 v17, v17, v19, vcc
  v_cndmask_b32 v18, v18, v14, vcc
  v_cmp_le_u32 vcc, 16, v14
  s_lshl_b32 s44, s39, 2
  v_lshl_add_u32 v19, v16, 1, s44
  v_add3_u32 v19, v19, v14, -16
  v_cndmask_b32 v17, v17, 4, vcc
  v_cndmask_b32 v18, v18, v19, vcc
  v_lshlrev_b32 v15, 12, v15
  v_lshl_add_u32 v15, v18, 3, v15
  v_lshrrev_b32 v18, 1, v17
  v_lshl_add_u32 v15, v18, 7, v15
  v_and_b32 v17, 1, v17
  v_lshl_add_u32 v78, v17, 2, v15
  s_branch a_rawn
a_raw2:
  s_load_dwordx2 s[54:55], s[0:1], 48
  s_sub_u32 s38, s2, 144
  s_mul_i32 s39, s38, 57
  s_lshr_b32 s39, s39, 9
  s_mul_i32 s44, s39, 9
  s_sub_u32 s38, s38, s44
  s_mul_i32 s56, s39, 663552
  s_lshl_b32 s44, s38, 7
  s_add_u32 s56, s56, s44
  s_mov_b32 s41, 1152
  s_mov_b32 s8, 1073741824
  s_mov_b32 s59, 36864
  s_lshl_b32 s38, s38, 2
  s_add_u32 s38, s38, s33
  s_mul_i32 s44, s38, 29
  s_lshr_b32 s44, s44, 8
  s_lshl_b32 s45, s39, 1
  s_sub_u32 s45, s45, s44
  s_and_b32 s45, s45, 3
  s_mov_b32 s9, -322560
  s_cmp_eq_u32 s45, 3
  s_cselect_b32 s9, -359424, s9
  s_mul_i32 s45, s45, 9216
  s_mul_i32 s44, s44, 1115136
  s_lshl_b32 s38, s38, 10
  s_add_u32 s58, s38, s44
  s_add_u32 s58, s58, s45
  s_lshr_b32 s44, s39, 1
  s_mul_i32 s44, s44, 4497408
  s_add_u32 s58, s58, s44
  s_add_u32 s58, s58, 82862080
  v_lshl_add_u32 v12, v8, 9, v12
  v_and_b32 v8, 2, v8
  v_xor_b32 v13, v13, v8
  v_lshl_add_u32 v76, v13, 5, v12
  v_add_u32 v77, 2048, v76
a_raw3:
  v_bfe_u32 v8, v0, 3, 3
  v_mul_lo_u32 v12, v8, s41
  v_and_b32 v8, 6, v8
  v_and_b32 v9, 7, v0
  v_xor_b32 v9, v9, v8
  v_lshl_add_u32 v72, v9, 4, v12
  v_xor_b32 v9, 4, v9
  v_lshl_add_u32 v73, v9, 4, v12
  s_lshl_b32 s52, s41, 3
  s_sub_u32 s38, s52, 1024
  v_add_u32 v73, s38, v73
  s_lshl_b32 s38, s38, 1
  v_add_u32 v74, s38, v72
  v_add_u32 v75, s38, v73
  s_lshl_b32 s57, s52, 4
  s_waitcnt lgkmcnt(0)
layer:
  s_mul_i32 s34, s28, 36864
  s_add_u32 s34, s34, 40763392
  s_sub_u32 s34, s34, s26
  s_mov_b32 s36, s34
  s_add_u32 s37, s34, 18432
  s_mul_i32 s34, s25, 1124352
  s_add_u32 s34, s34, 83193856
  s_add_u32 s16, s4, s34
  s_addc_u32 s17, s5, 0
  s_mov_b32 s18, 129024
  s_mov_b32 s19, 0x20000
  v_and_b32 v12, 15, v0
  v_bfe_u32 v4, v0, 4, 2
  v_lshrrev_b32 v13, 1, v4
  v_and_b32 v14, 1, v4
  s_mul_i32 s38, s33, 1152
  s_add_u32 s38, s38, 131072
  s_mul_i32 s39, s33, 768
  s_add_u32 s39, s39, 149504
  v_lshlrev_b32 v15, 4, v12
  v_lshl_add_u32 v15, v14, 9, v15
  v_mul_u32_u24 v140, 4608, v13
  v_add3_u32 v140, v140, v15, s38
  v_mul_u32_u24 v141, 2432, v13
  v_add_u32 v141, v141, v15
  v_cmp_eq_u32 s[48:49], 0, v4
  v_lshlrev_b32 v6, 4, v4
  v_lshrrev_b32 v13, 2, v12
  v_and_b32 v15, 3, v12
  v_lshlrev_b32 v143, 5, v13
  v_lshl_add_u32 v143, v15, 1, v143
  v_add_u32 v143, s39, v143
  s_add_u32 s40, s38, 1024
  s_add_u32 s41, s39, 128
  v_lshl_add_u32 v144, v12, 2, s40
  v_lshl_add_u32 v15, v12, 2, s41
  v_cndmask_b32 v144, v15, v144, s[48:49]
  v_mov_b32 v13, 384
  v_mov_b32 v14, 4608
  v_cndmask_b32 v13, v13, v14, s[48:49]
  v_add_u32 v145, v144, v13
  v_and_b32 v14, 3, v0
  v_bfe_u32 v13, v0, 2, 1
  v_mul_u32_u24 v13, 384, v13
  v_lshl_add_u32 v13, v14, 2, v13
  v_add_u32 v148, s39, v13
  v_add_u32 v149, s39, v1
  v_add_u32 v13, 2048, v1
  v_cmp_gt_u32 vcc, 384, v1
  v_mov_b32 v14, 1073741824
  s_mul_i32 s43, s25, 311296
  v_cndmask_b32 v13, v13, v1, vcc
  v_cmp_gt_u32 vcc, 768, v1
  s_mul_i32 s44, s28, 4864
  s_add_u32 s43, s43, s44
  v_cndmask_b32 v150, v14, v13, vcc
  s_add_u32 s43, s43, s26
  s_add_u32 s43, s43, 35389440
  s_mul_i32 s42, s28, 3072
  s_add_u32 s42, s42, 40566784
  v_mov_b32 v7, 0x3f803f80
  v_add_u32 v5, 65536, v1
  v_mov_b32 v160, 0
  v_mov_b32 v161, 0
  v_mov_b32 v162, 0
  v_mov_b32 v163, 0
  v_mov_b32 v164, 0
  v_mov_b32 v165, 0
  v_mov_b32 v166, 0
  v_mov_b32 v167, 0
  v_mov_b32 v168, 0
  v_mov_b32 v169, 0
  v_mov_b32 v170, 0
  v_mov_b32 v171, 0
  v_mov_b32 v172, 0
  v_mov_b32 v173, 0
  v_mov_b32 v174, 0
  v_mov_b32 v175, 0
  v_mov_b32 v176, 0
  v_mov_b32 v177, 0
  v_mov_b32 v178, 0
  v_mov_b32 v179, 0
  v_mov_b32 v180, 0
  v_mov_b32 v181, 0
  v_mov_b32 v182, 0
  v_mov_b32 v183, 0
  v_mov_b32 v184, 0
  v_mov_b32 v185, 0
  v_mov_b32 v186, 0
  v_mov_b32 v187, 0
  v_mov_b32 v188, 0
  v_mov_b32 v189, 0
  v_mov_b32 v190, 0
  v_mov_b32 v191, 0
  v_mov_b32 v192, 0
  v_mov_b32 v193, 0
  v_mov_b32 v194, 0
  v_mov_b32 v195, 0
  v_mov_b32 v196, 0
  v_mov_b32 v197, 0
  v_mov_b32 v198, 0
  v_mov_b32 v199, 0
  v_mov_b32 v200, 0
  v_mov_b32 v201, 0
  v_mov_b32 v202, 0
  v_mov_b32 v203, 0
  v_mov_b32 v204, 0
  v_mov_b32 v205, 0
  v_mov_b32 v206, 0
  v_mov_b32 v207, 0
  v_mov_b32 v208, 0
  v_mov_b32 v209, 0
  v_mov_b32 v210, 0
  v_mov_b32 v211, 0
  v_mov_b32 v212, 0
  v_mov_b32 v213, 0
  v_mov_b32 v214, 0
  v_mov_b32 v215, 0
  v_mov_b32 v216, 0
  v_mov_b32 v217, 0
  v_mov_b32 v218, 0
  v_mov_b32 v219, 0
  v_mov_b32 v220, 0
  v_mov_b32 v221, 0
  v_mov_b32 v222, 0
  v_mov_b32 v223, 0
  s_cmp_eq_u32 s26, 0
  s_cbranch_scc0 q_next
  s_waitcnt vmcnt(0)
  v_lshl_or_b32 v116, v89, 16, v88
  v_lshl_or_b32 v117, v91, 16, v90
  v_lshl_or_b32 v118, v93, 16, v92
  v_lshl_or_b32 v119, v95, 16, v94
  buffer_store_dwordx4 v[116:119], v57, s[12:15], s53 offen sc1
  v_mov_b32 v152, 1073741824
  v_cmp_eq_u32 vcc, 0, v0
  v_and_b32 v153, 31, v0
  v_lshlrev_b32 v153, 12, v153
  v_cndmask_b32 v152, v152, v2, vcc
  s_lshr_b32 s44, s2, 3
  s_lshl_b32 s44, s44, 12
  s_add_u32 s44, s44, 100321536
  s_mov_b32 s45, 100321536
  s_cmp_eq_u32 s33, 3
  s_cselect_b32 s45, s45, 1073741824
  s_cselect_b32 s46, 8, 0
  s_cmp_lg_u32 s33, 3
  s_cbranch_scc1 g_ok
  v_and_b32 v8, 31, v0
  v_mul_u32_u24 v8, 1152, v8
  s_mov_b32 s60, 100646912
  s_mov_b32 s61, 0x40000
g_poll:
  buffer_load_dword v4, v8, s[12:15], s60 offen sc1
  s_sub_u32 s61, s61, 1
  s_waitcnt vmcnt(0)
  v_cmp_gt_u32 vcc, 8, v4
  s_cbranch_scc1 g_ok
  s_cbranch_vccnz g_poll
g_ok:
  s_barrier
  s_mov_b32 m0, s10
  s_nop 0
  buffer_load_dwordx4 v1, s[16:19], s10 offen sc1 lds
  s_add_u32 s10, s10, 4096
  s_mov_b32 m0, s10
  s_nop 0
  buffer_load_dwordx4 v1, s[16:19], s10 offen sc1 lds
  s_add_u32 s10, s10, 4096
  s_mov_b32 m0, s10
  s_nop 0
  buffer_load_dwordx4 v1, s[16:19], s10 offen sc1 lds
  s_add_u32 s10, s10, 4096
  s_mov_b32 m0, s10
  s_nop 0
  buffer_load_dwordx4 v1, s[16:19], s10 offen sc1 lds
  s_add_u32 s10, s10, 4096
  s_mov_b32 m0, s10
  s_nop 0
  buffer_load_dwordx4 v1, s[16:19], s10 offen sc1 lds
  s_add_u32 s10, s10, 4096
  s_mov_b32 m0, s10
  s_nop 0
  buffer_load_dwordx4 v1, s[16:19], s10 offen sc1 lds
  s_add_u32 s10, s10, 4096
  s_mov_b32 m0, s10
  s_nop 0
  buffer_load_dwordx4 v1, s[16:19], s10 offen sc1 lds
  s_add_u32 s10, s10, 4096
  s_mov_b32 m0, s10
  s_nop 0
  buffer_load_dwordx4 v1, s[16:19], s10 offen sc1 lds
  s_add_u32 s10, s10, 4096
  s_branch q_ok
q_next:
  s_lshl_b32 s60, s28, 11
  s_add_u32 s60, s60, s27
  s_add_u32 s60, s60, -129664
  s_mov_b32 s61, 0x40000
q_poll:
  buffer_load_dword v4, v2, s[12:15], s60 offen sc1
  s_sub_u32 s61, s61, 1
  s_waitcnt vmcnt(0)
  v_cmp_gt_u32 vcc, 4, v4
  s_cbranch_scc1 q_ok
  s_cbranch_vccnz q_poll
q_ok:
  s_mov_b32 m0, s10
  buffer_load_dwordx4 a[64:67], v1, s[12:15], s36 offen sc1
  buffer_load_dwordx4 a[68:71], v1, s[12:15], s37 offen sc1
  buffer_load_dwordx4 a[72:75], v1, s[12:15], s36 offen offset:1024 sc1
  buffer_load_dwordx4 a[76:79], v1, s[12:15], s37 offen offset:1024 sc1
  s_waitcnt vmcnt(4)
  s_barrier
  ds_read_b128 a[16:19], v1 offset:4096
  ds_read_b128 a[0:3], v1 offset:0
  ds_read_b128 a[4:7], v1 offset:1024
  ds_read_b128 a[8:11], v1 offset:2048
  ds_read_b128 a[12:15], v1 offset:3072
  buffer_load_dwordx4 a[80:83], v1, s[12:15], s36 offen offset:2048 sc1
  buffer_load_dwordx4 a[84:87], v1, s[12:15], s37 offen offset:2048 sc1
  buffer_load_dwordx4 a[88:91], v1, s[12:15], s36 offen offset:3072 sc1
  s_add_u32 s36, s36, 4096
  buffer_load_dwordx4 a[92:95], v1, s[12:15], s37 offen offset:3072 sc1
  s_add_u32 s37, s37, 4096
  buffer_load_dwordx4 a[96:99], v1, s[12:15], s36 offen sc1
  buffer_load_dwordx4 a[100:103], v1, s[12:15], s37 offen sc1
  s_cmp_eq_u32 s26, 0
  s_waitcnt vmcnt(8) lgkmcnt(0)
  s_cbranch_scc1 q_fill
  v_mfma_f32_16x16x32_bf16 v[48:51], a[16:19], a[64:67], 0
  ds_read_b128 a[36:39], v1 offset:9216
  v_and_b32 v159, 15, v0
  v_mfma_f32_16x16x32_bf16 v[52:55], a[16:19], a[68:71], 0
  buffer_load_dwordx4 a[104:107], v1, s[12:15], s36 offen offset:1024 sc1
  v_mfma_f32_16x16x32_bf16 v[16:19], a[0:3], a[64:67], 0
  ds_read_b128 a[20:23], v1 offset:5120
  v_lshlrev_b32 v159, 3, v159
  v_mfma_f32_16x16x32_bf16 v[20:23], a[0:3], a[68:71], 0
  v_add_u32 v159, 158976, v159
  v_bfe_u32 v88, v0, 4, 2
  v_mfma_f32_16x16x32_bf16 v[24:27], a[4:7], a[64:67], 0
  ds_read_b128 a[24:27], v1 offset:6144
  v_cmp_eq_u32 s[54:55], 0, v88
  v_mfma_f32_16x16x32_bf16 v[28:31], a[4:7], a[68:71], 0
  ds_read_b128 a[28:31], v1 offset:7168
  v_cmp_eq_u32 s[56:57], 1, v88
  v_mfma_f32_16x16x32_bf16 v[32:35], a[64:67], a[8:11], 0
  buffer_load_dwordx4 a[108:111], v1, s[12:15], s37 offen offset:1024 sc1
  v_mfma_f32_16x16x32_bf16 v[36:39], a[68:71], a[8:11], 0
  ds_read_b128 a[32:35], v1 offset:8192
  s_mov_b32 s58, 0x07060302
  v_mfma_f32_16x16x32_bf16 v[40:43], a[64:67], a[12:15], 0
  buffer_load_dwordx4 v[104:107], v1, s[12:15], s42 offen offset:0 sc1
  v_mfma_f32_16x16x32_bf16 v[44:47], a[68:71], a[12:15], 0
  s_waitcnt vmcnt(9) lgkmcnt(3)
  v_mov_b32 v81, 0
  v_mov_b32 v82, 0
  v_mfma_f32_16x16x32_bf16 v[48:51], a[36:39], a[72:75], v[48:51]
  ds_read_b128 a[16:19], v1 offset:14336
  v_mov_b32 v85, 0
  v_mfma_f32_16x16x32_bf16 v[52:55], a[36:39], a[76:79], v[52:55]
  buffer_load_dwordx4 a[112:115], v1, s[12:15], s36 offen offset:2048 sc1
  v_mfma_f32_16x16x32_bf16 v[16:19], a[20:23], a[72:75], v[16:19]
  ds_read_b128 a[0:3], v1 offset:10240
  v_mov_b32 v86, 0
  v_mfma_f32_16x16x32_bf16 v[20:23], a[20:23], a[76:79], v[20:23]
  s_waitcnt lgkmcnt(2)
  v_mfma_f32_16x16x32_bf16 v[24:27], a[24:27], a[72:75], v[24:27]
  ds_read_b128 a[4:7], v1 offset:11264
  v_mfma_f32_16x16x32_bf16 v[28:31], a[24:27], a[76:79], v[28:31]
  ds_read_b128 a[8:11], v1 offset:12288
  v_mfma_f32_16x16x32_bf16 v[32:35], a[72:75], a[28:31], v[32:35]
  buffer_load_dwordx4 a[116:119], v1, s[12:15], s37 offen offset:2048 sc1
  v_mfma_f32_16x16x32_bf16 v[36:39], a[76:79], a[28:31], v[36:39]
  ds_read_b128 a[12:15], v1 offset:13312
  v_mfma_f32_16x16x32_bf16 v[40:43], a[72:75], a[32:35], v[40:43]
  buffer_load_dwordx4 v[108:111], v1, s[12:15], s42 offen offset:1024 sc1
  v_mfma_f32_16x16x32_bf16 v[44:47], a[76:79], a[32:35], v[44:47]
  s_waitcnt vmcnt(10) lgkmcnt(3)
  v_mfma_f32_16x16x32_bf16 v[48:51], a[16:19], a[80:83], v[48:51]
  ds_read_b128 a[36:39], v1 offset:19456
  v_mfma_f32_16x16x32_bf16 v[52:55], a[16:19], a[84:87], v[52:55]
  buffer_load_dwordx4 a[120:123], v1, s[12:15], s36 offen offset:3072 sc1
  v_mfma_f32_16x16x32_bf16 v[16:19], a[0:3], a[80:83], v[16:19]
  ds_read_b128 a[20:23], v1 offset:15360
  s_add_u32 s36, s36, 4096
  v_mfma_f32_16x16x32_bf16 v[20:23], a[0:3], a[84:87], v[20:23]
  s_waitcnt lgkmcnt(2)
  v_mfma_f32_16x16x32_bf16 v[24:27], a[4:7], a[80:83], v[24:27]
  ds_read_b128 a[24:27], v1 offset:16384
  v_mfma_f32_16x16x32_bf16 v[28:31], a[4:7], a[84:87], v[28:31]
  ds_read_b128 a[28:31], v1 offset:17408
  v_mfma_f32_16x16x32_bf16 v[32:35], a[80:83], a[8:11], v[32:35]
  buffer_load_dwordx4 a[124:127], v1, s[12:15], s37 offen offset:3072 sc1
  v_mfma_f32_16x16x32_bf16 v[36:39], a[84:87], a[8:11], v[36:39]
  ds_read_b128 a[32:35], v1 offset:18432
  s_add_u32 s37, s37, 4096
  v_mfma_f32_16x16x32_bf16 v[40:43], a[80:83], a[12:15], v[40:43]
  buffer_load_dwordx4 v[112:115], v1, s[12:15], s42 offen offset:2048 sc1
  v_mfma_f32_16x16x32_bf16 v[44:47], a[84:87], a[12:15], v[44:47]
  s_waitcnt vmcnt(11) lgkmcnt(3)
  v_mfma_f32_16x16x32_bf16 v[48:51], a[36:39], a[88:91], v[48:51]
  ds_read_b128 a[16:19], v1 offset:24576
  v_mfma_f32_16x16x32_bf16 v[52:55], a[36:39], a[92:95], v[52:55]
  buffer_load_dwordx4 a[128:131], v1, s[12:15], s36 offen sc1
  v_mfma_f32_16x16x32_bf16 v[16:19], a[20:23], a[88:91], v[16:19]
  ds_read_b128 a[0:3], v1 offset:20480
  v_mfma_f32_16x16x32_bf16 v[20:23], a[20:23], a[92:95], v[20:23]
  s_waitcnt lgkmcnt(2)
  v_mfma_f32_16x16x32_bf16 v[24:27], a[24:27], a[88:91], v[24:27]
  ds_read_b128 a[4:7], v1 offset:21504
  v_mfma_f32_16x16x32_bf16 v[28:31], a[24:27], a[92:95], v[28:31]
  ds_read_b128 a[8:11], v1 offset:22528
  v_mfma_f32_16x16x32_bf16 v[32:35], a[88:91], a[28:31], v[32:35]
  buffer_load_dwordx4 a[132:135], v1, s[12:15], s37 offen sc1
  v_mfma_f32_16x16x32_bf16 v[36:39], a[92:95], a[28:31], v[36:39]
  ds_read_b128 a[12:15], v1 offset:23552
  v_mfma_f32_16x16x32_bf16 v[40:43], a[88:91], a[32:35], v[40:43]
  ds_read_b64 v[88:89], v159 offset:0
  v_mfma_f32_16x16x32_bf16 v[44:47], a[92:95], a[32:35], v[44:47]
  s_waitcnt vmcnt(11) lgkmcnt(3)
  v_mfma_f32_16x16x32_bf16 v[48:51], a[16:19], a[96:99], v[48:51]
  ds_read_b128 a[36:39], v1 offset:29696
  v_mfma_f32_16x16x32_bf16 v[52:55], a[16:19], a[100:103], v[52:55]
  buffer_load_dwordx4 a[136:139], v1, s[12:15], s36 offen offset:1024 sc1
  v_mfma_f32_16x16x32_bf16 v[16:19], a[0:3], a[96:99], v[16:19]
  ds_read_b128 a[20:23], v1 offset:25600
  v_mfma_f32_16x16x32_bf16 v[20:23], a[0:3], a[100:103], v[20:23]
  s_waitcnt lgkmcnt(2)
  v_mfma_f32_16x16x32_bf16 v[24:27], a[4:7], a[96:99], v[24:27]
  ds_read_b128 a[24:27], v1 offset:26624
  v_mfma_f32_16x16x32_bf16 v[28:31], a[4:7], a[100:103], v[28:31]
  ds_read_b128 a[28:31], v1 offset:27648
  v_mfma_f32_16x16x32_bf16 v[32:35], a[96:99], a[8:11], v[32:35]
  buffer_load_dwordx4 a[140:143], v1, s[12:15], s37 offen offset:1024 sc1
  v_mfma_f32_16x16x32_bf16 v[36:39], a[100:103], a[8:11], v[36:39]
  ds_read_b128 a[32:35], v1 offset:28672
  v_mfma_f32_16x16x32_bf16 v[40:43], a[96:99], a[12:15], v[40:43]
  ds_read_b64 v[90:91], v159 offset:128
  v_mfma_f32_16x16x32_bf16 v[44:47], a[100:103], a[12:15], v[44:47]
  s_waitcnt vmcnt(11) lgkmcnt(3)
  v_mfma_f32_16x16x32_bf16 v[48:51], a[36:39], a[104:107], v[48:51]
  ds_read_b128 a[16:19], v1 offset:34816
  v_mfma_f32_16x16x32_bf16 v[52:55], a[36:39], a[108:111], v[52:55]
  buffer_load_dwordx4 a[144:147], v1, s[12:15], s36 offen offset:2048 sc1
  v_mfma_f32_16x16x32_bf16 v[16:19], a[20:23], a[104:107], v[16:19]
  ds_read_b128 a[0:3], v1 offset:30720
  v_mfma_f32_16x16x32_bf16 v[20:23], a[20:23], a[108:111], v[20:23]
  s_waitcnt lgkmcnt(2)
  v_mfma_f32_16x16x32_bf16 v[24:27], a[24:27], a[104:107], v[24:27]
  ds_read_b128 a[4:7], v1 offset:31744
  v_mfma_f32_16x16x32_bf16 v[28:31], a[24:27], a[108:111], v[28:31]
  ds_read_b128 a[8:11], v1 offset:32768
  v_mfma_f32_16x16x32_bf16 v[32:35], a[104:107], a[28:31], v[32:35]
  buffer_load_dwordx4 a[148:151], v1, s[12:15], s37 offen offset:2048 sc1
  v_mfma_f32_16x16x32_bf16 v[36:39], a[108:111], a[28:31], v[36:39]
  ds_read_b128 a[12:15], v1 offset:33792
  v_mfma_f32_16x16x32_bf16 v[40:43], a[104:107], a[32:35], v[40:43]
  ds_read_b64 v[92:93], v159 offset:256
  v_mfma_f32_16x16x32_bf16 v[44:47], a[108:111], a[32:35], v[44:47]
  s_waitcnt vmcnt(10) lgkmcnt(3)
  v_mfma_f32_16x16x32_bf16 v[48:51], a[16:19], a[112:115], v[48:51]
  ds_read_b128 a[36:39], v1 offset:39936
  v_mfma_f32_16x16x32_bf16 v[52:55], a[16:19], a[116:119], v[52:55]
  buffer_load_dwordx4 a[152:155], v1, s[12:15], s36 offen offset:3072 sc1
  v_mfma_f32_16x16x32_bf16 v[16:19], a[0:3], a[112:115], v[16:19]
  ds_read_b128 a[20:23], v1 offset:35840
  s_add_u32 s36, s36, 4096
  v_mfma_f32_16x16x32_bf16 v[20:23], a[0:3], a[116:119], v[20:23]
  s_waitcnt lgkmcnt(2)
  v_mfma_f32_16x16x32_bf16 v[24:27], a[4:7], a[112:115], v[24:27]
  ds_read_b128 a[24:27], v1 offset:36864
  v_mfma_f32_16x16x32_bf16 v[28:31], a[4:7], a[116:119], v[28:31]
  ds_read_b128 a[28:31], v1 offset:37888
  v_mfma_f32_16x16x32_bf16 v[32:35], a[112:115], a[8:11], v[32:35]
  buffer_load_dwordx4 a[156:159], v1, s[12:15], s37 offen offset:3072 sc1
  v_mfma_f32_16x16x32_bf16 v[36:39], a[116:119], a[8:11], v[36:39]
  ds_read_b128 a[32:35], v1 offset:38912
  s_add_u32 s37, s37, 4096
  v_mfma_f32_16x16x32_bf16 v[40:43], a[112:115], a[12:15], v[40:43]
  ds_read_b64 v[94:95], v159 offset:384
  v_mfma_f32_16x16x32_bf16 v[44:47], a[116:119], a[12:15], v[44:47]
  s_waitcnt vmcnt(9) lgkmcnt(3)
  v_mfma_f32_16x16x32_bf16 v[48:51], a[36:39], a[120:123], v[48:51]
  ds_read_b128 a[16:19], v1 offset:45056
  v_mfma_f32_16x16x32_bf16 v[52:55], a[36:39], a[124:127], v[52:55]
  buffer_load_dwordx4 a[160:163], v1, s[12:15], s36 offen sc1
  v_mfma_f32_16x16x32_bf16 v[16:19], a[20:23], a[120:123], v[16:19]
  ds_read_b128 a[0:3], v1 offset:40960
  v_mfma_f32_16x16x32_bf16 v[20:23], a[20:23], a[124:127], v[20:23]
  s_waitcnt lgkmcnt(2)
  v_mfma_f32_16x16x32_bf16 v[24:27], a[24:27], a[120:123], v[24:27]
  ds_read_b128 a[4:7], v1 offset:41984
  v_mfma_f32_16x16x32_bf16 v[28:31], a[24:27], a[124:127], v[28:31]
  ds_read_b128 a[8:11], v1 offset:43008
  v_mfma_f32_16x16x32_bf16 v[32:35], a[120:123], a[28:31], v[32:35]
  buffer_load_dwordx4 a[164:167], v1, s[12:15], s37 offen sc1
  v_mfma_f32_16x16x32_bf16 v[36:39], a[124:127], a[28:31], v[36:39]
  ds_read_b128 a[12:15], v1 offset:44032
  v_mfma_f32_16x16x32_bf16 v[40:43], a[120:123], a[32:35], v[40:43]
  v_mfma_f32_16x16x32_bf16 v[44:47], a[124:127], a[32:35], v[44:47]
  s_waitcnt vmcnt(8) lgkmcnt(3)
  v_mfma_f32_16x16x32_bf16 v[48:51], a[16:19], a[128:131], v[48:51]
  ds_read_b128 a[36:39], v1 offset:50176
  v_add_f32 v104, v104, v108
  v_mfma_f32_16x16x32_bf16 v[52:55], a[16:19], a[132:135], v[52:55]
  buffer_load_dwordx4 a[168:171], v1, s[12:15], s36 offen offset:1024 sc1
  v_mfma_f32_16x16x32_bf16 v[16:19], a[0:3], a[128:131], v[16:19]
  ds_read_b128 a[20:23], v1 offset:46080
  v_add_f32 v105, v105, v109
  v_mfma_f32_16x16x32_bf16 v[20:23], a[0:3], a[132:135], v[20:23]
  s_waitcnt lgkmcnt(2)
  v_add_f32 v106, v106, v110
  v_add_f32 v107, v107, v111
  v_mfma_f32_16x16x32_bf16 v[24:27], a[4:7], a[128:131], v[24:27]
  ds_read_b128 a[24:27], v1 offset:47104
  v_add_f32 v104, v104, v112
  v_mfma_f32_16x16x32_bf16 v[28:31], a[4:7], a[132:135], v[28:31]
  ds_read_b128 a[28:31], v1 offset:48128
  v_add_f32 v105, v105, v113
  v_mfma_f32_16x16x32_bf16 v[32:35], a[128:131], a[8:11], v[32:35]
  buffer_load_dwordx4 a[172:175], v1, s[12:15], s37 offen offset:1024 sc1
  v_mfma_f32_16x16x32_bf16 v[36:39], a[132:135], a[8:11], v[36:39]
  ds_read_b128 a[32:35], v1 offset:49152
  v_add_f32 v106, v106, v114
  v_mfma_f32_16x16x32_bf16 v[40:43], a[128:131], a[12:15], v[40:43]
  v_add_f32 v107, v107, v115
  v_mfma_f32_16x16x32_bf16 v[44:47], a[132:135], a[12:15], v[44:47]
  s_waitcnt vmcnt(8) lgkmcnt(3)
  v_mfma_f32_16x16x32_bf16 v[48:51], a[36:39], a[136:139], v[48:51]
  ds_read_b128 a[16:19], v1 offset:55296
  v_permlane32_swap_b32 v104, v105
  v_mfma_f32_16x16x32_bf16 v[52:55], a[36:39], a[140:143], v[52:55]
  buffer_load_dwordx4 a[176:179], v1, s[12:15], s36 offen offset:2048 sc1
  v_mfma_f32_16x16x32_bf16 v[16:19], a[20:23], a[136:139], v[16:19]
  ds_read_b128 a[0:3], v1 offset:51200
  v_permlane32_swap_b32 v106, v107
  v_mfma_f32_16x16x32_bf16 v[20:23], a[20:23], a[140:143], v[20:23]
  s_waitcnt lgkmcnt(2)
  v_add_f32 v104, v104, v105
  v_add_f32 v106, v106, v107
  v_mfma_f32_16x16x32_bf16 v[24:27], a[24:27], a[136:139], v[24:27]
  ds_read_b128 a[4:7], v1 offset:52224
  v_mfma_f32_16x16x32_bf16 v[28:31], a[24:27], a[140:143], v[28:31]
  ds_read_b128 a[8:11], v1 offset:53248
  v_permlane16_swap_b32 v104, v106
  v_mfma_f32_16x16x32_bf16 v[32:35], a[136:139], a[28:31], v[32:35]
  buffer_load_dwordx4 a[180:183], v1, s[12:15], s37 offen offset:2048 sc1
  v_mfma_f32_16x16x32_bf16 v[36:39], a[140:143], a[28:31], v[36:39]
  ds_read_b128 a[12:15], v1 offset:54272
  v_add_f32 v104, v104, v106
  v_mfma_f32_16x16x32_bf16 v[40:43], a[136:139], a[32:35], v[40:43]
  v_mul_f32 v104, 0x3ae38e39, v104
  v_mov_b32 v105, v104
  v_mfma_f32_16x16x32_bf16 v[44:47], a[140:143], a[32:35], v[44:47]
  s_waitcnt vmcnt(8) lgkmcnt(3)
  v_mfma_f32_16x16x32_bf16 v[48:51], a[16:19], a[144:147], v[48:51]
  ds_read_b128 a[36:39], v1 offset:60416
  v_permlane32_swap_b32 v104, v105
  v_mfma_f32_16x16x32_bf16 v[52:55], a[16:19], a[148:151], v[52:55]
  buffer_load_dwordx4 a[184:187], v1, s[12:15], s36 offen offset:3072 sc1
  v_mfma_f32_16x16x32_bf16 v[16:19], a[0:3], a[144:147], v[16:19]
  ds_read_b128 a[20:23], v1 offset:56320
  s_add_u32 s36, s36, 4096
  v_mfma_f32_16x16x32_bf16 v[20:23], a[0:3], a[148:151], v[20:23]
  s_waitcnt lgkmcnt(2)
  v_sub_f32 v106, 0, v104
  v_sub_f32 v107, 0, v104
  v_mfma_f32_16x16x32_bf16 v[24:27], a[4:7], a[144:147], v[24:27]
  ds_read_b128 a[24:27], v1 offset:57344
  v_fma_f32 v104, -v104, v104, v105
  v_mfma_f32_16x16x32_bf16 v[28:31], a[4:7], a[148:151], v[28:31]
  ds_read_b128 a[28:31], v1 offset:58368
  v_max_f32 v104, 0, v104
  v_mfma_f32_16x16x32_bf16 v[32:35], a[144:147], a[8:11], v[32:35]
  buffer_load_dwordx4 a[188:191], v1, s[12:15], s37 offen offset:3072 sc1
  v_mfma_f32_16x16x32_bf16 v[36:39], a[148:151], a[8:11], v[36:39]
  ds_read_b128 a[32:35], v1 offset:59392
  s_add_u32 s37, s37, 4096
  v_mfma_f32_16x16x32_bf16 v[40:43], a[144:147], a[12:15], v[40:43]
  v_permlane16_swap_b32 v106, v107
  v_add_f32 v104, 0x3727c5ac, v104
  v_mfma_f32_16x16x32_bf16 v[44:47], a[148:151], a[12:15], v[44:47]
  s_waitcnt vmcnt(8) lgkmcnt(3)
  v_mov_b32 v105, v104
  v_and_b32 v108, 0xffff0000, v106
  v_mfma_f32_16x16x32_bf16 v[48:51], a[36:39], a[152:155], v[48:51]
  ds_read_b128 a[16:19], v5 offset:0
  v_sub_f32 v106, v106, v108
  v_mfma_f32_16x16x32_bf16 v[52:55], a[36:39], a[156:159], v[52:55]
  buffer_load_dwordx4 a[192:195], v1, s[12:15], s36 offen sc1
  v_mfma_f32_16x16x32_bf16 v[16:19], a[20:23], a[152:155], v[16:19]
  ds_read_b128 a[0:3], v1 offset:61440
  v_cndmask_b32 v106, 0, v106, s[56:57]
  v_mfma_f32_16x16x32_bf16 v[20:23], a[20:23], a[156:159], v[20:23]
  s_waitcnt lgkmcnt(2)
  v_cndmask_b32 v106, v106, v108, s[54:55]
  v_perm_b32 v80, v106, v106, s58
  v_mfma_f32_16x16x32_bf16 v[24:27], a[24:27], a[152:155], v[24:27]
  ds_read_b128 a[4:7], v1 offset:62464
  v_mov_b32 v83, v80
  v_mfma_f32_16x16x32_bf16 v[28:31], a[24:27], a[156:159], v[28:31]
  ds_read_b128 a[8:11], v1 offset:63488
  v_and_b32 v109, 0xffff0000, v107
  v_mfma_f32_16x16x32_bf16 v[32:35], a[152:155], a[28:31], v[32:35]
  buffer_load_dwordx4 a[196:199], v1, s[12:15], s37 offen sc1
  v_mfma_f32_16x16x32_bf16 v[36:39], a[156:159], a[28:31], v[36:39]
  ds_read_b128 a[12:15], v1 offset:64512
  v_sub_f32 v107, v107, v109
  v_mfma_f32_16x16x32_bf16 v[40:43], a[152:155], a[32:35], v[40:43]
  v_cndmask_b32 v107, 0, v107, s[56:57]
  v_cndmask_b32 v107, v107, v109, s[54:55]
  v_mfma_f32_16x16x32_bf16 v[44:47], a[156:159], a[32:35], v[44:47]
  s_waitcnt vmcnt(8) lgkmcnt(3)
  v_perm_b32 v84, v107, v107, s58
  v_mov_b32 v87, v84
  v_mfma_f32_16x16x32_bf16 v[48:51], a[16:19], a[160:163], v[48:51]
  ds_read_b128 a[36:39], v5 offset:5120
  v_permlane16_swap_b32 v104, v105
  v_mfma_f32_16x16x32_bf16 v[52:55], a[16:19], a[164:167], v[52:55]
  buffer_load_dwordx4 a[200:203], v1, s[12:15], s36 offen offset:1024 sc1
  v_mfma_f32_16x16x32_bf16 v[16:19], a[0:3], a[160:163], v[16:19]
  ds_read_b128 a[20:23], v5 offset:1024
  v_mfma_f32_16x16x32_bf16 v[20:23], a[0:3], a[164:167], v[20:23]
  s_waitcnt lgkmcnt(2)
  v_rsq_f32 v8, v104
  v_mfma_f32_16x16x32_bf16 v[24:27], a[4:7], a[160:163], v[24:27]
  ds_read_b128 a[24:27], v5 offset:2048
  v_mfma_f32_16x16x32_bf16 v[28:31], a[4:7], a[164:167], v[28:31]
  ds_read_b128 a[28:31], v5 offset:3072
  v_mfma_f32_16x16x32_bf16 v[32:35], a[160:163], a[8:11], v[32:35]
  buffer_load_dwordx4 a[204:207], v1, s[12:15], s37 offen offset:1024 sc1
  v_mfma_f32_16x16x32_bf16 v[36:39], a[164:167], a[8:11], v[36:39]
  ds_read_b128 a[32:35], v5 offset:4096
  v_mfma_f32_16x16x32_bf16 v[40:43], a[160:163], a[12:15], v[40:43]
  v_rsq_f32 v9, v105
  v_mfma_f32_16x16x32_bf16 v[44:47], a[164:167], a[12:15], v[44:47]
  s_waitcnt vmcnt(8) lgkmcnt(3)
  v_mul_f32 v12, 0x3eae1a93, v8
  v_mul_f32 v13, 0x3eae1a93, v9
  v_mfma_f32_16x16x32_bf16 v[48:51], a[36:39], a[168:171], v[48:51]
  ds_read_b128 a[16:19], v5 offset:10240
  v_cndmask_b32 v14, v8, v12, s[48:49]
  v_mfma_f32_16x16x32_bf16 v[52:55], a[36:39], a[172:175], v[52:55]
  v_cndmask_b32 v15, v9, v13, s[48:49]
  v_mfma_f32_16x16x32_bf16 v[16:19], a[20:23], a[168:171], v[16:19]
  ds_read_b128 a[0:3], v5 offset:6144
  v_mfma_f32_16x16x32_bf16 v[20:23], a[20:23], a[172:175], v[20:23]
  s_waitcnt lgkmcnt(2)
  v_mfma_f32_16x16x32_bf16 v[24:27], a[24:27], a[168:171], v[24:27]
  ds_read_b128 a[4:7], v5 offset:7168
  v_mfma_f32_16x16x32_bf16 v[28:31], a[24:27], a[172:175], v[28:31]
  ds_read_b128 a[8:11], v5 offset:8192
  v_mfma_f32_16x16x32_bf16 v[32:35], a[168:171], a[28:31], v[32:35]
  v_mfma_f32_16x16x32_bf16 v[36:39], a[172:175], a[28:31], v[36:39]
  ds_read_b128 a[12:15], v5 offset:9216
  v_mfma_f32_16x16x32_bf16 v[40:43], a[168:171], a[32:35], v[40:43]
  v_mfma_f32_16x16x32_bf16 v[44:47], a[172:175], a[32:35], v[44:47]
  s_waitcnt vmcnt(6) lgkmcnt(3)
  v_mfma_f32_16x16x32_bf16 v[48:51], a[16:19], a[176:179], v[48:51]
  ds_read_b128 a[36:39], v5 offset:15360
  v_mfma_f32_16x16x32_bf16 v[52:55], a[16:19], a[180:183], v[52:55]
  v_mfma_f32_16x16x32_bf16 v[16:19], a[0:3], a[176:179], v[16:19]
  ds_read_b128 a[20:23], v5 offset:11264
  v_mfma_f32_16x16x32_bf16 v[20:23], a[0:3], a[180:183], v[20:23]
  s_waitcnt lgkmcnt(2)
  v_mfma_f32_16x16x32_bf16 v[24:27], a[4:7], a[176:179], v[24:27]
  ds_read_b128 a[24:27], v5 offset:12288
  v_mfma_f32_16x16x32_bf16 v[28:31], a[4:7], a[180:183], v[28:31]
  ds_read_b128 a[28:31], v5 offset:13312
  v_mfma_f32_16x16x32_bf16 v[32:35], a[176:179], a[8:11], v[32:35]
  v_mfma_f32_16x16x32_bf16 v[36:39], a[180:183], a[8:11], v[36:39]
  ds_read_b128 a[32:35], v5 offset:14336
  v_mfma_f32_16x16x32_bf16 v[40:43], a[176:179], a[12:15], v[40:43]
  v_mfma_f32_16x16x32_bf16 v[44:47], a[180:183], a[12:15], v[44:47]
  s_waitcnt vmcnt(4) lgkmcnt(3)
  v_mfma_f32_16x16x16_bf16 v[48:51], v[92:93], v[80:81], v[48:51]
  v_mfma_f32_16x16x16_bf16 v[52:55], v[92:93], v[84:85], v[52:55]
  v_mfma_f32_16x16x16_bf16 v[16:19], v[88:89], v[80:81], v[16:19]
  v_mfma_f32_16x16x16_bf16 v[20:23], v[88:89], v[84:85], v[20:23]
  v_mfma_f32_16x16x16_bf16 v[24:27], v[88:89], v[82:83], v[24:27]
  v_mfma_f32_16x16x16_bf16 v[28:31], v[88:89], v[86:87], v[28:31]
  v_mfma_f32_16x16x16_bf16 v[32:35], v[80:81], v[90:91], v[32:35]
  v_mfma_f32_16x16x16_bf16 v[36:39], v[84:85], v[90:91], v[36:39]
  v_mfma_f32_16x16x16_bf16 v[40:43], v[82:83], v[90:91], v[40:43]
  v_mfma_f32_16x16x16_bf16 v[44:47], v[86:87], v[90:91], v[44:47]
  v_mfma_f32_16x16x32_bf16 v[48:51], a[36:39], a[184:187], v[48:51]
  ds_read_b128 a[16:19], v5 offset:20480
  v_mfma_f32_16x16x32_bf16 v[52:55], a[36:39], a[188:191], v[52:55]
  v_mfma_f32_16x16x32_bf16 v[16:19], a[20:23], a[184:187], v[16:19]
  ds_read_b128 a[0:3], v5 offset:16384
  v_mfma_f32_16x16x32_bf16 v[20:23], a[20:23], a[188:191], v[20:23]
  s_waitcnt lgkmcnt(2)
  v_mfma_f32_16x16x32_bf16 v[24:27], a[24:27], a[184:187], v[24:27]
  ds_read_b128 a[4:7], v5 offset:17408
  v_mfma_f32_16x16x32_bf16 v[28:31], a[24:27], a[188:191], v[28:31]
  ds_read_b128 a[8:11], v5 offset:18432
  v_mfma_f32_16x16x32_bf16 v[32:35], a[184:187], a[28:31], v[32:35]
  v_mfma_f32_16x16x32_bf16 v[36:39], a[188:191], a[28:31], v[36:39]
  ds_read_b128 a[12:15], v5 offset:19456
  v_mfma_f32_16x16x32_bf16 v[40:43], a[184:187], a[32:35], v[40:43]
  v_mfma_f32_16x16x32_bf16 v[44:47], a[188:191], a[32:35], v[44:47]
  s_waitcnt vmcnt(2) lgkmcnt(3)
  v_mfma_f32_16x16x32_bf16 v[48:51], a[16:19], a[192:195], v[48:51]
  ds_read_b128 a[36:39], v5 offset:25600
  v_mfma_f32_16x16x32_bf16 v[52:55], a[16:19], a[196:199], v[52:55]
  v_mfma_f32_16x16x32_bf16 v[16:19], a[0:3], a[192:195], v[16:19]
  ds_read_b128 a[20:23], v5 offset:21504
  v_mfma_f32_16x16x32_bf16 v[20:23], a[0:3], a[196:199], v[20:23]
  s_waitcnt lgkmcnt(2)
  v_mfma_f32_16x16x32_bf16 v[24:27], a[4:7], a[192:195], v[24:27]
  ds_read_b128 a[24:27], v5 offset:22528
  v_mfma_f32_16x16x32_bf16 v[28:31], a[4:7], a[196:199], v[28:31]
  ds_read_b128 a[28:31], v5 offset:23552
  v_mfma_f32_16x16x32_bf16 v[32:35], a[192:195], a[8:11], v[32:35]
  v_mfma_f32_16x16x32_bf16 v[36:39], a[196:199], a[8:11], v[36:39]
  ds_read_b128 a[32:35], v5 offset:24576
  v_mfma_f32_16x16x32_bf16 v[40:43], a[192:195], a[12:15], v[40:43]
  v_mfma_f32_16x16x32_bf16 v[44:47], a[196:199], a[12:15], v[44:47]
  s_waitcnt vmcnt(0) lgkmcnt(3)
  v_mfma_f32_16x16x32_bf16 v[48:51], a[36:39], a[200:203], v[48:51]
  ds_bpermute_b32 v96, v6, v8 offset:0
  v_mfma_f32_16x16x32_bf16 v[52:55], a[36:39], a[204:207], v[52:55]
  ds_bpermute_b32 v97, v6, v8 offset:4
  v_mfma_f32_16x16x32_bf16 v[16:19], a[20:23], a[200:203], v[16:19]
  ds_bpermute_b32 v98, v6, v8 offset:8
  v_mfma_f32_16x16x32_bf16 v[20:23], a[20:23], a[204:207], v[20:23]
  s_waitcnt lgkmcnt(3)
  v_mfma_f32_16x16x32_bf16 v[24:27], a[24:27], a[200:203], v[24:27]
  ds_bpermute_b32 v99, v6, v8 offset:12
  v_mfma_f32_16x16x32_bf16 v[28:31], a[24:27], a[204:207], v[28:31]
  ds_bpermute_b32 v100, v6, v9 offset:0
  v_mfma_f32_16x16x32_bf16 v[32:35], a[200:203], a[28:31], v[32:35]
  ds_bpermute_b32 v101, v6, v9 offset:4
  v_mfma_f32_16x16x32_bf16 v[36:39], a[204:207], a[28:31], v[36:39]
  ds_bpermute_b32 v102, v6, v9 offset:8
  v_mfma_f32_16x16x32_bf16 v[40:43], a[200:203], a[32:35], v[40:43]
  ds_bpermute_b32 v103, v6, v9 offset:12
  v_mfma_f32_16x16x32_bf16 v[44:47], a[204:207], a[32:35], v[44:47]
q_kv:
  v_pk_mul_f32 v[48:49], v[14:15], v[48:49] op_sel_hi:[0,1]
  v_pk_mul_f32 v[50:51], v[14:15], v[50:51] op_sel_hi:[0,1]
  v_pk_mul_f32 v[52:53], v[14:15], v[52:53] op_sel:[1,0] op_sel_hi:[1,1]
  v_pk_mul_f32 v[54:55], v[14:15], v[54:55] op_sel:[1,0] op_sel_hi:[1,1]
  v_cvt_pk_bf16_f32 v104, v48, v49
  v_cvt_pk_bf16_f32 v105, v50, v51
  v_cvt_pk_bf16_f32 v106, v52, v53
  v_cvt_pk_bf16_f32 v107, v54, v55
  ds_write_b32 v148, v7 offset:256
  s_mov_b64 exec, 0xffffffff
  ds_write_b32 v144, v104 offset:0
  ds_write_b32 v145, v105 offset:0
  ds_write_b32 v144, v106 offset:64
  ds_write_b32 v145, v107 offset:64
  s_mov_b32 exec_lo, 0
  s_mov_b32 exec_hi, 0xffff
  s_waitcnt lgkmcnt(5)
  ds_write_b16 v143, v104 offset:0
  ds_write_b16_d16_hi v143, v104 offset:16
  ds_write_b16 v143, v105 offset:384
  ds_write_b16_d16_hi v143, v105 offset:400
  ds_write_b16 v143, v106 offset:8
  ds_write_b16_d16_hi v143, v106 offset:24
  ds_write_b16 v143, v107 offset:392
  ds_write_b16_d16_hi v143, v107 offset:408
  s_mov_b64 exec, -1
  ds_read_b128 v[136:139], v149
  v_pk_mul_f32 v[16:17], v[8:9], v[16:17] op_sel_hi:[0,1]
  v_pk_mul_f32 v[18:19], v[8:9], v[18:19] op_sel_hi:[0,1]
  v_pk_mul_f32 v[24:25], v[8:9], v[24:25] op_sel_hi:[0,1]
  v_pk_mul_f32 v[26:27], v[8:9], v[26:27] op_sel_hi:[0,1]
  v_cvt_pk_bf16_f32 v108, v16, v17
  v_cvt_pk_bf16_f32 v109, v18, v19
  v_cvt_pk_bf16_f32 v110, v24, v25
  v_cvt_pk_bf16_f32 v111, v26, v27
  buffer_store_dwordx4 v[108:111], v141, s[12:15], s43 offen offset:0 sc1
  v_pk_mul_f32 v[20:21], v[8:9], v[20:21] op_sel:[1,0] op_sel_hi:[1,1]
  v_pk_mul_f32 v[22:23], v[8:9], v[22:23] op_sel:[1,0] op_sel_hi:[1,1]
  v_pk_mul_f32 v[28:29], v[8:9], v[28:29] op_sel:[1,0] op_sel_hi:[1,1]
  v_pk_mul_f32 v[30:31], v[8:9], v[30:31] op_sel:[1,0] op_sel_hi:[1,1]
  v_cvt_pk_bf16_f32 v112, v20, v21
  v_cvt_pk_bf16_f32 v113, v22, v23
  v_cvt_pk_bf16_f32 v114, v28, v29
  v_cvt_pk_bf16_f32 v115, v30, v31
  buffer_store_dwordx4 v[112:115], v141, s[12:15], s43 offen offset:256 sc1
  v_pk_mul_f32 v[32:33], v[96:97], v[32:33]
  v_pk_mul_f32 v[34:35], v[98:99], v[34:35]
  v_pk_mul_f32 v[36:37], v[100:101], v[36:37]
  v_pk_mul_f32 v[38:39], v[102:103], v[38:39]
  v_cvt_pk_bf16_f32 v116, v32, v33
  v_cvt_pk_bf16_f32 v117, v34, v35
  v_cvt_pk_bf16_f32 v118, v36, v37
  v_cvt_pk_bf16_f32 v119, v38, v39
  buffer_store_dwordx4 v[116:119], v1, s[12:15], s43 offen offset:1024 sc1
  v_pk_mul_f32 v[40:41], v[96:97], v[40:41]
  v_pk_mul_f32 v[42:43], v[98:99], v[42:43]
  v_pk_mul_f32 v[44:45], v[100:101], v[44:45]
  v_pk_mul_f32 v[46:47], v[102:103], v[46:47]
  v_cvt_pk_bf16_f32 v120, v40, v41
  v_cvt_pk_bf16_f32 v121, v42, v43
  v_cvt_pk_bf16_f32 v122, v44, v45
  v_cvt_pk_bf16_f32 v123, v46, v47
  buffer_store_dwordx4 v[120:123], v1, s[12:15], s43 offen offset:3456 sc1
  s_waitcnt lgkmcnt(0)
  buffer_store_dwordx4 v[136:139], v150, s[12:15], s43 offen offset:2048 sc1
  s_waitcnt vmcnt(5)
  s_barrier
  ds_read_b128 a[208:211], v5 offset:26624
  ds_read_b128 a[212:215], v5 offset:27648
  ds_read_b128 a[216:219], v5 offset:28672
  ds_read_b128 a[220:223], v5 offset:29696
  ds_read_b128 a[224:227], v5 offset:30720
  ds_read_b128 a[228:231], v5 offset:31744
  ds_read_b128 a[232:235], v5 offset:32768
  ds_read_b128 a[236:239], v5 offset:33792
  ds_write_b128 v140, v[108:111] offset:9216
  ds_write_b128 v140, v[112:115] offset:9472
  v_mfma_f32_16x16x16_bf16 v[56:59], v[92:93], v[82:83], 0
  v_mfma_f32_16x16x16_bf16 v[60:63], v[92:93], v[86:87], 0
  v_mfma_f32_16x16x16_bf16 v[64:67], v[94:95], v[80:81], 0
  v_mfma_f32_16x16x16_bf16 v[68:71], v[94:95], v[84:85], 0
  s_and_b32 s38, s25, 3
  s_mul_i32 s38, s38, 167936
  s_mul_i32 s39, s33, 12288
  s_add_u32 s38, s38, s39
  s_add_u32 s38, s38, 81526784
  s_cmp_eq_u32 s33, 3
  s_cselect_b32 s53, 1073741824, s38
  v_mov_b32 v151, 1073741824
  v_cmp_eq_u32 vcc, 0, v0
  s_lshl_b32 s48, s25, 13
  s_add_u32 s48, s48, s27
  s_add_u32 s48, s48, 65792
  v_cndmask_b32 v151, v151, v2, vcc
  s_waitcnt lgkmcnt(6)
  v_mfma_f32_16x16x32_bf16 v[56:59], a[208:211], a[64:67], v[56:59]
  ds_read_b128 a[240:243], v5 offset:34816
  v_and_b32 v152, 31, v0
  v_mfma_f32_16x16x32_bf16 v[60:63], a[208:211], a[68:71], v[60:63]
  buffer_load_dwordx4 a[0:3], v1, s[12:15], s53 offen sc1
  v_mfma_f32_16x16x32_bf16 v[64:67], a[212:215], a[64:67], v[64:67]
  ds_read_b128 a[244:247], v5 offset:35840
  v_bfe_u32 v153, v0, 5, 1
  v_mfma_f32_16x16x32_bf16 v[68:71], a[212:215], a[68:71], v[68:71]
  s_lshr_b32 s37, s33, 1
  v_lshlrev_b32 v8, 8, v153
  v_lshl_add_u32 v8, v152, 4, v8
  v_mfma_f32_16x16x32_bf16 v[56:59], a[216:219], a[72:75], v[56:59]
  ds_read_b128 a[248:251], v5 offset:36864
  v_add_u32 v8, 1024, v8
  v_mfma_f32_16x16x32_bf16 v[60:63], a[216:219], a[76:79], v[60:63]
  s_lshl_b32 s34, s25, 1
  v_lshlrev_b32 v9, 5, v153
  v_lshl_add_u32 v9, v152, 4, v9
  v_mfma_f32_16x16x32_bf16 v[64:67], a[220:223], a[72:75], v[64:67]
  ds_read_b128 a[252:255], v5 offset:37888
  v_add_u32 v9, 1792, v9
  v_mfma_f32_16x16x32_bf16 v[68:71], a[220:223], a[76:79], v[68:71]
  s_waitcnt lgkmcnt(4)
  v_and_b32 v14, 27, v152
  v_cmp_eq_u32 vcc, 18, v14
  v_mfma_f32_16x16x32_bf16 v[56:59], a[224:227], a[80:83], v[56:59]
  ds_read_b128 a[208:211], v5 offset:38912
  v_cmp_gt_u32 s[60:61], 18, v152
  v_mfma_f32_16x16x32_bf16 v[60:63], a[224:227], a[84:87], v[60:63]
  buffer_load_dwordx4 a[4:7], v1, s[12:15], s53 offen offset:1024 sc1
  v_mfma_f32_16x16x32_bf16 v[64:67], a[228:231], a[80:83], v[64:67]
  ds_read_b128 a[212:215], v5 offset:39936
  v_cmp_gt_u32 s[44:45], 16, v152
  v_mfma_f32_16x16x32_bf16 v[68:71], a[228:231], a[84:87], v[68:71]
  s_add_u32 s34, s34, s37
  v_cmp_eq_u32 s[50:51], 0, v153
  v_mov_b32 v155, 1073741824
  v_mfma_f32_16x16x32_bf16 v[56:59], a[232:235], a[88:91], v[56:59]
  ds_read_b128 a[216:219], v5 offset:40960
  v_mov_b32 v156, 2304
  v_mfma_f32_16x16x32_bf16 v[60:63], a[232:235], a[92:95], v[60:63]
  s_and_b32 s35, s33, 1
  v_cndmask_b32 v156, v155, v156, vcc
  v_cndmask_b32 v14, v156, v9, s[60:61]
  v_mfma_f32_16x16x32_bf16 v[64:67], a[236:239], a[88:91], v[64:67]
  ds_read_b128 a[220:223], v5 offset:41984
  v_cndmask_b32 v229, v14, v8, s[44:45]
  v_mfma_f32_16x16x32_bf16 v[68:71], a[236:239], a[92:95], v[68:71]
  s_waitcnt lgkmcnt(4)
  v_add_u32 v8, 512, v8
  v_add_u32 v9, 64, v9
  v_mfma_f32_16x16x32_bf16 v[56:59], a[240:243], a[96:99], v[56:59]
  ds_read_b128 a[224:227], v5 offset:43008
  v_cndmask_b32 v14, v156, v9, s[60:61]
  v_mfma_f32_16x16x32_bf16 v[60:63], a[240:243], a[100:103], v[60:63]
  buffer_load_dwordx4 a[8:11], v1, s[12:15], s53 offen offset:2048 sc1
  v_mfma_f32_16x16x32_bf16 v[64:67], a[244:247], a[96:99], v[64:67]
  ds_read_b128 a[228:231], v5 offset:44032
  v_cndmask_b32 v230, v14, v8, s[44:45]
  v_mfma_f32_16x16x32_bf16 v[68:71], a[244:247], a[100:103], v[68:71]
  s_lshl_b32 s42, s24, 1
  v_bfe_u32 v8, v152, 2, 1
  v_lshrrev_b32 v9, 3, v152
  v_mfma_f32_16x16x32_bf16 v[56:59], a[248:251], a[104:107], v[56:59]
  ds_read_b128 a[232:235], v5 offset:45056
  v_lshlrev_b32 v9, 2, v9
  v_mfma_f32_16x16x32_bf16 v[60:63], a[248:251], a[108:111], v[60:63]
  buffer_load_dwordx4 a[12:15], v1, s[12:15], s53 offen offset:3072 sc1
  v_mfma_f32_16x16x32_bf16 v[64:67], a[252:255], a[104:107], v[64:67]
  ds_read_b128 a[236:239], v5 offset:46080
  v_lshl_add_u32 v8, v8, 4, v9
  v_mfma_f32_16x16x32_bf16 v[68:71], a[252:255], a[108:111], v[68:71]
  s_waitcnt lgkmcnt(4)
  v_and_b32 v9, 3, v152
  v_add_u32 v8, v8, v9
  v_mfma_f32_16x16x32_bf16 v[56:59], a[208:211], a[112:115], v[56:59]
  ds_read_b128 a[240:243], v5 offset:47104
  s_add_u32 s53, s53, 4096
  v_mfma_f32_16x16x32_bf16 v[60:63], a[208:211], a[116:119], v[60:63]
  s_add_u32 s42, s42, 1
  v_lshlrev_b32 v231, 2, v8
  v_lshlrev_b32 v8, 4, v8
  v_mfma_f32_16x16x32_bf16 v[64:67], a[212:215], a[112:115], v[64:67]
  ds_read_b128 a[244:247], v5 offset:48128
  v_lshl_add_u32 v79, v153, 9, v8
  v_mfma_f32_16x16x32_bf16 v[68:71], a[212:215], a[116:119], v[68:71]
  buffer_load_dwordx4 a[16:19], v1, s[12:15], s53 offen sc1
  v_mfma_f32_16x16x32_bf16 v[56:59], a[216:219], a[120:123], v[56:59]
  ds_read_b128 a[248:251], v5 offset:49152
  v_and_b32 v8, 35, v0
  v_mfma_f32_16x16x32_bf16 v[60:63], a[216:219], a[124:127], v[60:63]
  s_sub_u32 s42, s42, s35
  v_cmp_eq_u32 vcc, 0, v8
  v_lshlrev_b32 v154, 2, v152
  v_mfma_f32_16x16x32_bf16 v[64:67], a[220:223], a[120:123], v[64:67]
  ds_read_b128 a[252:255], v5 offset:50176
  v_lshrrev_b32 v6, 4, v152
  v_mfma_f32_16x16x32_bf16 v[68:71], a[220:223], a[124:127], v[68:71]
  s_waitcnt lgkmcnt(4)
  v_lshlrev_b32 v6, 14, v6
  v_and_b32 v8, 15, v152
  v_mfma_f32_16x16x32_bf16 v[56:59], a[224:227], a[128:131], v[56:59]
  ds_read_b128 a[208:211], v5 offset:51200
  v_lshl_add_u32 v6, v8, 4, v6
  v_mfma_f32_16x16x32_bf16 v[60:63], a[224:227], a[132:135], v[60:63]
  buffer_load_dwordx4 a[20:23], v1, s[12:15], s53 offen offset:1024 sc1
  v_mfma_f32_16x16x32_bf16 v[64:67], a[228:231], a[128:131], v[64:67]
  ds_read_b128 a[212:215], v5 offset:52224
  v_lshl_add_u32 v6, v153, 8, v6
  v_mfma_f32_16x16x32_bf16 v[68:71], a[228:231], a[132:135], v[68:71]
  s_mul_i32 s42, s42, 73728
  v_cndmask_b32 v7, v155, v154, vcc
  v_mov_b32 v228, 0xdddddddd
  v_mfma_f32_16x16x32_bf16 v[56:59], a[232:235], a[136:139], v[56:59]
  ds_read_b128 a[216:219], v5 offset:53248
  v_mov_b32 v41, 0x3f803f80
  v_mfma_f32_16x16x32_bf16 v[60:63], a[232:235], a[140:143], v[60:63]
  buffer_load_dwordx4 a[24:27], v1, s[12:15], s53 offen offset:2048 sc1
  v_mfma_f32_16x16x32_bf16 v[64:67], a[236:239], a[136:139], v[64:67]
  ds_read_b128 a[220:223], v5 offset:54272
  v_mov_b32 v43, 0x3f803f80
  v_mfma_f32_16x16x32_bf16 v[68:71], a[236:239], a[140:143], v[68:71]
  s_waitcnt lgkmcnt(4)
  v_mov_b32 v45, 0x3f803f80
  v_mov_b32 v47, 0x3f803f80
  v_mfma_f32_16x16x32_bf16 v[56:59], a[240:243], a[144:147], v[56:59]
  ds_read_b128 a[224:227], v5 offset:55296
  s_add_u32 s42, s42, s26
  v_mfma_f32_16x16x32_bf16 v[60:63], a[240:243], a[148:151], v[60:63]
  s_add_u32 s42, s42, 2359296
  s_lshl_b32 s43, s34, 9
  s_add_u32 s43, s43, s42
  v_mfma_f32_16x16x32_bf16 v[64:67], a[244:247], a[144:147], v[64:67]
  ds_read_b128 a[228:231], v5 offset:56320
  s_lshl_b32 s38, s34, 7
  v_mfma_f32_16x16x32_bf16 v[68:71], a[244:247], a[148:151], v[68:71]
  buffer_load_dwordx4 a[28:31], v1, s[12:15], s53 offen offset:3072 sc1
  v_mfma_f32_16x16x32_bf16 v[56:59], a[248:251], a[152:155], v[56:59]
  ds_read_b128 a[232:235], v5 offset:57344
  s_add_u32 s53, s53, 4096
  v_mfma_f32_16x16x32_bf16 v[60:63], a[248:251], a[156:159], v[60:63]
  s_add_u32 s42, s42, s38
  s_add_u32 s42, s42, 32768
  s_mul_i32 s46, s33, 6144
  v_mfma_f32_16x16x32_bf16 v[64:67], a[252:255], a[152:155], v[64:67]
  ds_read_b128 a[236:239], v5 offset:58368
  s_xor_b32 s47, s33, 1
  v_mfma_f32_16x16x32_bf16 v[68:71], a[252:255], a[156:159], v[68:71]
  s_waitcnt lgkmcnt(4)
  s_mul_i32 s47, s47, 6144
  s_add_u32 s46, s46, 131072
  v_mfma_f32_16x16x32_bf16 v[56:59], a[208:211], a[160:163], v[56:59]
  ds_read_b128 a[240:243], v5 offset:59392
  s_add_u32 s47, s47, 131072
  v_mfma_f32_16x16x32_bf16 v[60:63], a[208:211], a[164:167], v[60:63]
  buffer_load_dwordx4 a[32:35], v1, s[12:15], s53 offen sc1
  v_mfma_f32_16x16x32_bf16 v[64:67], a[212:215], a[160:163], v[64:67]
  ds_read_b128 a[244:247], v5 offset:60416
  s_mul_i32 s38, s37, 4608
  v_mfma_f32_16x16x32_bf16 v[68:71], a[212:215], a[164:167], v[68:71]
  s_waitcnt vmcnt(9)
  s_barrier
  s_add_u32 s38, s38, 131072
  v_mfma_f32_16x16x32_bf16 v[56:59], a[216:219], a[168:171], v[56:59]
  ds_read_b128 a[248:251], v5 offset:61440
  s_mul_i32 s39, s35, 2304
  v_mfma_f32_16x16x32_bf16 v[60:63], a[216:219], a[172:175], v[60:63]
  buffer_atomic_add v3, v151, s[12:15], s48 offen sc1
  v_mfma_f32_16x16x32_bf16 v[64:67], a[220:223], a[168:171], v[64:67]
  ds_read_b128 a[252:255], v5 offset:62464
  s_add_u32 s40, s38, s39
  v_mfma_f32_16x16x32_bf16 v[68:71], a[220:223], a[172:175], v[68:71]
  s_waitcnt lgkmcnt(4)
  s_sub_u32 s41, s38, s39
  s_mul_i32 s36, s35, 1536
  v_mfma_f32_16x16x32_bf16 v[56:59], a[224:227], a[176:179], v[56:59]
  buffer_load_dwordx4 a[36:39], v1, s[12:15], s53 offen offset:1024 sc1
  v_mfma_f32_16x16x32_bf16 v[60:63], a[224:227], a[180:183], v[60:63]
  s_mul_i32 s39, s37, 384
  s_add_u32 s36, s36, s39
  s_add_u32 s36, s36, 149632
  v_mfma_f32_16x16x32_bf16 v[64:67], a[228:231], a[176:179], v[64:67]
  s_mul_i32 s39, s37, 2432
  s_mul_i32 s38, s25, 311296
  s_add_u32 s38, s38, s39
  v_mfma_f32_16x16x32_bf16 v[68:71], a[228:231], a[180:183], v[68:71]
  s_mul_i32 s39, s35, 155648
  s_add_u32 s38, s38, s39
  s_add_u32 s38, s38, s26
  v_mfma_f32_16x16x32_bf16 v[56:59], a[232:235], a[184:187], v[56:59]
  buffer_load_dwordx4 a[40:43], v1, s[12:15], s53 offen offset:2048 sc1
  v_mfma_f32_16x16x32_bf16 v[60:63], a[232:235], a[188:191], v[60:63]
  s_add_u32 s38, s38, 35389440
  s_mov_b32 s49, 0x07060302
  s_mov_b32 s3, 0
  v_mfma_f32_16x16x32_bf16 v[64:67], a[236:239], a[184:187], v[64:67]
  s_mov_b32 s18, 153216
  s_add_u32 s16, s4, s38
  s_addc_u32 s17, s5, 0
  v_mfma_f32_16x16x32_bf16 v[68:71], a[236:239], a[188:191], v[68:71]
  s_waitcnt lgkmcnt(0)
  v_add_u32 v10, s46, v1
  v_add_u32 v11, s47, v1
  v_mfma_f32_16x16x32_bf16 v[56:59], a[240:243], a[192:195], v[56:59]
  buffer_load_dwordx4 a[44:47], v1, s[12:15], s53 offen offset:3072 sc1
  v_mfma_f32_16x16x32_bf16 v[60:63], a[240:243], a[196:199], v[60:63]
  s_add_u32 s53, s53, 4096
  v_add_u32 v8, s40, v1
  v_add_u32 v9, s41, v1
  v_mfma_f32_16x16x32_bf16 v[64:67], a[244:247], a[192:195], v[64:67]
  v_add_u32 v157, s40, v154
  v_add_u32 v158, s41, v154
  v_mfma_f32_16x16x32_bf16 v[68:71], a[244:247], a[196:199], v[68:71]
  v_add_u32 v15, s36, v154
  v_mfma_f32_16x16x32_bf16 v[56:59], a[248:251], a[200:203], v[56:59]
  v_mfma_f32_16x16x32_bf16 v[60:63], a[248:251], a[204:207], v[60:63]
  v_mfma_f32_16x16x32_bf16 v[64:67], a[252:255], a[200:203], v[64:67]
  v_mfma_f32_16x16x32_bf16 v[68:71], a[252:255], a[204:207], v[68:71]
  s_nop 4
  v_pk_mul_f32 v[56:57], v[12:13], v[56:57] op_sel_hi:[0,1]
  v_pk_mul_f32 v[58:59], v[12:13], v[58:59] op_sel_hi:[0,1]
  v_pk_mul_f32 v[64:65], v[12:13], v[64:65] op_sel_hi:[0,1]
  v_pk_mul_f32 v[66:67], v[12:13], v[66:67] op_sel_hi:[0,1]
  v_cvt_pk_bf16_f32 v124, v56, v57
  v_cvt_pk_bf16_f32 v125, v58, v59
  v_cvt_pk_bf16_f32 v126, v64, v65
  v_cvt_pk_bf16_f32 v127, v66, v67
  ds_write_b128 v140, v[124:127] offset:0
  v_pk_mul_f32 v[60:61], v[12:13], v[60:61] op_sel:[1,0] op_sel_hi:[1,1]
  v_pk_mul_f32 v[62:63], v[12:13], v[62:63] op_sel:[1,0] op_sel_hi:[1,1]
  v_pk_mul_f32 v[68:69], v[12:13], v[68:69] op_sel:[1,0] op_sel_hi:[1,1]
  v_pk_mul_f32 v[70:71], v[12:13], v[70:71] op_sel:[1,0] op_sel_hi:[1,1]
  v_cvt_pk_bf16_f32 v128, v60, v61
  v_cvt_pk_bf16_f32 v129, v62, v63
  v_cvt_pk_bf16_f32 v130, v68, v69
  v_cvt_pk_bf16_f32 v131, v70, v71
  ds_write_b128 v140, v[128:131] offset:256
  v_accvgpr_write_b32 a104, 0
  v_accvgpr_write_b32 a105, 0
  v_accvgpr_write_b32 a106, 0
  v_accvgpr_write_b32 a107, 0
  v_accvgpr_write_b32 a108, 0
  v_accvgpr_write_b32 a109, 0
  v_accvgpr_write_b32 a110, 0
  v_accvgpr_write_b32 a111, 0
  s_mov_b32 s47, 1
  s_mov_b32 s40, 16384
  s_waitcnt lgkmcnt(0)
  s_barrier
  ds_read_b128 a[64:67], v8 offset:9216
  ds_read_b32 v40, v15
  ds_read_b128 v[16:19], v8 offset:0
  ds_read_b32 v32, v157 offset:1024
  ds_read_b128 v[20:23], v8 offset:1152
  ds_read_b32 v34, v157 offset:2176
  ds_read_b128 v[24:27], v9 offset:2304
  ds_read_b32 v36, v158 offset:3328
  ds_read_b128 v[28:31], v9 offset:3456
  ds_read_b32 v38, v158 offset:4480
  s_cmp_eq_u32 s26, 0
  s_cbranch_scc1 a_jobs
  s_mov_b32 s32, 4
  s_and_b32 s38, s25, 3
  s_mul_i32 s38, s38, 167936
  s_add_u32 s38, s38, 81563648
  s_lshl_b32 s56, s33, 12
  s_add_u32 s56, s56, -16384
  s_mov_b32 m0, s56
  s_mov_b32 s57, 16384
  s_add_u32 s20, s4, s38
  s_addc_u32 s21, s5, 0
  s_mov_b32 s22, 129024
  s_mov_b32 s23, 0x20000
  v_mov_b32 v72, v1
  v_mov_b32 v73, v1
  v_mov_b32 v74, v1
  v_mov_b32 v75, v1
a_init:
  s_waitcnt lgkmcnt(0)
  v_cndmask_b32 v32, 0, v32, s[50:51]
  v_cndmask_b32 v34, 0, v34, s[50:51]
  v_cndmask_b32 v36, 0, v36, s[50:51]
  v_cndmask_b32 v38, 0, v38, s[50:51]
  s_lshl_b32 s60, s25, 13
  s_add_u32 s60, s60, s27
  s_add_u32 s60, s60, 65792
  s_cmp_eq_u32 s33, 3
  s_cselect_b32 s60, s60, 1073741824
  buffer_load_dword v4, v2, s[12:15], s60 offen sc1
a_max:
  v_mov_b32 v33, 0
  v_mov_b32 v224, 0xff800000
  v_mov_b32 v35, 0
  v_mov_b32 v225, 0xff800000
  v_mov_b32 v37, 0
  v_mov_b32 v226, 0xff800000
  v_mov_b32 v39, 0
  v_mov_b32 v227, 0xff800000
  s_mov_b32 s46, 0
  s_cmp_eq_u32 s3, 0
  s_cbranch_scc1 a_maxbody
a_maxloop:
  buffer_load_dwordx4 a[64:67], v79, s[16:19], s46 offen sc1
  buffer_load_dword v40, v231, s[16:19], s46 offen offset:2176 sc1
  s_add_u32 s46, s46, 4864
  s_waitcnt vmcnt(0)
a_maxbody:
  v_mfma_f32_32x32x8_bf16 v[96:111], v[40:41], v[32:33], 0
  v_mfma_f32_32x32x16_bf16 v[96:111], a[64:67], v[16:19], v[96:111]
  v_mfma_f32_32x32x8_bf16 v[112:127], v[40:41], v[34:35], 0
  v_mfma_f32_32x32x16_bf16 v[112:127], a[64:67], v[20:23], v[112:127]
  v_mfma_f32_32x32x8_bf16 v[128:143], v[40:41], v[36:37], 0
  v_mfma_f32_32x32x16_bf16 v[128:143], a[64:67], v[24:27], v[128:143]
  v_mfma_f32_32x32x8_bf16 v[144:159], v[40:41], v[38:39], 0
  v_mfma_f32_32x32x16_bf16 v[144:159], a[64:67], v[28:31], v[144:159]
  s_nop 5
  v_max3_f32 v224, v96, v97, v224
  v_max3_f32 v224, v98, v99, v224
  v_max3_f32 v224, v100, v101, v224
  v_max3_f32 v224, v102, v103, v224
  v_max3_f32 v224, v104, v105, v224
  v_max3_f32 v224, v106, v107, v224
  v_max3_f32 v224, v108, v109, v224
  v_max3_f32 v224, v110, v111, v224
  v_max3_f32 v225, v112, v113, v225
  v_max3_f32 v225, v114, v115, v225
  v_max3_f32 v225, v116, v117, v225
  v_max3_f32 v225, v118, v119, v225
  v_max3_f32 v225, v120, v121, v225
  v_max3_f32 v225, v122, v123, v225
  v_max3_f32 v225, v124, v125, v225
  v_max3_f32 v225, v126, v127, v225
  v_max3_f32 v226, v128, v129, v226
  v_max3_f32 v226, v130, v131, v226
  v_max3_f32 v226, v132, v133, v226
  v_max3_f32 v226, v134, v135, v226
  v_max3_f32 v226, v136, v137, v226
  v_max3_f32 v226, v138, v139, v226
  v_max3_f32 v226, v140, v141, v226
  v_max3_f32 v226, v142, v143, v226
  v_max3_f32 v227, v144, v145, v227
  v_max3_f32 v227, v146, v147, v227
  v_max3_f32 v227, v148, v149, v227
  v_max3_f32 v227, v150, v151, v227
  v_max3_f32 v227, v152, v153, v227
  v_max3_f32 v227, v154, v155, v227
  v_max3_f32 v227, v156, v157, v227
  v_max3_f32 v227, v158, v159, v227
  s_sub_u32 s47, s47, 1
  s_cmp_lg_u32 s47, 0
  s_cbranch_scc1 a_maxloop
  s_cmp_lg_u32 s3, 0
  s_cbranch_scc1 a_go
  s_cmp_lg_u32 s33, 3
  s_cbranch_scc1 a_ok
  s_waitcnt vmcnt(0)
  v_cmp_gt_u32 vcc, 16, v4
  s_nop 0
  s_cbranch_vccz a_ok
  s_lshl_b32 s60, s25, 13
  s_add_u32 s60, s60, s27
  s_add_u32 s60, s60, 65792
  s_mov_b32 s61, 0x40000
  s_cmp_lg_u32 s33, 3
  s_cbranch_scc1 a_ok
a_poll:
  buffer_load_dword v4, v2, s[12:15], s60 offen sc1
  s_sub_u32 s61, s61, 1
  s_waitcnt vmcnt(0)
  v_cmp_gt_u32 vcc, 16, v4
  s_cbranch_scc1 a_ok
  s_cbranch_vccnz a_poll
a_ok:
  s_barrier
a_go:
  s_mov_b32 s46, 0
  buffer_load_dwordx4 a[64:67], v79, s[16:19], s46 offen sc1
  buffer_load_dword v40, v231, s[16:19], s46 offen offset:2176 sc1
  buffer_load_dwordx4 a[80:83], v229, s[16:19], s46 offen sc1
  buffer_load_dwordx4 a[84:87], v230, s[16:19], s46 offen sc1
  s_add_u32 s46, s46, 4864
  buffer_load_dwordx4 a[68:71], v79, s[16:19], s46 offen sc1
  buffer_load_dword v42, v231, s[16:19], s46 offen offset:2176 sc1
  buffer_load_dwordx4 a[88:91], v229, s[16:19], s46 offen sc1
  buffer_load_dwordx4 a[92:95], v230, s[16:19], s46 offen sc1
  s_add_u32 s46, s46, 4864
  buffer_load_dwordx4 a[72:75], v79, s[16:19], s46 offen sc1
  buffer_load_dword v44, v231, s[16:19], s46 offen offset:2176 sc1
  buffer_load_dwordx4 a[96:99], v229, s[16:19], s46 offen sc1
  buffer_load_dwordx4 a[100:103], v230, s[16:19], s46 offen sc1
  s_mov_b32 s47, 8
  s_cmp_lg_u32 s32, 0
  s_cbranch_scc1 a_nopre
  s_mov_b32 s47, 4
  s_lshl_b32 s38, s33, 1
  s_add_u32 s38, s38, 64
  s_lshl_b32 m0, s38, 10
  s_mul_i32 s38, s38, s41
  s_add_u32 s38, s38, s56
  buffer_load_dwordx4 v72, s[20:23], s38 offen lds
  buffer_load_dwordx4 v73, s[20:23], s38 offen offset:1024 lds
  s_lshl_b32 s38, s33, 2
  s_sub_u32 s38, s38, 16
  s_lshl_b32 m0, s38, 10
  s_mul_i32 s38, s38, s41
  s_add_u32 s56, s56, s38
a_nopre:
  v_mov_b32 v128, v224
  v_mov_b32 v144, 0
  v_mov_b32 v145, 0
  v_permlane32_swap_b32 v224, v128
  v_mov_b32 v146, 0
  v_max_f32 v224, v224, v128
  v_sub_f32 v128, 0, v224
  v_and_b32 v129, 0xffff0000, v128
  v_sub_f32 v130, v128, v129
  v_and_b32 v131, 0xffff0000, v130
  v_sub_f32 v130, v130, v131
  v_perm_b32 v129, v131, v129, s49
  v_lshrrev_b32 v130, 16, v130
  v_cndmask_b32 v33, v130, v129, s[50:51]
  v_mov_b32 v147, 0
  v_mov_b32 v128, v225
  v_mov_b32 v148, 0
  v_mov_b32 v149, 0
  v_permlane32_swap_b32 v225, v128
  v_mov_b32 v150, 0
  v_max_f32 v225, v225, v128
  v_sub_f32 v128, 0, v225
  v_and_b32 v129, 0xffff0000, v128
  v_sub_f32 v130, v128, v129
  v_and_b32 v131, 0xffff0000, v130
  v_sub_f32 v130, v130, v131
  v_perm_b32 v129, v131, v129, s49
  v_lshrrev_b32 v130, 16, v130
  v_cndmask_b32 v35, v130, v129, s[50:51]
  v_mov_b32 v151, 0
  v_mov_b32 v128, v226
  v_mov_b32 v152, 0
  v_mov_b32 v153, 0
  v_permlane32_swap_b32 v226, v128
  v_mov_b32 v154, 0
  v_max_f32 v226, v226, v128
  v_sub_f32 v128, 0, v226
  v_and_b32 v129, 0xffff0000, v128
  v_sub_f32 v130, v128, v129
  v_and_b32 v131, 0xffff0000, v130
  v_sub_f32 v130, v130, v131
  v_perm_b32 v129, v131, v129, s49
  v_lshrrev_b32 v130, 16, v130
  v_cndmask_b32 v37, v130, v129, s[50:51]
  v_mov_b32 v155, 0
  v_mov_b32 v128, v227
  v_mov_b32 v156, 0
  v_mov_b32 v157, 0
  v_permlane32_swap_b32 v227, v128
  v_mov_b32 v158, 0
  v_max_f32 v227, v227, v128
  v_sub_f32 v128, 0, v227
  v_and_b32 v129, 0xffff0000, v128
  v_sub_f32 v130, v128, v129
  v_and_b32 v131, 0xffff0000, v130
  v_sub_f32 v130, v130, v131
  v_perm_b32 v129, v131, v129, s49
  v_lshrrev_b32 v130, 16, v130
  v_cndmask_b32 v39, v130, v129, s[50:51]
  v_mov_b32 v159, 0
  s_waitcnt vmcnt(10)
  v_mfma_f32_32x32x8_bf16 v[96:111], v[40:41], v[32:33], 0
  v_mfma_f32_32x32x16_bf16 v[96:111], a[64:67], v[16:19], v[96:111]
  v_mfma_f32_32x32x8_bf16 v[112:127], v[40:41], v[34:35], 0
  v_mfma_f32_32x32x16_bf16 v[112:127], a[64:67], v[20:23], v[112:127]
  s_nop 8
.p2align 3
a_loop:
  v_mfma_f32_32x32x8_bf16 v[128:143], v[40:41], v[36:37], 0
  v_exp_f32 v96, v96
  v_exp_f32 v97, v97
  v_exp_f32 v98, v98
  v_exp_f32 v99, v99
  v_mfma_f32_32x32x16_bf16 v[128:143], a[64:67], v[24:27], v[128:143]
  s_add_u32 s46, s46, 4864
  v_exp_f32 v100, v100
  v_exp_f32 v101, v101
  v_exp_f32 v102, v102
  v_exp_f32 v103, v103
  v_smfmac_f32_32x32x32_bf16 v[208:223], a[104:107], v[144:151], v228
  buffer_load_dwordx4 a[76:79], v79, s[16:19], s46 offen sc1
  v_exp_f32 v104, v104
  v_exp_f32 v105, v105
  v_exp_f32 v106, v106
  v_exp_f32 v107, v107
  v_smfmac_f32_32x32x32_bf16 v[208:223], a[108:111], v[152:159], v228
  s_add_u32 s56, s56, s57
  s_add_u32 m0, m0, s40
  v_exp_f32 v108, v108
  v_exp_f32 v109, v109
  v_exp_f32 v110, v110
  v_exp_f32 v111, v111
  v_mfma_f32_32x32x8_bf16 v[144:159], v[40:41], v[38:39], 0
  v_exp_f32 v112, v112
  v_exp_f32 v113, v113
  v_exp_f32 v114, v114
  v_exp_f32 v115, v115
  v_mfma_f32_32x32x16_bf16 v[144:159], a[64:67], v[28:31], v[144:159]
  s_waitcnt vmcnt(9)
  v_exp_f32 v116, v116
  v_exp_f32 v117, v117
  v_exp_f32 v118, v118
  v_exp_f32 v119, v119
  v_smfmac_f32_32x32x32_bf16 v[160:175], a[80:83], v[96:103], v228
  buffer_load_dword v46, v231, s[16:19], s46 offen offset:2176 sc1
  v_exp_f32 v120, v120
  v_exp_f32 v121, v121
  v_exp_f32 v122, v122
  v_exp_f32 v123, v123
  v_smfmac_f32_32x32x32_bf16 v[160:175], a[84:87], v[104:111], v228
  s_waitcnt vmcnt(8)
  v_exp_f32 v124, v124
  v_exp_f32 v125, v125
  v_exp_f32 v126, v126
  v_exp_f32 v127, v127
  v_mfma_f32_32x32x8_bf16 v[96:111], v[42:43], v[32:33], 0
  v_exp_f32 v128, v128
  v_exp_f32 v129, v129
  v_exp_f32 v130, v130
  v_exp_f32 v131, v131
  v_mfma_f32_32x32x16_bf16 v[96:111], a[68:71], v[16:19], v[96:111]
  v_exp_f32 v132, v132
  v_exp_f32 v133, v133
  v_exp_f32 v134, v134
  v_exp_f32 v135, v135
  v_smfmac_f32_32x32x32_bf16 v[176:191], a[80:83], v[112:119], v228
  buffer_load_dwordx4 a[104:107], v229, s[16:19], s46 offen sc1
  v_exp_f32 v136, v136
  v_exp_f32 v137, v137
  v_exp_f32 v138, v138
  v_exp_f32 v139, v139
  v_smfmac_f32_32x32x32_bf16 v[176:191], a[84:87], v[120:127], v228
  v_exp_f32 v140, v140
  v_exp_f32 v141, v141
  v_exp_f32 v142, v142
  v_exp_f32 v143, v143
  v_mfma_f32_32x32x8_bf16 v[112:127], v[42:43], v[34:35], 0
  v_exp_f32 v144, v144
  v_exp_f32 v145, v145
  v_exp_f32 v146, v146
  v_exp_f32 v147, v147
  v_mfma_f32_32x32x16_bf16 v[112:127], a[68:71], v[20:23], v[112:127]
  v_exp_f32 v148, v148
  v_exp_f32 v149, v149
  v_exp_f32 v150, v150
  v_exp_f32 v151, v151
  v_smfmac_f32_32x32x32_bf16 v[192:207], a[80:83], v[128:135], v228
  buffer_load_dwordx4 a[108:111], v230, s[16:19], s46 offen sc1
  v_exp_f32 v152, v152
  v_exp_f32 v153, v153
  v_exp_f32 v154, v154
  v_exp_f32 v155, v155
  v_smfmac_f32_32x32x32_bf16 v[192:207], a[84:87], v[136:143], v228
  buffer_load_dwordx4 v72, s[20:23], s56 offen sc1 lds
  v_exp_f32 v156, v156
  v_exp_f32 v157, v157
  v_exp_f32 v158, v158
  v_exp_f32 v159, v159
  v_mfma_f32_32x32x8_bf16 v[128:143], v[42:43], v[36:37], 0
  v_exp_f32 v96, v96
  v_exp_f32 v97, v97
  v_exp_f32 v98, v98
  v_exp_f32 v99, v99
  v_mfma_f32_32x32x16_bf16 v[128:143], a[68:71], v[24:27], v[128:143]
  s_add_u32 s46, s46, 4864
  v_exp_f32 v100, v100
  v_exp_f32 v101, v101
  v_exp_f32 v102, v102
  v_exp_f32 v103, v103
  v_smfmac_f32_32x32x32_bf16 v[208:223], a[80:83], v[144:151], v228
  buffer_load_dwordx4 a[64:67], v79, s[16:19], s46 offen sc1
  v_exp_f32 v104, v104
  v_exp_f32 v105, v105
  v_exp_f32 v106, v106
  v_exp_f32 v107, v107
  v_smfmac_f32_32x32x32_bf16 v[208:223], a[84:87], v[152:159], v228
  v_exp_f32 v108, v108
  v_exp_f32 v109, v109
  v_exp_f32 v110, v110
  v_exp_f32 v111, v111
  v_mfma_f32_32x32x8_bf16 v[144:159], v[42:43], v[38:39], 0
  v_exp_f32 v112, v112
  v_exp_f32 v113, v113
  v_exp_f32 v114, v114
  v_exp_f32 v115, v115
  v_mfma_f32_32x32x16_bf16 v[144:159], a[68:71], v[28:31], v[144:159]
  s_waitcnt vmcnt(10)
  v_exp_f32 v116, v116
  v_exp_f32 v117, v117
  v_exp_f32 v118, v118
  v_exp_f32 v119, v119
  v_smfmac_f32_32x32x32_bf16 v[160:175], a[88:91], v[96:103], v228
  buffer_load_dword v40, v231, s[16:19], s46 offen offset:2176 sc1
  v_exp_f32 v120, v120
  v_exp_f32 v121, v121
  v_exp_f32 v122, v122
  v_exp_f32 v123, v123
  v_smfmac_f32_32x32x32_bf16 v[160:175], a[92:95], v[104:111], v228
  s_waitcnt vmcnt(9)
  v_exp_f32 v124, v124
  v_exp_f32 v125, v125
  v_exp_f32 v126, v126
  v_exp_f32 v127, v127
  v_mfma_f32_32x32x8_bf16 v[96:111], v[44:45], v[32:33], 0
  v_exp_f32 v128, v128
  v_exp_f32 v129, v129
  v_exp_f32 v130, v130
  v_exp_f32 v131, v131
  v_mfma_f32_32x32x16_bf16 v[96:111], a[72:75], v[16:19], v[96:111]
  v_exp_f32 v132, v132
  v_exp_f32 v133, v133
  v_exp_f32 v134, v134
  v_exp_f32 v135, v135
  v_smfmac_f32_32x32x32_bf16 v[176:191], a[88:91], v[112:119], v228
  buffer_load_dwordx4 a[80:83], v229, s[16:19], s46 offen sc1
  v_exp_f32 v136, v136
  v_exp_f32 v137, v137
  v_exp_f32 v138, v138
  v_exp_f32 v139, v139
  v_smfmac_f32_32x32x32_bf16 v[176:191], a[92:95], v[120:127], v228
  v_exp_f32 v140, v140
  v_exp_f32 v141, v141
  v_exp_f32 v142, v142
  v_exp_f32 v143, v143
  v_mfma_f32_32x32x8_bf16 v[112:127], v[44:45], v[34:35], 0
  v_exp_f32 v144, v144
  v_exp_f32 v145, v145
  v_exp_f32 v146, v146
  v_exp_f32 v147, v147
  v_mfma_f32_32x32x16_bf16 v[112:127], a[72:75], v[20:23], v[112:127]
  v_exp_f32 v148, v148
  v_exp_f32 v149, v149
  v_exp_f32 v150, v150
  v_exp_f32 v151, v151
  v_smfmac_f32_32x32x32_bf16 v[192:207], a[88:91], v[128:135], v228
  buffer_load_dwordx4 a[84:87], v230, s[16:19], s46 offen sc1
  v_exp_f32 v152, v152
  v_exp_f32 v153, v153
  v_exp_f32 v154, v154
  v_exp_f32 v155, v155
  v_smfmac_f32_32x32x32_bf16 v[192:207], a[92:95], v[136:143], v228
  buffer_load_dwordx4 v73, s[20:23], s56 offen offset:1024 sc1 lds
  v_exp_f32 v156, v156
  v_exp_f32 v157, v157
  v_exp_f32 v158, v158
  v_exp_f32 v159, v159
  v_mfma_f32_32x32x8_bf16 v[128:143], v[44:45], v[36:37], 0
  v_exp_f32 v96, v96
  v_exp_f32 v97, v97
  v_exp_f32 v98, v98
  v_exp_f32 v99, v99
  v_mfma_f32_32x32x16_bf16 v[128:143], a[72:75], v[24:27], v[128:143]
  s_add_u32 s46, s46, 4864
  v_exp_f32 v100, v100
  v_exp_f32 v101, v101
  v_exp_f32 v102, v102
  v_exp_f32 v103, v103
  v_smfmac_f32_32x32x32_bf16 v[208:223], a[88:91], v[144:151], v228
  buffer_load_dwordx4 a[68:71], v79, s[16:19], s46 offen sc1
  v_exp_f32 v104, v104
  v_exp_f32 v105, v105
  v_exp_f32 v106, v106
  v_exp_f32 v107, v107
  v_smfmac_f32_32x32x32_bf16 v[208:223], a[92:95], v[152:159], v228
  v_exp_f32 v108, v108
  v_exp_f32 v109, v109
  v_exp_f32 v110, v110
  v_exp_f32 v111, v111
  v_mfma_f32_32x32x8_bf16 v[144:159], v[44:45], v[38:39], 0
  v_exp_f32 v112, v112
  v_exp_f32 v113, v113
  v_exp_f32 v114, v114
  v_exp_f32 v115, v115
  v_mfma_f32_32x32x16_bf16 v[144:159], a[72:75], v[28:31], v[144:159]
  s_waitcnt vmcnt(11)
  v_exp_f32 v116, v116
  v_exp_f32 v117, v117
  v_exp_f32 v118, v118
  v_exp_f32 v119, v119
  v_smfmac_f32_32x32x32_bf16 v[160:175], a[96:99], v[96:103], v228
  buffer_load_dword v42, v231, s[16:19], s46 offen offset:2176 sc1
  v_exp_f32 v120, v120
  v_exp_f32 v121, v121
  v_exp_f32 v122, v122
  v_exp_f32 v123, v123
  v_smfmac_f32_32x32x32_bf16 v[160:175], a[100:103], v[104:111], v228
  s_waitcnt vmcnt(10)
  v_exp_f32 v124, v124
  v_exp_f32 v125, v125
  v_exp_f32 v126, v126
  v_exp_f32 v127, v127
  v_mfma_f32_32x32x8_bf16 v[96:111], v[46:47], v[32:33], 0
  v_exp_f32 v128, v128
  v_exp_f32 v129, v129
  v_exp_f32 v130, v130
  v_exp_f32 v131, v131
  v_mfma_f32_32x32x16_bf16 v[96:111], a[76:79], v[16:19], v[96:111]
  v_exp_f32 v132, v132
  v_exp_f32 v133, v133
  v_exp_f32 v134, v134
  v_exp_f32 v135, v135
  v_smfmac_f32_32x32x32_bf16 v[176:191], a[96:99], v[112:119], v228
  buffer_load_dwordx4 a[88:91], v229, s[16:19], s46 offen sc1
  v_exp_f32 v136, v136
  v_exp_f32 v137, v137
  v_exp_f32 v138, v138
  v_exp_f32 v139, v139
  v_smfmac_f32_32x32x32_bf16 v[176:191], a[100:103], v[120:127], v228
  v_exp_f32 v140, v140
  v_exp_f32 v141, v141
  v_exp_f32 v142, v142
  v_exp_f32 v143, v143
  v_mfma_f32_32x32x8_bf16 v[112:127], v[46:47], v[34:35], 0
  v_exp_f32 v144, v144
  v_exp_f32 v145, v145
  v_exp_f32 v146, v146
  v_exp_f32 v147, v147
  v_mfma_f32_32x32x16_bf16 v[112:127], a[76:79], v[20:23], v[112:127]
  v_exp_f32 v148, v148
  v_exp_f32 v149, v149
  v_exp_f32 v150, v150
  v_exp_f32 v151, v151
  v_smfmac_f32_32x32x32_bf16 v[192:207], a[96:99], v[128:135], v228
  buffer_load_dwordx4 a[92:95], v230, s[16:19], s46 offen sc1
  v_exp_f32 v152, v152
  v_exp_f32 v153, v153
  v_exp_f32 v154, v154
  v_exp_f32 v155, v155
  v_smfmac_f32_32x32x32_bf16 v[192:207], a[100:103], v[136:143], v228
  buffer_load_dwordx4 v74, s[20:23], s56 offen offset:2048 sc1 lds
  v_exp_f32 v156, v156
  v_exp_f32 v157, v157
  v_exp_f32 v158, v158
  v_exp_f32 v159, v159
  v_mfma_f32_32x32x8_bf16 v[128:143], v[46:47], v[36:37], 0
  v_exp_f32 v96, v96
  v_exp_f32 v97, v97
  v_exp_f32 v98, v98
  v_exp_f32 v99, v99
  v_mfma_f32_32x32x16_bf16 v[128:143], a[76:79], v[24:27], v[128:143]
  s_add_u32 s46, s46, 4864
  v_exp_f32 v100, v100
  v_exp_f32 v101, v101
  v_exp_f32 v102, v102
  v_exp_f32 v103, v103
  v_smfmac_f32_32x32x32_bf16 v[208:223], a[96:99], v[144:151], v228
  buffer_load_dwordx4 a[72:75], v79, s[16:19], s46 offen sc1
  v_exp_f32 v104, v104
  v_exp_f32 v105, v105
  v_exp_f32 v106, v106
  v_exp_f32 v107, v107
  v_smfmac_f32_32x32x32_bf16 v[208:223], a[100:103], v[152:159], v228
  v_exp_f32 v108, v108
  v_exp_f32 v109, v109
  v_exp_f32 v110, v110
  v_exp_f32 v111, v111
  v_mfma_f32_32x32x8_bf16 v[144:159], v[46:47], v[38:39], 0
  v_exp_f32 v112, v112
  v_exp_f32 v113, v113
  v_exp_f32 v114, v114
  v_exp_f32 v115, v115
  v_mfma_f32_32x32x16_bf16 v[144:159], a[76:79], v[28:31], v[144:159]
  s_waitcnt vmcnt(12)
  v_exp_f32 v116, v116
  v_exp_f32 v117, v117
  v_exp_f32 v118, v118
  v_exp_f32 v119, v119
  v_smfmac_f32_32x32x32_bf16 v[160:175], a[104:107], v[96:103], v228
  buffer_load_dword v44, v231, s[16:19], s46 offen offset:2176 sc1
  v_exp_f32 v120, v120
  v_exp_f32 v121, v121
  v_exp_f32 v122, v122
  v_exp_f32 v123, v123
  v_smfmac_f32_32x32x32_bf16 v[160:175], a[108:111], v[104:111], v228
  s_waitcnt vmcnt(10)
  v_exp_f32 v124, v124
  v_exp_f32 v125, v125
  v_exp_f32 v126, v126
  v_exp_f32 v127, v127
  v_mfma_f32_32x32x8_bf16 v[96:111], v[40:41], v[32:33], 0
  v_exp_f32 v128, v128
  v_exp_f32 v129, v129
  v_exp_f32 v130, v130
  v_exp_f32 v131, v131
  v_mfma_f32_32x32x16_bf16 v[96:111], a[64:67], v[16:19], v[96:111]
  s_sub_u32 s47, s47, 1
  v_exp_f32 v132, v132
  v_exp_f32 v133, v133
  v_exp_f32 v134, v134
  v_exp_f32 v135, v135
  v_smfmac_f32_32x32x32_bf16 v[176:191], a[104:107], v[112:119], v228
  buffer_load_dwordx4 a[96:99], v229, s[16:19], s46 offen sc1
  v_exp_f32 v136, v136
  v_exp_f32 v137, v137
  v_exp_f32 v138, v138
  v_exp_f32 v139, v139
  v_smfmac_f32_32x32x32_bf16 v[176:191], a[108:111], v[120:127], v228
  v_exp_f32 v140, v140
  v_exp_f32 v141, v141
  v_exp_f32 v142, v142
  v_exp_f32 v143, v143
  v_mfma_f32_32x32x8_bf16 v[112:127], v[40:41], v[34:35], 0
  v_exp_f32 v144, v144
  v_exp_f32 v145, v145
  v_exp_f32 v146, v146
  v_exp_f32 v147, v147
  v_mfma_f32_32x32x16_bf16 v[112:127], a[64:67], v[20:23], v[112:127]
  s_cmp_lg_u32 s47, 0
  v_exp_f32 v148, v148
  v_exp_f32 v149, v149
  v_exp_f32 v150, v150
  v_exp_f32 v151, v151
  v_smfmac_f32_32x32x32_bf16 v[192:207], a[104:107], v[128:135], v228
  buffer_load_dwordx4 a[100:103], v230, s[16:19], s46 offen sc1
  v_exp_f32 v152, v152
  v_exp_f32 v153, v153
  v_exp_f32 v154, v154
  v_exp_f32 v155, v155
  v_smfmac_f32_32x32x32_bf16 v[192:207], a[108:111], v[136:143], v228
  buffer_load_dwordx4 v75, s[20:23], s56 offen offset:3072 sc1 lds
  v_exp_f32 v156, v156
  v_exp_f32 v157, v157
  v_exp_f32 v158, v158
  v_exp_f32 v159, v159
  s_cbranch_scc1 a_loop
  s_cmp_lt_u32 s32, 4
  s_cbranch_scc1 a_break
a_done:
  v_smfmac_f32_32x32x32_bf16 v[208:223], a[104:107], v[144:151], v228
  v_mov_b32 v171, v224
  v_mov_b32 v187, v225
  v_smfmac_f32_32x32x32_bf16 v[208:223], a[108:111], v[152:159], v228
  ds_write_b128 v10, v[160:163] offset:0
  ds_write_b128 v10, v[164:167] offset:1024
  ds_write_b128 v10, v[168:171] offset:2048
  ds_write_b128 v10, v[176:179] offset:3072
  ds_write_b128 v10, v[180:183] offset:4096
  ds_write_b128 v10, v[184:187] offset:5120
  v_max3_f32 v8, v170, v186, v202
  v_mov_b32 v9, 0x53800000
  v_cmp_u_f32 s[52:53], v170, v186
  s_and_b32 s38, s2, 7
  s_lshl_b32 s38, s38, 12
  s_add_u32 s38, s38, s27
  v_max_f32 v8, v218, v8
  v_cmp_u_f32 s[54:55], v202, v218
  v_cmp_nlt_f32 vcc, v8, v9
  s_add_u32 s38, s38, 66304
  s_or_b64 s[52:53], s[52:53], s[54:55]
  s_or_b64 vcc, vcc, s[52:53]
  s_cmp_eq_u32 s3, 0
  s_cselect_b64 vcc, vcc, 0
  s_waitcnt lgkmcnt(0)
  s_cbranch_vccnz a_redo
  s_barrier
  ds_read_b128 v[104:107], v11 offset:2048
  ds_read_b128 v[96:99], v11 offset:0
  ds_read_b128 v[100:103], v11 offset:1024
  ds_read_b128 v[120:123], v11 offset:5120
  ds_read_b128 v[112:115], v11 offset:3072
  ds_read_b128 v[116:119], v11 offset:4096
  s_waitcnt lgkmcnt(5)
  v_max_f32 v8, v226, v107
  v_sub_f32 v9, v226, v8
  v_sub_f32 v8, v107, v8
  v_exp_f32 v9, v9
  v_exp_f32 v8, v8
  v_mul_f32 v12, v9, v202
  v_fmac_f32 v12, v8, v106
  v_rcp_f32 v12, v12
  s_waitcnt lgkmcnt(3)
  v_pk_mul_f32 v[8:9], v[8:9], v[12:13] op_sel_hi:[1,0]
  v_pk_mul_f32 v[200:201], v[8:9], v[200:201] op_sel:[1,0] op_sel_hi:[1,1]
  v_pk_mul_f32 v[192:193], v[8:9], v[192:193] op_sel:[1,0] op_sel_hi:[1,1]
  v_pk_mul_f32 v[194:195], v[8:9], v[194:195] op_sel:[1,0] op_sel_hi:[1,1]
  v_pk_mul_f32 v[196:197], v[8:9], v[196:197] op_sel:[1,0] op_sel_hi:[1,1]
  v_pk_mul_f32 v[198:199], v[8:9], v[198:199] op_sel:[1,0] op_sel_hi:[1,1]
  v_pk_fma_f32 v[200:201], v[8:9], v[104:105], v[200:201] op_sel_hi:[0,1,1]
  v_pk_fma_f32 v[192:193], v[8:9], v[96:97], v[192:193] op_sel_hi:[0,1,1]
  v_pk_fma_f32 v[194:195], v[8:9], v[98:99], v[194:195] op_sel_hi:[0,1,1]
  v_pk_fma_f32 v[196:197], v[8:9], v[100:101], v[196:197] op_sel_hi:[0,1,1]
  v_pk_fma_f32 v[198:199], v[8:9], v[102:103], v[198:199] op_sel_hi:[0,1,1]
  v_cvt_pk_bf16_f32 v20, v200, v201
  v_cvt_pk_bf16_f32 v16, v192, v193
  v_cvt_pk_bf16_f32 v17, v194, v195
  v_cvt_pk_bf16_f32 v18, v196, v197
  v_cvt_pk_bf16_f32 v19, v198, v199
  buffer_store_dwordx4 v[16:19], v6, s[12:15], s43 offen sc1
  v_mov_b32 v21, v20 quad_perm:[1,1,1,1] row_mask:0xf bank_mask:0xf
  v_mov_b32 v22, v20 quad_perm:[2,2,2,2] row_mask:0xf bank_mask:0xf
  v_mov_b32 v23, v20 quad_perm:[3,3,3,3] row_mask:0xf bank_mask:0xf
  buffer_store_dwordx4 v[20:23], v7, s[12:15], s42 offen sc1
  s_add_u32 s42, s42, 36864
  s_add_u32 s43, s43, 36864
  s_waitcnt lgkmcnt(2)
  v_max_f32 v8, v227, v123
  v_sub_f32 v9, v227, v8
  v_sub_f32 v8, v123, v8
  v_exp_f32 v9, v9
  v_exp_f32 v8, v8
  v_mul_f32 v12, v9, v218
  v_fmac_f32 v12, v8, v122
  v_rcp_f32 v12, v12
  s_waitcnt lgkmcnt(0)
  v_pk_mul_f32 v[8:9], v[8:9], v[12:13] op_sel_hi:[1,0]
  v_pk_mul_f32 v[216:217], v[8:9], v[216:217] op_sel:[1,0] op_sel_hi:[1,1]
  v_pk_mul_f32 v[208:209], v[8:9], v[208:209] op_sel:[1,0] op_sel_hi:[1,1]
  v_pk_mul_f32 v[210:211], v[8:9], v[210:211] op_sel:[1,0] op_sel_hi:[1,1]
  v_pk_mul_f32 v[212:213], v[8:9], v[212:213] op_sel:[1,0] op_sel_hi:[1,1]
  v_pk_mul_f32 v[214:215], v[8:9], v[214:215] op_sel:[1,0] op_sel_hi:[1,1]
  v_pk_fma_f32 v[216:217], v[8:9], v[120:121], v[216:217] op_sel_hi:[0,1,1]
  v_pk_fma_f32 v[208:209], v[8:9], v[112:113], v[208:209] op_sel_hi:[0,1,1]
  v_pk_fma_f32 v[210:211], v[8:9], v[114:115], v[210:211] op_sel_hi:[0,1,1]
  v_pk_fma_f32 v[212:213], v[8:9], v[116:117], v[212:213] op_sel_hi:[0,1,1]
  v_pk_fma_f32 v[214:215], v[8:9], v[118:119], v[214:215] op_sel_hi:[0,1,1]
  v_cvt_pk_bf16_f32 v28, v216, v217
  v_cvt_pk_bf16_f32 v24, v208, v209
  v_cvt_pk_bf16_f32 v25, v210, v211
  v_cvt_pk_bf16_f32 v26, v212, v213
  v_cvt_pk_bf16_f32 v27, v214, v215
  buffer_store_dwordx4 v[24:27], v6, s[12:15], s43 offen sc1
  v_mov_b32 v29, v28 quad_perm:[1,1,1,1] row_mask:0xf bank_mask:0xf
  v_mov_b32 v30, v28 quad_perm:[2,2,2,2] row_mask:0xf bank_mask:0xf
  v_mov_b32 v31, v28 quad_perm:[3,3,3,3] row_mask:0xf bank_mask:0xf
  buffer_store_dwordx4 v[28:31], v7, s[12:15], s42 offen sc1
  s_lshl_b32 s60, s24, 13
  s_add_u32 s60, s60, s27
  s_add_u32 s60, s60, 69888
  s_waitcnt vmcnt(0) lgkmcnt(0)
a_bar:
  s_barrier
  s_cmp_lg_u32 s33, 3
  s_cbranch_scc1 a_sig
  s_mov_b64 exec, 1
  buffer_atomic_add v3, v2, s[12:15], s60 offen sc1
  buffer_atomic_add v3, v2, s[12:15], s38 offen sc1
  s_mov_b64 exec, -1
a_sig:
  s_cmp_eq_u32 s33, 3
  s_cbranch_scc1 o_nowo
  s_lshl_b32 s38, s33, 14
  s_add_u32 s38, s38, 79872
  v_add_u32 v6, s38, v1
  s_mul_i32 s38, s33, 26624
  v_add_u32 v7, s38, v1
  s_cmp_eq_u32 s26, 0
  s_cbranch_scc1 o_first
o_rest:
  ds_read_b128 a[48:51], v7 offset:0
  ds_read_b128 a[52:55], v7 offset:1024
  ds_read_b128 a[56:59], v7 offset:2048
  ds_read_b128 a[60:63], v7 offset:3072
  s_waitcnt lgkmcnt(4)
  ds_read_b128 a[64:67], v7 offset:4096
  ds_read_b128 a[68:71], v7 offset:5120
  ds_read_b128 a[72:75], v7 offset:6144
  ds_read_b128 a[76:79], v7 offset:7168
  ds_read_b128 a[80:83], v7 offset:8192
  ds_read_b128 a[84:87], v7 offset:9216
  ds_read_b128 a[88:91], v7 offset:10240
  ds_read_b128 a[92:95], v7 offset:11264
  s_waitcnt lgkmcnt(4)
  ds_read_b128 a[96:99], v7 offset:12288
  ds_read_b128 a[100:103], v7 offset:13312
  ds_read_b128 a[104:107], v7 offset:14336
  ds_read_b128 a[108:111], v7 offset:15360
  ds_read_b128 a[112:115], v7 offset:16384
  ds_read_b128 a[116:119], v7 offset:17408
  ds_read_b128 a[120:123], v7 offset:18432
  ds_read_b128 a[124:127], v7 offset:19456
  s_waitcnt lgkmcnt(4)
  ds_read_b128 a[128:131], v7 offset:20480
  ds_read_b128 a[132:135], v7 offset:21504
  ds_read_b128 a[136:139], v7 offset:22528
  ds_read_b128 a[140:143], v7 offset:23552
  ds_read_b128 a[144:147], v7 offset:24576
  ds_read_b128 a[148:151], v7 offset:25600
  s_waitcnt lgkmcnt(4)
  ds_read_b128 a[152:155], v6 offset:0
  ds_read_b128 a[156:159], v6 offset:1024
  ds_read_b128 a[160:163], v6 offset:2048
  ds_read_b128 a[164:167], v6 offset:3072
  ds_read_b128 a[168:171], v6 offset:4096
  ds_read_b128 a[172:175], v6 offset:5120
  ds_read_b128 a[176:179], v6 offset:6144
  ds_read_b128 a[180:183], v6 offset:7168
  s_waitcnt lgkmcnt(4)
  ds_read_b128 a[184:187], v6 offset:8192
  ds_read_b128 a[188:191], v6 offset:9216
  ds_read_b128 a[192:195], v6 offset:10240
  ds_read_b128 a[196:199], v6 offset:11264
  ds_read_b128 a[200:203], v6 offset:12288
  ds_read_b128 a[204:207], v6 offset:13312
  ds_read_b128 a[208:211], v6 offset:14336
  ds_read_b128 a[212:215], v6 offset:15360
o_nowo:
  s_mul_i32 s38, s25, 1124352
  s_add_u32 s38, s38, 82198528
  s_add_u32 s16, s4, s38
  s_addc_u32 s17, s5, 0
  s_mov_b32 s18, 1124352
  s_mov_b32 s19, 0x20000
  s_cmp_eq_u32 s26, 0
  s_cselect_b32 s18, s18, 995328
  v_bfe_u32 v6, v0, 4, 1
  v_bfe_u32 v7, v0, 5, 1
  v_mul_u32_u24 v5, 18432, v6
  v_lshl_add_u32 v5, v7, 8, v5
  v_and_b32 v6, 15, v0
  v_lshl_add_u32 v5, v6, 4, v5
  v_and_b32 v13, 15, v0
  v_lshlrev_b32 v13, 4, v13
  v_bfe_u32 v14, v0, 4, 1
  v_lshl_add_u32 v13, v14, 3, v13
  v_bfe_u32 v14, v0, 5, 1
  v_lshl_add_u32 v13, v14, 2, v13
  s_and_b32 s59, s25, 3
  s_mul_i32 s59, s59, 3
  s_add_u32 s59, s59, s33
  s_lshl_b32 s59, s59, 8
  s_mul_i32 s38, s29, 3072
  s_add_u32 s59, s59, s38
  v_permlane16_swap_b32 v232, v236
  v_permlane16_swap_b32 v233, v237
  v_permlane16_swap_b32 v234, v238
  v_permlane16_swap_b32 v235, v239
  v_permlane16_swap_b32 v240, v244
  v_permlane16_swap_b32 v241, v245
  v_permlane16_swap_b32 v242, v246
  v_permlane16_swap_b32 v243, v247
  v_permlane16_swap_b32 v248, v252
  v_permlane16_swap_b32 v249, v253
  v_permlane16_swap_b32 v250, v254
  v_permlane16_swap_b32 v251, v255
  s_and_b32 s34, s25, 3
  s_mul_i32 s34, s34, 3
  s_add_u32 s34, s34, s33
  s_mul_i32 s34, s34, 1536
  s_mul_i32 s35, s29, 36864
  s_add_u32 s34, s34, s35
  s_lshl_b32 s38, s33, 10
  s_add_u32 s37, s35, s38
  s_add_u32 s37, s37, s26
  s_add_u32 s37, s37, 2359296
  s_add_u32 s38, s38, 110592
  v_add_u32 v6, 110592, v1
  s_add_u32 s36, s34, s26
  s_add_u32 s36, s36, 4718592
  v_bfe_u32 v7, v0, 4, 2
  v_and_b32 v8, 15, v0
  v_lshlrev_b32 v7, 9, v7
  v_lshl_add_u32 v7, v8, 2, v7
  v_add_u32 v7, 143360, v7
  v_add_u32 v8, 2048, v7
  v_and_b32 v11, 7, v0
  v_lshlrev_b32 v11, 12, v11
  s_lshl_b32 s41, s26, 2
  s_add_u32 s41, s41, s33
  s_mov_b32 s40, 100320000
  s_cmp_eq_u32 s41, 3
  s_cselect_b32 s40, s40, 1073741824
  s_cselect_b32 s41, 32, 0
  s_waitcnt lgkmcnt(0)
  s_lshl_b32 s60, s24, 13
  s_add_u32 s60, s60, s27
  s_add_u32 s60, s60, 69888
  s_mov_b32 s61, 0x40000
  s_cmp_lg_u32 s33, 3
  s_cbranch_scc1 o_ok
o_poll:
  buffer_load_dword v4, v2, s[12:15], s60 offen sc1
  s_sub_u32 s61, s61, 1
  s_waitcnt vmcnt(0)
  v_cmp_gt_u32 vcc, 16, v4
  s_cbranch_scc1 o_ok
  s_cbranch_vccnz o_poll
o_ok:
  s_barrier
  buffer_load_dword v4, v11, s[12:15], s40 offen sc1
  s_add_u32 m0, s38, 0
  s_add_u32 s39, s37, 0
  buffer_load_dwordx4 v1, s[12:15], s39 offen sc1 lds
  s_add_u32 m0, s38, 16384
  s_add_u32 s39, s37, 16384
  buffer_load_dwordx4 v1, s[12:15], s39 offen sc1 lds
  s_add_u32 m0, s38, 4096
  s_add_u32 s39, s37, 4096
  buffer_load_dwordx4 v1, s[12:15], s39 offen sc1 lds
  s_add_u32 m0, s38, 20480
  s_add_u32 s39, s37, 20480
  buffer_load_dwordx4 v1, s[12:15], s39 offen sc1 lds
  s_add_u32 m0, s38, 8192
  s_add_u32 s39, s37, 8192
  buffer_load_dwordx4 v1, s[12:15], s39 offen sc1 lds
  s_add_u32 m0, s38, 24576
  s_add_u32 s39, s37, 24576
  buffer_load_dwordx4 v1, s[12:15], s39 offen sc1 lds
  s_add_u32 m0, s38, 12288
  s_add_u32 s39, s37, 12288
  buffer_load_dwordx4 v1, s[12:15], s39 offen sc1 lds
  s_add_u32 m0, s38, 28672
  s_add_u32 s39, s37, 28672
  buffer_load_dwordx4 v1, s[12:15], s39 offen sc1 lds
  s_add_u32 m0, s38, 32768
  s_add_u32 s39, s37, 32768
  buffer_load_dwordx4 v1, s[12:15], s39 offen sc1 lds
  s_waitcnt vmcnt(5)
  s_barrier
  s_cmp_eq_u32 s33, 3
  s_cbranch_scc1 o_ring
  ds_read_b128 v[56:59], v6 offset:0
  ds_read_b128 v[60:63], v6 offset:16384
  ds_read_b128 v[64:67], v6 offset:1024
  ds_read_b128 v[68:71], v6 offset:17408
  s_waitcnt lgkmcnt(2)
  v_mov_b32 v9, 0
  v_mov_b32 v10, 0
  v_mfma_f32_16x16x32_bf16 v[232:235], a[0:3], v[56:59], v[232:235]
  ds_read_b128 v[72:75], v6 offset:2048
  v_mfma_f32_16x16x32_bf16 v[236:239], a[0:3], v[60:63], v[236:239]
  ds_read_b128 v[76:79], v6 offset:18432
  v_mfma_f32_16x16x32_bf16 v[240:243], a[72:75], v[56:59], v[240:243]
  v_mfma_f32_16x16x32_bf16 v[244:247], a[72:75], v[60:63], v[244:247]
  v_mfma_f32_16x16x32_bf16 v[248:251], a[144:147], v[56:59], v[248:251]
  v_mfma_f32_16x16x32_bf16 v[252:255], a[144:147], v[60:63], v[252:255]
  s_waitcnt lgkmcnt(2)
  v_mfma_f32_16x16x32_bf16 v[232:235], a[4:7], v[64:67], v[232:235]
  ds_read_b128 v[80:83], v6 offset:3072
  v_mfma_f32_16x16x32_bf16 v[236:239], a[4:7], v[68:71], v[236:239]
  ds_read_b128 v[84:87], v6 offset:19456
  v_mfma_f32_16x16x32_bf16 v[240:243], a[76:79], v[64:67], v[240:243]
  v_mfma_f32_16x16x32_bf16 v[244:247], a[76:79], v[68:71], v[244:247]
  v_mfma_f32_16x16x32_bf16 v[248:251], a[148:151], v[64:67], v[248:251]
  v_mfma_f32_16x16x32_bf16 v[252:255], a[148:151], v[68:71], v[252:255]
  s_waitcnt lgkmcnt(2)
  v_mfma_f32_16x16x32_bf16 v[232:235], a[8:11], v[72:75], v[232:235]
  ds_read_b128 v[88:91], v6 offset:4096
  v_mfma_f32_16x16x32_bf16 v[236:239], a[8:11], v[76:79], v[236:239]
  ds_read_b128 v[92:95], v6 offset:20480
  v_mfma_f32_16x16x32_bf16 v[240:243], a[80:83], v[72:75], v[240:243]
  v_mfma_f32_16x16x32_bf16 v[244:247], a[80:83], v[76:79], v[244:247]
  v_mfma_f32_16x16x32_bf16 v[248:251], a[152:155], v[72:75], v[248:251]
  v_mfma_f32_16x16x32_bf16 v[252:255], a[152:155], v[76:79], v[252:255]
  s_waitcnt lgkmcnt(2)
  v_mfma_f32_16x16x32_bf16 v[232:235], a[12:15], v[80:83], v[232:235]
  ds_read_b128 v[96:99], v6 offset:5120
  v_mfma_f32_16x16x32_bf16 v[236:239], a[12:15], v[84:87], v[236:239]
  ds_read_b128 v[100:103], v6 offset:21504
  v_mfma_f32_16x16x32_bf16 v[240:243], a[84:87], v[80:83], v[240:243]
  v_mfma_f32_16x16x32_bf16 v[244:247], a[84:87], v[84:87], v[244:247]
  v_mfma_f32_16x16x32_bf16 v[248:251], a[156:159], v[80:83], v[248:251]
  v_mfma_f32_16x16x32_bf16 v[252:255], a[156:159], v[84:87], v[252:255]
  s_waitcnt lgkmcnt(2)
  v_mfma_f32_16x16x32_bf16 v[232:235], a[16:19], v[88:91], v[232:235]
  ds_read_b128 v[104:107], v6 offset:6144
  v_mfma_f32_16x16x32_bf16 v[236:239], a[16:19], v[92:95], v[236:239]
  ds_read_b128 v[108:111], v6 offset:22528
  v_mfma_f32_16x16x32_bf16 v[240:243], a[88:91], v[88:91], v[240:243]
  v_mfma_f32_16x16x32_bf16 v[244:247], a[88:91], v[92:95], v[244:247]
  v_mfma_f32_16x16x32_bf16 v[248:251], a[160:163], v[88:91], v[248:251]
  v_mfma_f32_16x16x32_bf16 v[252:255], a[160:163], v[92:95], v[252:255]
  s_waitcnt lgkmcnt(2)
  v_mfma_f32_16x16x32_bf16 v[232:235], a[20:23], v[96:99], v[232:235]
  ds_read_b128 v[112:115], v6 offset:7168
  v_mfma_f32_16x16x32_bf16 v[236:239], a[20:23], v[100:103], v[236:239]
  ds_read_b128 v[116:119], v6 offset:23552
  v_mfma_f32_16x16x32_bf16 v[240:243], a[92:95], v[96:99], v[240:243]
  v_mfma_f32_16x16x32_bf16 v[244:247], a[92:95], v[100:103], v[244:247]
  v_mfma_f32_16x16x32_bf16 v[248:251], a[164:167], v[96:99], v[248:251]
  s_waitcnt vmcnt(0)
  s_barrier
  v_mfma_f32_16x16x32_bf16 v[252:255], a[164:167], v[100:103], v[252:255]
  s_waitcnt lgkmcnt(2)
  v_mfma_f32_16x16x32_bf16 v[232:235], a[24:27], v[104:107], v[232:235]
  ds_read_b128 v[120:123], v6 offset:8192
  v_mfma_f32_16x16x32_bf16 v[236:239], a[24:27], v[108:111], v[236:239]
  ds_read_b128 v[124:127], v6 offset:24576
  v_mfma_f32_16x16x32_bf16 v[240:243], a[96:99], v[104:107], v[240:243]
  ds_read_b128 v[128:131], v6 offset:9216
  v_mfma_f32_16x16x32_bf16 v[244:247], a[96:99], v[108:111], v[244:247]
  ds_read_b128 v[132:135], v6 offset:25600
  v_mfma_f32_16x16x32_bf16 v[248:251], a[168:171], v[104:107], v[248:251]
  v_mfma_f32_16x16x32_bf16 v[252:255], a[168:171], v[108:111], v[252:255]
  s_waitcnt lgkmcnt(4)
  v_mfma_f32_16x16x32_bf16 v[232:235], a[28:31], v[112:115], v[232:235]
  ds_read_b128 v[136:139], v6 offset:10240
  v_mfma_f32_16x16x32_bf16 v[236:239], a[28:31], v[116:119], v[236:239]
  ds_read_b128 v[140:143], v6 offset:26624
  v_mfma_f32_16x16x32_bf16 v[240:243], a[100:103], v[112:115], v[240:243]
  ds_read_b128 v[144:147], v6 offset:11264
  v_mfma_f32_16x16x32_bf16 v[244:247], a[100:103], v[116:119], v[244:247]
  ds_read_b128 v[148:151], v6 offset:27648
  v_mfma_f32_16x16x32_bf16 v[248:251], a[172:175], v[112:115], v[248:251]
  v_mfma_f32_16x16x32_bf16 v[252:255], a[172:175], v[116:119], v[252:255]
  s_waitcnt lgkmcnt(4)
  v_mfma_f32_16x16x32_bf16 v[232:235], a[32:35], v[120:123], v[232:235]
  ds_read_b128 v[152:155], v6 offset:12288
  v_mfma_f32_16x16x32_bf16 v[236:239], a[32:35], v[124:127], v[236:239]
  ds_read_b128 v[156:159], v6 offset:28672
  v_mfma_f32_16x16x32_bf16 v[240:243], a[104:107], v[120:123], v[240:243]
  ds_read_b128 v[160:163], v6 offset:13312
  v_mfma_f32_16x16x32_bf16 v[244:247], a[104:107], v[124:127], v[244:247]
  ds_read_b128 v[164:167], v6 offset:29696
  v_mfma_f32_16x16x32_bf16 v[248:251], a[176:179], v[120:123], v[248:251]
  v_mfma_f32_16x16x32_bf16 v[252:255], a[176:179], v[124:127], v[252:255]
  s_waitcnt lgkmcnt(4)
  v_mfma_f32_16x16x32_bf16 v[232:235], a[36:39], v[128:131], v[232:235]
  ds_read_b128 v[168:171], v6 offset:14336
  v_mfma_f32_16x16x32_bf16 v[236:239], a[36:39], v[132:135], v[236:239]
  ds_read_b128 v[172:175], v6 offset:30720
  v_mfma_f32_16x16x32_bf16 v[240:243], a[108:111], v[128:131], v[240:243]
  ds_read_b128 v[176:179], v6 offset:15360
  v_mfma_f32_16x16x32_bf16 v[244:247], a[108:111], v[132:135], v[244:247]
  ds_read_b128 v[180:183], v6 offset:31744
  v_mfma_f32_16x16x32_bf16 v[248:251], a[180:183], v[128:131], v[248:251]
  v_mfma_f32_16x16x32_bf16 v[252:255], a[180:183], v[132:135], v[252:255]
  s_waitcnt lgkmcnt(4)
  v_mfma_f32_16x16x32_bf16 v[232:235], a[40:43], v[136:139], v[232:235]
  ds_read2_b32 v[184:185], v7 offset0:0 offset1:32
  v_mfma_f32_16x16x32_bf16 v[236:239], a[40:43], v[140:143], v[236:239]
  ds_read2_b32 v[186:187], v7 offset0:64 offset1:96
  v_mfma_f32_16x16x32_bf16 v[240:243], a[112:115], v[136:139], v[240:243]
  ds_read2_b32 v[188:189], v7 offset0:16 offset1:48
  v_mfma_f32_16x16x32_bf16 v[244:247], a[112:115], v[140:143], v[244:247]
  ds_read2_b32 v[190:191], v7 offset0:80 offset1:112
  v_mfma_f32_16x16x32_bf16 v[248:251], a[184:187], v[136:139], v[248:251]
  v_mfma_f32_16x16x32_bf16 v[252:255], a[184:187], v[140:143], v[252:255]
  s_waitcnt lgkmcnt(4)
  v_mfma_f32_16x16x32_bf16 v[232:235], a[44:47], v[144:147], v[232:235]
  ds_read2_b32 v[192:193], v8 offset0:0 offset1:32
  v_mfma_f32_16x16x32_bf16 v[236:239], a[44:47], v[148:151], v[236:239]
  ds_read2_b32 v[194:195], v8 offset0:64 offset1:96
  v_mfma_f32_16x16x32_bf16 v[240:243], a[116:119], v[144:147], v[240:243]
  ds_read2_b32 v[196:197], v8 offset0:16 offset1:48
  v_mfma_f32_16x16x32_bf16 v[244:247], a[116:119], v[148:151], v[244:247]
  ds_read2_b32 v[198:199], v8 offset0:80 offset1:112
  v_mfma_f32_16x16x32_bf16 v[248:251], a[188:191], v[144:147], v[248:251]
  v_mfma_f32_16x16x32_bf16 v[252:255], a[188:191], v[148:151], v[252:255]
  s_waitcnt lgkmcnt(4)
  v_mfma_f32_16x16x32_bf16 v[232:235], a[48:51], v[152:155], v[232:235]
  v_mfma_f32_16x16x32_bf16 v[236:239], a[48:51], v[156:159], v[236:239]
  v_mfma_f32_16x16x32_bf16 v[232:235], a[52:55], v[160:163], v[232:235]
  v_mfma_f32_16x16x32_bf16 v[236:239], a[52:55], v[164:167], v[236:239]
  v_mfma_f32_16x16x32_bf16 v[232:235], a[56:59], v[168:171], v[232:235]
  v_mfma_f32_16x16x32_bf16 v[236:239], a[56:59], v[172:175], v[236:239]
  s_waitcnt lgkmcnt(0)
  v_mfma_f32_16x16x32_bf16 v[232:235], a[60:63], v[176:179], v[232:235]
  v_mfma_f32_16x16x32_bf16 v[236:239], a[60:63], v[180:183], v[236:239]
  v_mfma_f32_16x16x32_bf16 v[232:235], a[64:67], v[184:187], v[232:235]
  v_mfma_f32_16x16x32_bf16 v[236:239], a[64:67], v[188:191], v[236:239]
  v_mfma_f32_16x16x32_bf16 v[232:235], a[68:71], v[192:195], v[232:235]
  v_mfma_f32_16x16x32_bf16 v[236:239], a[68:71], v[196:199], v[236:239]
  v_mfma_f32_16x16x32_bf16 v[240:243], a[120:123], v[152:155], v[240:243]
  v_mfma_f32_16x16x32_bf16 v[244:247], a[120:123], v[156:159], v[244:247]
  v_mfma_f32_16x16x32_bf16 v[240:243], a[124:127], v[160:163], v[240:243]
  v_mfma_f32_16x16x32_bf16 v[244:247], a[124:127], v[164:167], v[244:247]
  v_mfma_f32_16x16x32_bf16 v[240:243], a[128:131], v[168:171], v[240:243]
  v_mfma_f32_16x16x32_bf16 v[244:247], a[128:131], v[172:175], v[244:247]
  v_mfma_f32_16x16x32_bf16 v[240:243], a[132:135], v[176:179], v[240:243]
  v_mfma_f32_16x16x32_bf16 v[244:247], a[132:135], v[180:183], v[244:247]
  v_permlane16_swap_b32 v232, v236
  v_permlane16_swap_b32 v233, v237
  v_mfma_f32_16x16x32_bf16 v[240:243], a[136:139], v[184:187], v[240:243]
  v_permlane16_swap_b32 v234, v238
  v_permlane16_swap_b32 v235, v239
  v_mfma_f32_16x16x32_bf16 v[244:247], a[136:139], v[188:191], v[244:247]
  v_add_f32 v9, v9, v232
  v_fmac_f32 v10, v232, v232
  v_mfma_f32_16x16x32_bf16 v[240:243], a[140:143], v[192:195], v[240:243]
  v_cvt_pk_bf16_f32 v16, v232, v233
  v_add_f32 v9, v9, v233
  v_mfma_f32_16x16x32_bf16 v[244:247], a[140:143], v[196:199], v[244:247]
  v_cvt_pk_bf16_f32 v17, v234, v235
  v_fmac_f32 v10, v233, v233
  v_mfma_f32_16x16x32_bf16 v[248:251], a[192:195], v[152:155], v[248:251]
  v_cvt_pk_bf16_f32 v18, v236, v237
  v_add_f32 v9, v9, v234
  v_mfma_f32_16x16x32_bf16 v[252:255], a[192:195], v[156:159], v[252:255]
  v_cvt_pk_bf16_f32 v19, v238, v239
  v_fmac_f32 v10, v234, v234
  v_mfma_f32_16x16x32_bf16 v[248:251], a[196:199], v[160:163], v[248:251]
  buffer_store_dwordx4 v[16:19], v5, s[12:15], s36 offen offset:0 sc1
  v_mfma_f32_16x16x32_bf16 v[252:255], a[196:199], v[164:167], v[252:255]
  v_add_f32 v9, v9, v235
  v_fmac_f32 v10, v235, v235
  v_mfma_f32_16x16x32_bf16 v[248:251], a[200:203], v[168:171], v[248:251]
  v_add_f32 v9, v9, v236
  v_fmac_f32 v10, v236, v236
  v_mfma_f32_16x16x32_bf16 v[252:255], a[200:203], v[172:175], v[252:255]
  v_permlane16_swap_b32 v240, v244
  v_permlane16_swap_b32 v241, v245
  v_mfma_f32_16x16x32_bf16 v[248:251], a[204:207], v[176:179], v[248:251]
  v_permlane16_swap_b32 v242, v246
  v_permlane16_swap_b32 v243, v247
  v_mfma_f32_16x16x32_bf16 v[252:255], a[204:207], v[180:183], v[252:255]
  v_cvt_pk_bf16_f32 v20, v240, v241
  v_cvt_pk_bf16_f32 v21, v242, v243
  v_mfma_f32_16x16x32_bf16 v[248:251], a[208:211], v[184:187], v[248:251]
  v_cvt_pk_bf16_f32 v22, v244, v245
  v_cvt_pk_bf16_f32 v23, v246, v247
  v_mfma_f32_16x16x32_bf16 v[252:255], a[208:211], v[188:191], v[252:255]
  buffer_store_dwordx4 v[20:23], v5, s[12:15], s36 offen offset:512 sc1
  v_mfma_f32_16x16x32_bf16 v[248:251], a[212:215], v[192:195], v[248:251]
  v_add_f32 v9, v9, v237
  v_fmac_f32 v10, v237, v237
  v_mfma_f32_16x16x32_bf16 v[252:255], a[212:215], v[196:199], v[252:255]
  v_add_f32 v9, v9, v238
  v_fmac_f32 v10, v238, v238
  v_add_f32 v9, v9, v239
  v_fmac_f32 v10, v239, v239
  v_add_f32 v9, v9, v240
  v_fmac_f32 v10, v240, v240
  v_add_f32 v9, v9, v241
  v_fmac_f32 v10, v241, v241
  v_add_f32 v9, v9, v242
  v_fmac_f32 v10, v242, v242
  v_add_f32 v9, v9, v243
  v_fmac_f32 v10, v243, v243
  v_permlane16_swap_b32 v248, v252
  v_permlane16_swap_b32 v249, v253
  v_permlane16_swap_b32 v250, v254
  v_permlane16_swap_b32 v251, v255
  v_cvt_pk_bf16_f32 v24, v248, v249
  v_cvt_pk_bf16_f32 v25, v250, v251
  v_cvt_pk_bf16_f32 v26, v252, v253
  v_cvt_pk_bf16_f32 v27, v254, v255
  buffer_store_dwordx4 v[24:27], v5, s[12:15], s36 offen offset:1024 sc1
  v_add_f32 v9, v9, v244
  v_fmac_f32 v10, v244, v244
  v_add_f32 v9, v9, v245
  v_fmac_f32 v10, v245, v245
  v_add_f32 v9, v9, v246
  v_fmac_f32 v10, v246, v246
  v_add_f32 v9, v9, v247
  v_fmac_f32 v10, v247, v247
  v_add_f32 v9, v9, v248
  v_fmac_f32 v10, v248, v248
  v_add_f32 v9, v9, v249
  v_fmac_f32 v10, v249, v249
  v_add_f32 v9, v9, v250
  v_fmac_f32 v10, v250, v250
  v_add_f32 v9, v9, v251
  v_fmac_f32 v10, v251, v251
  v_add_f32 v9, v9, v252
  v_fmac_f32 v10, v252, v252
  v_add_f32 v9, v9, v253
  v_fmac_f32 v10, v253, v253
  v_add_f32 v9, v9, v254
  v_fmac_f32 v10, v254, v254
  v_add_f32 v9, v9, v255
  v_fmac_f32 v10, v255, v255
  s_add_u32 s38, s59, s26
  s_add_u32 s38, s38, 40370176
  v_permlane32_swap_b32 v9, v10
  s_nop 0
  v_add_f32 v9, v9, v10
  buffer_store_dword v9, v13, s[12:15], s38 offen sc1
  s_lshl_b32 s60, s29, 11
  s_add_u32 s60, s60, s27
  s_add_u32 s60, s60, 65920
  s_waitcnt vmcnt(0) lgkmcnt(0)
o_bar:
  s_barrier
  s_cmp_lg_u32 s33, 0
  s_cbranch_scc1 o_sig
  s_mov_b64 exec, 1
  buffer_atomic_add v3, v2, s[12:15], s60 offen sc1
  s_mov_b64 exec, -1
o_sig:
  s_mul_i32 s43, s33, 9216
  s_add_u32 s43, s43, 110592
  s_mov_b32 m0, s43
  s_mul_i32 s39, s28, 36864
  buffer_load_dwordx4 v1, s[16:19], s43 offen sc1 lds
  v_bfe_u32 v48, v0, 4, 1
  v_bfe_u32 v49, v0, 5, 1
  v_mul_u32_u24 v156, 18432, v48
  v_lshl_add_u32 v156, v49, 8, v156
  v_and_b32 v48, 15, v0
  v_lshl_add_u32 v156, v48, 4, v156
  s_mul_i32 s45, s33, 9216
  s_mov_b32 s44, 0
  s_mul_i32 s34, s24, 0
  s_add_u32 s34, s34, 0
  s_mul_i32 s35, s34, 43
  s_lshr_b32 s35, s35, 7
  s_mul_i32 s35, s35, 3
  s_sub_u32 s34, s34, s35
  buffer_load_dwordx4 v1, s[16:19], s43 offen offset:1024 sc1 lds
  s_mul_i32 s34, s34, 3072
  s_add_u32 s48, s34, s45
  s_add_u32 s51, s48, 36864
  v_add_u32 v7, s48, v1
  s_mul_i32 s34, s24, 0
  s_add_u32 s34, s34, 1
  s_mul_i32 s35, s34, 43
  s_lshr_b32 s35, s35, 7
  s_mul_i32 s35, s35, 3
  s_sub_u32 s34, s34, s35
  s_mul_i32 s34, s34, 3072
  s_add_u32 s49, s34, s45
  s_add_u32 s52, s49, 36864
  v_add_u32 v8, s49, v1
  buffer_load_dwordx4 v1, s[16:19], s43 offen offset:2048 sc1 lds
  s_mul_i32 s34, s24, 0
  s_add_u32 s34, s34, 2
  s_mul_i32 s35, s34, 43
  s_lshr_b32 s35, s35, 7
  s_mul_i32 s35, s35, 3
  s_sub_u32 s34, s34, s35
  s_mul_i32 s34, s34, 3072
  s_add_u32 s50, s34, s45
  s_add_u32 s53, s50, 36864
  v_add_u32 v9, s50, v1
  s_mul_i32 s46, s28, 294912
  s_add_u32 s46, s46, s26
  s_add_u32 s46, s46, 16515072
  s_and_b32 s35, s25, 12
  buffer_load_dwordx4 v1, s[16:19], s43 offen offset:3072 sc1 lds
  s_add_u32 s34, s25, 0
  s_and_b32 s34, s34, 3
  s_add_u32 s34, s34, s35
  s_mul_i32 s34, s34, 18432
  s_add_u32 s34, s34, s46
  v_add_u32 v80, s34, v1
  s_add_u32 s34, s25, 1
  s_and_b32 s34, s34, 3
  s_add_u32 s34, s34, s35
  s_mul_i32 s34, s34, 18432
  s_add_u32 s34, s34, s46
  v_add_u32 v81, s34, v1
  s_add_u32 s34, s25, 2
  s_and_b32 s34, s34, 3
  s_add_u32 m0, m0, 4096
  s_add_u32 s43, s43, 4096
  buffer_load_dwordx4 v1, s[16:19], s43 offen sc1 lds
  s_add_u32 s34, s34, s35
  s_mul_i32 s34, s34, 18432
  s_add_u32 s34, s34, s46
  v_add_u32 v82, s34, v1
  s_add_u32 s34, s25, 3
  s_and_b32 s34, s34, 3
  s_add_u32 s34, s34, s35
  s_mul_i32 s34, s34, 18432
  s_add_u32 s34, s34, s46
  v_add_u32 v83, s34, v1
  s_mul_i32 s34, s25, 18432
  s_add_u32 s46, s46, s34
  s_lshl_b32 s41, s29, 9
  s_add_u32 s41, s41, s27
  buffer_load_dwordx4 v1, s[16:19], s43 offen offset:1024 sc1 lds
  s_add_u32 s41, s41, 32768
  s_and_b32 s37, s25, 3
  s_lshl_b32 s34, s37, 7
  v_mov_b32 v15, s34
  v_mov_b32 v14, 1073741824
  v_cmp_eq_u32 vcc, 0, v0
  s_mov_b32 s47, 3
  s_lshr_b32 s36, s25, 2
  v_cndmask_b32 v15, v14, v15, vcc
  v_mov_b32 v14, 2
  s_mul_i32 s34, s36, 2359296
  s_mul_i32 s35, s28, 36864
  s_add_u32 s34, s34, s35
  s_mul_i32 s35, s37, 4608
  buffer_load_dwordx4 v1, s[16:19], s43 offen offset:2048 sc1 lds
  s_add_u32 s34, s34, s35
  s_add_u32 s34, s34, s26
  s_add_u32 s34, s34, 7077888
  s_lshl_b32 s35, s28, 2
  s_add_u32 s37, s37, s35
  s_lshl_b32 s37, s37, 9
  s_add_u32 s37, s37, s27
  s_add_u32 s37, s37, 65536
  s_cmp_eq_u32 s36, s33
  s_cselect_b32 s34, 1073741824, s34
  s_cmp_eq_u32 s36, s33
  s_cselect_b32 s37, 1073741824, s37
  s_add_u32 s35, s34, 4096
  v_add_u32 v157, 147456, v1
  buffer_load_dwordx4 v1, s[16:19], s43 offen offset:3072 sc1 lds
  v_mov_b32 v228, 0
  v_and_b32 v74, 3, v0
  v_lshlrev_b32 v74, 2, v74
  v_add_u32 v230, 159744, v74
  v_lshlrev_b32 v74, 5, v74
  s_lshl_b32 s38, s33, 2
  s_add_u32 s38, s38, 159744
  v_mov_b32 v229, s38
  ds_write_b32 v229, v228
  s_mul_i32 s38, s28, 3072
  s_add_u32 s38, s38, s26
  s_add_u32 s38, s38, 40370176
  v_add_u32 v5, 73728, v1
  v_add_u32 v6, 110592, v1
  s_add_u32 m0, m0, 4096
  s_add_u32 s43, s43, 4096
  buffer_load_dwordx4 v1, s[16:19], s43 offen sc1 lds
  v_add_u32 v231, 36864, v1
  v_and_b32 v148, 15, v0
  v_lshlrev_b32 v148, 3, v148
  v_add_u32 v148, 156672, v148
  v_bfe_u32 v48, v0, 5, 1
  v_lshl_add_u32 v148, v48, 2, v148
  s_mov_b32 s58, 0x07060302
  s_mov_b32 s43, 147456
  s_add_u32 s42, s33, s26
  s_cmp_lg_u32 s42, 0
  s_cbranch_scc1 f_noext
  s_lshl_b32 s42, s25, 12
  s_mov_b32 m0, 156672
  s_add_u32 s42, s42, 100188160
  buffer_load_dwordx4 v1, s[12:15], s42 offen sc1 lds
  buffer_load_dwordx4 v1, s[12:15], s42 offen offset:1024 sc1 lds
  buffer_load_dwordx4 v1, s[12:15], s42 offen offset:2048 sc1 lds
f_noext:
  s_add_u32 s39, s39, s26
  s_add_u32 s39, s39, 4718592
  s_add_u32 s40, s39, 18432
  s_lshl_b32 s60, s28, 11
  s_add_u32 s60, s60, s27
  s_add_u32 s60, s60, 65920
  buffer_load_dword v4, v2, s[12:15], s60 offen sc1
  s_waitcnt vmcnt(1) lgkmcnt(0)
  s_barrier
  ds_read_b128 a[144:147], v1 offset:0
  ds_read_b128 a[148:151], v1 offset:1024
  ds_read_b128 a[152:155], v231 offset:0
  ds_read_b128 a[156:159], v231 offset:1024
  ds_read_b128 a[160:163], v5 offset:0
  ds_read_b128 a[164:167], v5 offset:1024
  s_waitcnt vmcnt(0)
  v_cmp_gt_u32 vcc, 4, v4
  s_nop 0
  s_cbranch_vccz f_ok
  s_lshl_b32 s60, s28, 11
  s_add_u32 s60, s60, s27
  s_add_u32 s60, s60, 65920
  s_mov_b32 s61, 0x40000
f_poll:
  buffer_load_dword v4, v2, s[12:15], s60 offen sc1
  s_sub_u32 s61, s61, 1
  s_waitcnt vmcnt(0)
  v_cmp_gt_u32 vcc, 4, v4
  s_cbranch_scc1 f_ok
  s_cbranch_vccnz f_poll
f_ok:
  buffer_load_dwordx4 a[0:3], v1, s[12:15], s39 offen sc1
  buffer_load_dwordx4 a[4:7], v1, s[12:15], s40 offen sc1
  buffer_load_dwordx4 a[8:11], v1, s[12:15], s39 offen offset:1024 sc1
  buffer_load_dwordx4 a[12:15], v1, s[12:15], s40 offen offset:1024 sc1
  buffer_load_dwordx4 a[16:19], v1, s[12:15], s39 offen offset:2048 sc1
  buffer_load_dwordx4 a[20:23], v1, s[12:15], s40 offen offset:2048 sc1
  buffer_load_dwordx4 a[24:27], v1, s[12:15], s39 offen offset:3072 sc1
  s_add_u32 s39, s39, 4096
  buffer_load_dwordx4 a[28:31], v1, s[12:15], s40 offen offset:3072 sc1
  s_add_u32 s40, s40, 4096
  s_waitcnt vmcnt(6) lgkmcnt(3)
  v_mfma_f32_16x16x32_bf16 v[16:19], a[144:147], a[0:3], 0
  ds_read_b128 a[168:171], v1 offset:2048
  v_mfma_f32_16x16x32_bf16 v[20:23], a[144:147], a[4:7], 0
  buffer_load_dwordx4 a[32:35], v1, s[12:15], s39 offen sc1
  v_mfma_f32_16x16x32_bf16 v[24:27], a[148:151], a[0:3], 0
  ds_read_b128 a[172:175], v1 offset:3072
  v_mfma_f32_16x16x32_bf16 v[28:31], a[148:151], a[4:7], 0
  ds_read2_b32 v[140:141], v148 offset0:0 offset1:0
  v_mfma_f32_16x16x32_bf16 v[32:35], a[152:155], a[0:3], 0
  ds_read_b128 a[176:179], v231 offset:2048
  v_mfma_f32_16x16x32_bf16 v[36:39], a[152:155], a[4:7], 0
  s_waitcnt lgkmcnt(3)
  v_mfma_f32_16x16x32_bf16 v[40:43], a[156:159], a[0:3], 0
  ds_read_b128 a[180:183], v231 offset:3072
  v_mfma_f32_16x16x32_bf16 v[44:47], a[156:159], a[4:7], 0
  buffer_load_dwordx4 a[36:39], v1, s[12:15], s40 offen sc1
  v_mfma_f32_16x16x32_bf16 v[192:195], a[160:163], a[0:3], 0
  ds_read_b128 a[184:187], v5 offset:2048
  v_mfma_f32_16x16x32_bf16 v[196:199], a[160:163], a[4:7], 0
  v_mfma_f32_16x16x32_bf16 v[200:203], a[164:167], a[0:3], 0
  ds_read_b128 a[188:191], v5 offset:3072
  v_mfma_f32_16x16x32_bf16 v[204:207], a[164:167], a[4:7], 0
  s_waitcnt vmcnt(6) lgkmcnt(3)
  v_mfma_f32_16x16x32_bf16 v[16:19], a[168:171], a[8:11], v[16:19]
  ds_read_b128 a[144:147], v1 offset:4096
  v_mfma_f32_16x16x32_bf16 v[20:23], a[168:171], a[12:15], v[20:23]
  buffer_load_dwordx4 a[40:43], v1, s[12:15], s39 offen offset:1024 sc1
  v_mfma_f32_16x16x32_bf16 v[24:27], a[172:175], a[8:11], v[24:27]
  ds_read_b128 a[148:151], v1 offset:5120
  v_mfma_f32_16x16x32_bf16 v[28:31], a[172:175], a[12:15], v[28:31]
  buffer_load_dwordx4 v[84:87], v1, s[12:15], s38 offen offset:0 sc1
  v_mfma_f32_16x16x32_bf16 v[32:35], a[176:179], a[8:11], v[32:35]
  ds_read_b128 a[152:155], v231 offset:4096
  v_mfma_f32_16x16x32_bf16 v[36:39], a[176:179], a[12:15], v[36:39]
  s_waitcnt lgkmcnt(3)
  v_mfma_f32_16x16x32_bf16 v[40:43], a[180:183], a[8:11], v[40:43]
  ds_read_b128 a[156:159], v231 offset:5120
  v_mfma_f32_16x16x32_bf16 v[44:47], a[180:183], a[12:15], v[44:47]
  buffer_load_dwordx4 a[44:47], v1, s[12:15], s40 offen offset:1024 sc1
  v_mfma_f32_16x16x32_bf16 v[192:195], a[184:187], a[8:11], v[192:195]
  ds_read_b128 a[160:163], v5 offset:4096
  v_mfma_f32_16x16x32_bf16 v[196:199], a[184:187], a[12:15], v[196:199]
  v_mfma_f32_16x16x32_bf16 v[200:203], a[188:191], a[8:11], v[200:203]
  ds_read_b128 a[164:167], v5 offset:5120
  v_mfma_f32_16x16x32_bf16 v[204:207], a[188:191], a[12:15], v[204:207]
  s_waitcnt vmcnt(7) lgkmcnt(3)
  v_mfma_f32_16x16x32_bf16 v[16:19], a[144:147], a[16:19], v[16:19]
  ds_read_b128 a[168:171], v1 offset:6144
  v_mfma_f32_16x16x32_bf16 v[20:23], a[144:147], a[20:23], v[20:23]
  buffer_load_dwordx4 a[48:51], v1, s[12:15], s39 offen offset:2048 sc1
  v_mfma_f32_16x16x32_bf16 v[24:27], a[148:151], a[16:19], v[24:27]
  ds_read_b128 a[172:175], v1 offset:7168
  v_mfma_f32_16x16x32_bf16 v[28:31], a[148:151], a[20:23], v[28:31]
  ds_read2_b32 v[142:143], v148 offset0:32 offset1:32
  v_mfma_f32_16x16x32_bf16 v[32:35], a[152:155], a[16:19], v[32:35]
  ds_read_b128 a[176:179], v231 offset:6144
  v_mfma_f32_16x16x32_bf16 v[36:39], a[152:155], a[20:23], v[36:39]
  s_waitcnt lgkmcnt(3)
  v_mfma_f32_16x16x32_bf16 v[40:43], a[156:159], a[16:19], v[40:43]
  ds_read_b128 a[180:183], v231 offset:7168
  v_mfma_f32_16x16x32_bf16 v[44:47], a[156:159], a[20:23], v[44:47]
  buffer_load_dwordx4 a[52:55], v1, s[12:15], s40 offen offset:2048 sc1
  v_mfma_f32_16x16x32_bf16 v[192:195], a[160:163], a[16:19], v[192:195]
  ds_read_b128 a[184:187], v5 offset:6144
  v_mfma_f32_16x16x32_bf16 v[196:199], a[160:163], a[20:23], v[196:199]
  v_mfma_f32_16x16x32_bf16 v[200:203], a[164:167], a[16:19], v[200:203]
  ds_read_b128 a[188:191], v5 offset:7168
  v_mfma_f32_16x16x32_bf16 v[204:207], a[164:167], a[20:23], v[204:207]
  s_waitcnt vmcnt(7) lgkmcnt(3)
  v_mfma_f32_16x16x32_bf16 v[16:19], a[168:171], a[24:27], v[16:19]
  ds_read_b128 a[144:147], v1 offset:8192
  v_mfma_f32_16x16x32_bf16 v[20:23], a[168:171], a[28:31], v[20:23]
  buffer_load_dwordx4 a[56:59], v1, s[12:15], s39 offen offset:3072 sc1
  v_mfma_f32_16x16x32_bf16 v[24:27], a[172:175], a[24:27], v[24:27]
  ds_read_b128 a[148:151], v1 offset:9216
  s_add_u32 s39, s39, 4096
  v_mfma_f32_16x16x32_bf16 v[28:31], a[172:175], a[28:31], v[28:31]
  buffer_load_dwordx4 v[88:91], v1, s[12:15], s38 offen offset:1024 sc1
  v_mfma_f32_16x16x32_bf16 v[32:35], a[176:179], a[24:27], v[32:35]
  ds_read_b128 a[152:155], v231 offset:8192
  v_mfma_f32_16x16x32_bf16 v[36:39], a[176:179], a[28:31], v[36:39]
  s_waitcnt lgkmcnt(3)
  v_mfma_f32_16x16x32_bf16 v[40:43], a[180:183], a[24:27], v[40:43]
  ds_read_b128 a[156:159], v231 offset:9216
  v_mfma_f32_16x16x32_bf16 v[44:47], a[180:183], a[28:31], v[44:47]
  buffer_load_dwordx4 a[60:63], v1, s[12:15], s40 offen offset:3072 sc1
  v_mfma_f32_16x16x32_bf16 v[192:195], a[184:187], a[24:27], v[192:195]
  ds_read_b128 a[160:163], v5 offset:8192
  s_add_u32 s40, s40, 4096
  v_mfma_f32_16x16x32_bf16 v[196:199], a[184:187], a[28:31], v[196:199]
  v_mfma_f32_16x16x32_bf16 v[200:203], a[188:191], a[24:27], v[200:203]
  ds_read_b128 a[164:167], v5 offset:9216
  v_mfma_f32_16x16x32_bf16 v[204:207], a[188:191], a[28:31], v[204:207]
  s_waitcnt vmcnt(8) lgkmcnt(3)
  v_mfma_f32_16x16x32_bf16 v[16:19], a[144:147], a[32:35], v[16:19]
  ds_read_b128 a[168:171], v1 offset:10240
  v_mfma_f32_16x16x32_bf16 v[20:23], a[144:147], a[36:39], v[20:23]
  buffer_load_dwordx4 a[64:67], v1, s[12:15], s39 offen sc1
  v_mfma_f32_16x16x32_bf16 v[24:27], a[148:151], a[32:35], v[24:27]
  ds_read_b128 a[172:175], v1 offset:11264
  v_mfma_f32_16x16x32_bf16 v[28:31], a[148:151], a[36:39], v[28:31]
  ds_read2_b32 v[144:145], v148 offset0:64 offset1:64
  v_mfma_f32_16x16x32_bf16 v[32:35], a[152:155], a[32:35], v[32:35]
  ds_read_b128 a[176:179], v231 offset:10240
  v_mfma_f32_16x16x32_bf16 v[36:39], a[152:155], a[36:39], v[36:39]
  s_waitcnt lgkmcnt(3)
  v_mfma_f32_16x16x32_bf16 v[40:43], a[156:159], a[32:35], v[40:43]
  ds_read_b128 a[180:183], v231 offset:11264
  v_mfma_f32_16x16x32_bf16 v[44:47], a[156:159], a[36:39], v[44:47]
  buffer_load_dwordx4 a[68:71], v1, s[12:15], s40 offen sc1
  v_mfma_f32_16x16x32_bf16 v[192:195], a[160:163], a[32:35], v[192:195]
  ds_read_b128 a[184:187], v5 offset:10240
  v_mfma_f32_16x16x32_bf16 v[196:199], a[160:163], a[36:39], v[196:199]
  v_mfma_f32_16x16x32_bf16 v[200:203], a[164:167], a[32:35], v[200:203]
  ds_read_b128 a[188:191], v5 offset:11264
  v_mfma_f32_16x16x32_bf16 v[204:207], a[164:167], a[36:39], v[204:207]
  s_waitcnt vmcnt(7) lgkmcnt(3)
  v_mfma_f32_16x16x32_bf16 v[16:19], a[168:171], a[40:43], v[16:19]
  ds_read_b128 a[144:147], v1 offset:12288
  v_mfma_f32_16x16x32_bf16 v[20:23], a[168:171], a[44:47], v[20:23]
  buffer_load_dwordx4 a[72:75], v1, s[12:15], s39 offen offset:1024 sc1
  v_mfma_f32_16x16x32_bf16 v[24:27], a[172:175], a[40:43], v[24:27]
  ds_read_b128 a[148:151], v1 offset:13312
  v_mfma_f32_16x16x32_bf16 v[28:31], a[172:175], a[44:47], v[28:31]
  buffer_load_dwordx4 v[92:95], v1, s[12:15], s38 offen offset:2048 sc1
  v_mfma_f32_16x16x32_bf16 v[32:35], a[176:179], a[40:43], v[32:35]
  ds_read_b128 a[152:155], v231 offset:12288
  v_mfma_f32_16x16x32_bf16 v[36:39], a[176:179], a[44:47], v[36:39]
  s_waitcnt lgkmcnt(3)
  v_mfma_f32_16x16x32_bf16 v[40:43], a[180:183], a[40:43], v[40:43]
  ds_read_b128 a[156:159], v231 offset:13312
  v_mfma_f32_16x16x32_bf16 v[44:47], a[180:183], a[44:47], v[44:47]
  buffer_load_dwordx4 a[76:79], v1, s[12:15], s40 offen offset:1024 sc1
  v_mfma_f32_16x16x32_bf16 v[192:195], a[184:187], a[40:43], v[192:195]
  ds_read_b128 a[160:163], v5 offset:12288
  v_mfma_f32_16x16x32_bf16 v[196:199], a[184:187], a[44:47], v[196:199]
  v_mfma_f32_16x16x32_bf16 v[200:203], a[188:191], a[40:43], v[200:203]
  ds_read_b128 a[164:167], v5 offset:13312
  v_mfma_f32_16x16x32_bf16 v[204:207], a[188:191], a[44:47], v[204:207]
  s_waitcnt vmcnt(8) lgkmcnt(3)
  v_mfma_f32_16x16x32_bf16 v[16:19], a[144:147], a[48:51], v[16:19]
  ds_read_b128 a[168:171], v1 offset:14336
  v_mfma_f32_16x16x32_bf16 v[20:23], a[144:147], a[52:55], v[20:23]
  buffer_load_dwordx4 a[80:83], v1, s[12:15], s39 offen offset:2048 sc1
  v_mfma_f32_16x16x32_bf16 v[24:27], a[148:151], a[48:51], v[24:27]
  ds_read_b128 a[172:175], v1 offset:15360
  v_mfma_f32_16x16x32_bf16 v[28:31], a[148:151], a[52:55], v[28:31]
  ds_read2_b32 v[146:147], v148 offset0:96 offset1:96
  v_mfma_f32_16x16x32_bf16 v[32:35], a[152:155], a[48:51], v[32:35]
  ds_read_b128 a[176:179], v231 offset:14336
  v_mfma_f32_16x16x32_bf16 v[36:39], a[152:155], a[52:55], v[36:39]
  s_waitcnt lgkmcnt(3)
  v_mfma_f32_16x16x32_bf16 v[40:43], a[156:159], a[48:51], v[40:43]
  ds_read_b128 a[180:183], v231 offset:15360
  v_mfma_f32_16x16x32_bf16 v[44:47], a[156:159], a[52:55], v[44:47]
  buffer_load_dwordx4 a[84:87], v1, s[12:15], s40 offen offset:2048 sc1
  v_mfma_f32_16x16x32_bf16 v[192:195], a[160:163], a[48:51], v[192:195]
  ds_read_b128 a[184:187], v5 offset:14336
  v_mfma_f32_16x16x32_bf16 v[196:199], a[160:163], a[52:55], v[196:199]
  v_mfma_f32_16x16x32_bf16 v[200:203], a[164:167], a[48:51], v[200:203]
  ds_read_b128 a[188:191], v5 offset:15360
  v_mfma_f32_16x16x32_bf16 v[204:207], a[164:167], a[52:55], v[204:207]
  s_waitcnt vmcnt(7) lgkmcnt(3)
  v_mfma_f32_16x16x32_bf16 v[16:19], a[168:171], a[56:59], v[16:19]
  ds_read_b128 a[144:147], v1 offset:16384
  v_mfma_f32_16x16x32_bf16 v[20:23], a[168:171], a[60:63], v[20:23]
  buffer_load_dwordx4 a[88:91], v1, s[12:15], s39 offen offset:3072 sc1
  v_mfma_f32_16x16x32_bf16 v[24:27], a[172:175], a[56:59], v[24:27]
  ds_read_b128 a[148:151], v1 offset:17408
  s_add_u32 s39, s39, 4096
  v_mfma_f32_16x16x32_bf16 v[28:31], a[172:175], a[60:63], v[28:31]
  v_mfma_f32_16x16x32_bf16 v[32:35], a[176:179], a[56:59], v[32:35]
  ds_read_b128 a[152:155], v231 offset:16384
  v_mfma_f32_16x16x32_bf16 v[36:39], a[176:179], a[60:63], v[36:39]
  s_waitcnt lgkmcnt(3)
  v_mfma_f32_16x16x32_bf16 v[40:43], a[180:183], a[56:59], v[40:43]
  ds_read_b128 a[156:159], v231 offset:17408
  v_mfma_f32_16x16x32_bf16 v[44:47], a[180:183], a[60:63], v[44:47]
  buffer_load_dwordx4 a[92:95], v1, s[12:15], s40 offen offset:3072 sc1
  v_mfma_f32_16x16x32_bf16 v[192:195], a[184:187], a[56:59], v[192:195]
  ds_read_b128 a[160:163], v5 offset:16384
  s_add_u32 s40, s40, 4096
  v_mfma_f32_16x16x32_bf16 v[196:199], a[184:187], a[60:63], v[196:199]
  v_mfma_f32_16x16x32_bf16 v[200:203], a[188:191], a[56:59], v[200:203]
  ds_read_b128 a[164:167], v5 offset:17408
  v_mfma_f32_16x16x32_bf16 v[204:207], a[188:191], a[60:63], v[204:207]
  s_waitcnt vmcnt(7) lgkmcnt(3)
  v_mfma_f32_16x16x32_bf16 v[16:19], a[144:147], a[64:67], v[16:19]
  ds_read_b128 a[168:171], v1 offset:18432
  v_mfma_f32_16x16x32_bf16 v[20:23], a[144:147], a[68:71], v[20:23]
  buffer_load_dwordx4 a[96:99], v1, s[12:15], s39 offen sc1
  v_mfma_f32_16x16x32_bf16 v[24:27], a[148:151], a[64:67], v[24:27]
  ds_read_b128 a[172:175], v1 offset:19456
  v_mfma_f32_16x16x32_bf16 v[28:31], a[148:151], a[68:71], v[28:31]
  v_mfma_f32_16x16x32_bf16 v[32:35], a[152:155], a[64:67], v[32:35]
  ds_read_b128 a[176:179], v231 offset:18432
  v_add_u32 v148, 512, v148
  v_mfma_f32_16x16x32_bf16 v[36:39], a[152:155], a[68:71], v[36:39]
  s_waitcnt lgkmcnt(3)
  v_mfma_f32_16x16x32_bf16 v[40:43], a[156:159], a[64:67], v[40:43]
  ds_read_b128 a[180:183], v231 offset:19456
  v_mfma_f32_16x16x32_bf16 v[44:47], a[156:159], a[68:71], v[44:47]
  buffer_load_dwordx4 a[100:103], v1, s[12:15], s40 offen sc1
  v_mfma_f32_16x16x32_bf16 v[192:195], a[160:163], a[64:67], v[192:195]
  ds_read_b128 a[184:187], v5 offset:18432
  v_mfma_f32_16x16x32_bf16 v[196:199], a[160:163], a[68:71], v[196:199]
  v_mfma_f32_16x16x32_bf16 v[200:203], a[164:167], a[64:67], v[200:203]
  ds_read_b128 a[188:191], v5 offset:19456
  v_mfma_f32_16x16x32_bf16 v[204:207], a[164:167], a[68:71], v[204:207]
  s_waitcnt vmcnt(6) lgkmcnt(3)
  v_mfma_f32_16x16x32_bf16 v[16:19], a[168:171], a[72:75], v[16:19]
  ds_read_b128 a[144:147], v1 offset:20480
  v_mfma_f32_16x16x32_bf16 v[20:23], a[168:171], a[76:79], v[20:23]
  buffer_load_dwordx4 a[104:107], v1, s[12:15], s39 offen offset:1024 sc1
  v_mfma_f32_16x16x32_bf16 v[24:27], a[172:175], a[72:75], v[24:27]
  ds_read_b128 a[148:151], v1 offset:21504
  v_mfma_f32_16x16x32_bf16 v[28:31], a[172:175], a[76:79], v[28:31]
  v_mfma_f32_16x16x32_bf16 v[32:35], a[176:179], a[72:75], v[32:35]
  ds_read_b128 a[152:155], v231 offset:20480
  v_mfma_f32_16x16x32_bf16 v[36:39], a[176:179], a[76:79], v[36:39]
  s_waitcnt lgkmcnt(3)
  v_mfma_f32_16x16x32_bf16 v[40:43], a[180:183], a[72:75], v[40:43]
  ds_read_b128 a[156:159], v231 offset:21504
  v_mfma_f32_16x16x32_bf16 v[44:47], a[180:183], a[76:79], v[44:47]
  buffer_load_dwordx4 a[108:111], v1, s[12:15], s40 offen offset:1024 sc1
  v_mfma_f32_16x16x32_bf16 v[192:195], a[184:187], a[72:75], v[192:195]
  ds_read_b128 a[160:163], v5 offset:20480
  v_mfma_f32_16x16x32_bf16 v[196:199], a[184:187], a[76:79], v[196:199]
  v_mfma_f32_16x16x32_bf16 v[200:203], a[188:191], a[72:75], v[200:203]
  ds_read_b128 a[164:167], v5 offset:21504
  v_mfma_f32_16x16x32_bf16 v[204:207], a[188:191], a[76:79], v[204:207]
  s_waitcnt vmcnt(6) lgkmcnt(3)
  v_mfma_f32_16x16x32_bf16 v[16:19], a[144:147], a[80:83], v[16:19]
  ds_read_b128 a[168:171], v1 offset:22528
  v_add_f32 v84, v84, v88
  v_mfma_f32_16x16x32_bf16 v[20:23], a[144:147], a[84:87], v[20:23]
  buffer_load_dwordx4 a[112:115], v1, s[12:15], s39 offen offset:2048 sc1
  v_mfma_f32_16x16x32_bf16 v[24:27], a[148:151], a[80:83], v[24:27]
  ds_read_b128 a[172:175], v1 offset:23552
  v_add_f32 v85, v85, v89
  v_mfma_f32_16x16x32_bf16 v[28:31], a[148:151], a[84:87], v[28:31]
  v_add_f32 v86, v86, v90
  v_add_f32 v87, v87, v91
  v_mfma_f32_16x16x32_bf16 v[32:35], a[152:155], a[80:83], v[32:35]
  ds_read_b128 a[176:179], v231 offset:22528
  v_add_f32 v84, v84, v92
  v_mfma_f32_16x16x32_bf16 v[36:39], a[152:155], a[84:87], v[36:39]
  s_waitcnt lgkmcnt(3)
  v_add_f32 v85, v85, v93
  v_add_f32 v86, v86, v94
  v_mfma_f32_16x16x32_bf16 v[40:43], a[156:159], a[80:83], v[40:43]
  ds_read_b128 a[180:183], v231 offset:23552
  v_add_f32 v87, v87, v95
  v_mfma_f32_16x16x32_bf16 v[44:47], a[156:159], a[84:87], v[44:47]
  buffer_load_dwordx4 a[116:119], v1, s[12:15], s40 offen offset:2048 sc1
  v_mfma_f32_16x16x32_bf16 v[192:195], a[160:163], a[80:83], v[192:195]
  ds_read_b128 a[184:187], v5 offset:22528
  v_permlane32_swap_b32 v84, v85
  v_mfma_f32_16x16x32_bf16 v[196:199], a[160:163], a[84:87], v[196:199]
  v_permlane32_swap_b32 v86, v87
  v_mfma_f32_16x16x32_bf16 v[200:203], a[164:167], a[80:83], v[200:203]
  ds_read_b128 a[188:191], v5 offset:23552
  v_add_f32 v84, v84, v85
  v_mfma_f32_16x16x32_bf16 v[204:207], a[164:167], a[84:87], v[204:207]
  s_waitcnt vmcnt(6) lgkmcnt(3)
  v_add_f32 v86, v86, v87
  v_mfma_f32_16x16x32_bf16 v[16:19], a[168:171], a[88:91], v[16:19]
  ds_read_b128 a[144:147], v1 offset:24576
  v_mfma_f32_16x16x32_bf16 v[20:23], a[168:171], a[92:95], v[20:23]
  buffer_load_dwordx4 a[120:123], v1, s[12:15], s39 offen offset:3072 sc1
  v_mfma_f32_16x16x32_bf16 v[24:27], a[172:175], a[88:91], v[24:27]
  ds_read_b128 a[148:151], v1 offset:25600
  s_add_u32 s39, s39, 4096
  v_mfma_f32_16x16x32_bf16 v[28:31], a[172:175], a[92:95], v[28:31]
  v_permlane16_swap_b32 v84, v86
  v_mfma_f32_16x16x32_bf16 v[32:35], a[176:179], a[88:91], v[32:35]
  ds_read_b128 a[152:155], v231 offset:24576
  v_add_f32 v84, v84, v86
  v_mfma_f32_16x16x32_bf16 v[36:39], a[176:179], a[92:95], v[36:39]
  s_waitcnt lgkmcnt(3)
  v_mul_f32 v84, 0x3ae38e39, v84
  v_mov_b32 v85, v84
  v_mfma_f32_16x16x32_bf16 v[40:43], a[180:183], a[88:91], v[40:43]
  ds_read_b128 a[156:159], v231 offset:25600
  v_mfma_f32_16x16x32_bf16 v[44:47], a[180:183], a[92:95], v[44:47]
  buffer_load_dwordx4 a[124:127], v1, s[12:15], s40 offen offset:3072 sc1
  v_mfma_f32_16x16x32_bf16 v[192:195], a[184:187], a[88:91], v[192:195]
  ds_read_b128 a[160:163], v5 offset:24576
  s_add_u32 s40, s40, 4096
  v_mfma_f32_16x16x32_bf16 v[196:199], a[184:187], a[92:95], v[196:199]
  v_permlane32_swap_b32 v84, v85
  v_mfma_f32_16x16x32_bf16 v[200:203], a[188:191], a[88:91], v[200:203]
  ds_read_b128 a[164:167], v5 offset:25600
  v_sub_f32 v86, 0, v84
  v_mfma_f32_16x16x32_bf16 v[204:207], a[188:191], a[92:95], v[204:207]
  s_waitcnt vmcnt(6) lgkmcnt(3)
  v_fma_f32 v84, -v84, v84, v85
  v_max_f32 v84, 0, v84
  v_mfma_f32_16x16x32_bf16 v[16:19], a[144:147], a[96:99], v[16:19]
  ds_read_b128 a[168:171], v1 offset:26624
  v_add_f32 v84, 0x3727c5ac, v84
  v_mfma_f32_16x16x32_bf16 v[20:23], a[144:147], a[100:103], v[20:23]
  buffer_load_dwordx4 a[128:131], v1, s[12:15], s39 offen sc1
  v_mfma_f32_16x16x32_bf16 v[24:27], a[148:151], a[96:99], v[24:27]
  ds_read_b128 a[172:175], v1 offset:27648
  v_mov_b32 v85, v84
  v_mfma_f32_16x16x32_bf16 v[28:31], a[148:151], a[100:103], v[28:31]
  v_and_b32 v88, 0xffff0000, v86
  v_sub_f32 v87, v86, v88
  v_mfma_f32_16x16x32_bf16 v[32:35], a[152:155], a[96:99], v[32:35]
  ds_read_b128 a[176:179], v231 offset:26624
  v_perm_b32 v132, v86, v86, s58
  v_mfma_f32_16x16x32_bf16 v[36:39], a[152:155], a[100:103], v[36:39]
  s_waitcnt lgkmcnt(3)
  v_perm_b32 v133, v87, v87, s58
  v_permlane16_swap_b32 v84, v85
  v_mfma_f32_16x16x32_bf16 v[40:43], a[156:159], a[96:99], v[40:43]
  ds_read_b128 a[180:183], v231 offset:27648
  v_mfma_f32_16x16x32_bf16 v[44:47], a[156:159], a[100:103], v[44:47]
  buffer_load_dwordx4 a[132:135], v1, s[12:15], s40 offen sc1
  v_mfma_f32_16x16x32_bf16 v[192:195], a[160:163], a[96:99], v[192:195]
  ds_read_b128 a[184:187], v5 offset:26624
  v_mfma_f32_16x16x32_bf16 v[196:199], a[160:163], a[100:103], v[196:199]
  v_rsq_f32 v10, v84
  v_mfma_f32_16x16x32_bf16 v[200:203], a[164:167], a[96:99], v[200:203]
  ds_read_b128 a[188:191], v5 offset:27648
  v_mfma_f32_16x16x32_bf16 v[204:207], a[164:167], a[100:103], v[204:207]
  s_waitcnt vmcnt(6) lgkmcnt(3)
  v_rsq_f32 v11, v85
  v_mfma_f32_16x16x32_bf16 v[16:19], a[168:171], a[104:107], v[16:19]
  ds_read_b128 a[144:147], v1 offset:28672
  v_mov_b32 v12, v84
  v_mfma_f32_16x16x32_bf16 v[20:23], a[168:171], a[108:111], v[20:23]
  buffer_load_dwordx4 a[136:139], v1, s[12:15], s39 offen offset:1024 sc1
  v_mfma_f32_16x16x32_bf16 v[24:27], a[172:175], a[104:107], v[24:27]
  ds_read_b128 a[148:151], v1 offset:29696
  v_mov_b32 v13, v85
  v_mfma_f32_16x16x32_bf16 v[28:31], a[172:175], a[108:111], v[28:31]
  v_mul_f32 v10, 0xbfb8aa3b, v10
  v_mul_f32 v11, 0xbfb8aa3b, v11
  v_mfma_f32_16x16x32_bf16 v[32:35], a[176:179], a[104:107], v[32:35]
  ds_read_b128 a[152:155], v231 offset:28672
  v_mfma_f32_16x16x32_bf16 v[36:39], a[176:179], a[108:111], v[36:39]
  s_waitcnt lgkmcnt(3)
  v_mfma_f32_16x16x32_bf16 v[40:43], a[180:183], a[104:107], v[40:43]
  ds_read_b128 a[156:159], v231 offset:29696
  v_mfma_f32_16x16x32_bf16 v[44:47], a[180:183], a[108:111], v[44:47]
  buffer_load_dwordx4 a[140:143], v1, s[12:15], s40 offen offset:1024 sc1
  v_mfma_f32_16x16x32_bf16 v[192:195], a[184:187], a[104:107], v[192:195]
  ds_read_b128 a[160:163], v5 offset:28672
  v_mfma_f32_16x16x32_bf16 v[196:199], a[184:187], a[108:111], v[196:199]
  s_lshl_b32 s45, s33, 10
  s_barrier
  v_mfma_f32_16x16x32_bf16 v[200:203], a[188:191], a[104:107], v[200:203]
  ds_read_b128 a[164:167], v5 offset:29696
  s_add_u32 m0, s45, 0
  v_mfma_f32_16x16x32_bf16 v[204:207], a[188:191], a[108:111], v[204:207]
  s_waitcnt vmcnt(6) lgkmcnt(3)
  v_mfma_f32_16x16x32_bf16 v[16:19], a[144:147], a[112:115], v[16:19]
  ds_read_b128 a[168:171], v1 offset:30720
  s_add_u32 s42, s45, 147456
  v_mfma_f32_16x16x32_bf16 v[20:23], a[144:147], a[116:119], v[20:23]
  buffer_load_dwordx4 v1, s[16:19], s42 offen sc1 lds
  v_mfma_f32_16x16x32_bf16 v[24:27], a[148:151], a[112:115], v[24:27]
  ds_read_b128 a[172:175], v1 offset:31744
  v_mfma_f32_16x16x32_bf16 v[28:31], a[148:151], a[116:119], v[28:31]
  v_mfma_f32_16x16x32_bf16 v[32:35], a[152:155], a[112:115], v[32:35]
  ds_read_b128 a[176:179], v231 offset:30720
  s_add_u32 m0, s45, 4096
  v_mfma_f32_16x16x32_bf16 v[36:39], a[152:155], a[116:119], v[36:39]
  s_waitcnt lgkmcnt(3)
  v_mfma_f32_16x16x32_bf16 v[40:43], a[156:159], a[112:115], v[40:43]
  ds_read_b128 a[180:183], v231 offset:31744
  s_add_u32 s42, s45, 151552
  v_mfma_f32_16x16x32_bf16 v[44:47], a[156:159], a[116:119], v[44:47]
  buffer_load_dwordx4 v1, s[16:19], s42 offen sc1 lds
  v_mfma_f32_16x16x32_bf16 v[192:195], a[160:163], a[112:115], v[192:195]
  ds_read_b128 a[184:187], v5 offset:30720
  v_mfma_f32_16x16x32_bf16 v[196:199], a[160:163], a[116:119], v[196:199]
  v_mfma_f32_16x16x32_bf16 v[200:203], a[164:167], a[112:115], v[200:203]
  ds_read_b128 a[188:191], v5 offset:31744
  s_add_u32 m0, s45, 8192
  v_mfma_f32_16x16x32_bf16 v[204:207], a[164:167], a[116:119], v[204:207]
  s_waitcnt vmcnt(6) lgkmcnt(3)
  v_mfma_f32_16x16x32_bf16 v[16:19], a[168:171], a[120:123], v[16:19]
  ds_read_b128 a[144:147], v1 offset:32768
  s_add_u32 s42, s45, 155648
  v_mfma_f32_16x16x32_bf16 v[20:23], a[168:171], a[124:127], v[20:23]
  buffer_load_dwordx4 v1, s[16:19], s42 offen sc1 lds
  v_mfma_f32_16x16x32_bf16 v[24:27], a[172:175], a[120:123], v[24:27]
  ds_read_b128 a[148:151], v1 offset:33792
  v_mfma_f32_16x16x32_bf16 v[28:31], a[172:175], a[124:127], v[28:31]
  v_mfma_f32_16x16x32_bf16 v[32:35], a[176:179], a[120:123], v[32:35]
  ds_read_b128 a[152:155], v231 offset:32768
  s_add_u32 m0, s45, 12288
  v_mfma_f32_16x16x32_bf16 v[36:39], a[176:179], a[124:127], v[36:39]
  s_waitcnt lgkmcnt(3)
  v_mfma_f32_16x16x32_bf16 v[40:43], a[180:183], a[120:123], v[40:43]
  ds_read_b128 a[156:159], v231 offset:33792
  s_add_u32 s42, s45, 159744
  v_mfma_f32_16x16x32_bf16 v[44:47], a[180:183], a[124:127], v[44:47]
  buffer_load_dwordx4 v1, s[16:19], s42 offen sc1 lds
  v_mfma_f32_16x16x32_bf16 v[192:195], a[184:187], a[120:123], v[192:195]
  ds_read_b128 a[160:163], v5 offset:32768
  v_mfma_f32_16x16x32_bf16 v[196:199], a[184:187], a[124:127], v[196:199]
  v_mfma_f32_16x16x32_bf16 v[200:203], a[188:191], a[120:123], v[200:203]
  ds_read_b128 a[164:167], v5 offset:33792
  s_add_u32 m0, s45, 16384
  v_mfma_f32_16x16x32_bf16 v[204:207], a[188:191], a[124:127], v[204:207]
  s_waitcnt vmcnt(6) lgkmcnt(3)
  v_mfma_f32_16x16x32_bf16 v[16:19], a[144:147], a[128:131], v[16:19]
  ds_read_b128 a[168:171], v1 offset:34816
  s_add_u32 s42, s45, 163840
  v_mfma_f32_16x16x32_bf16 v[20:23], a[144:147], a[132:135], v[20:23]
  buffer_load_dwordx4 v1, s[16:19], s42 offen sc1 lds
  v_mfma_f32_16x16x32_bf16 v[24:27], a[148:151], a[128:131], v[24:27]
  ds_read_b128 a[172:175], v1 offset:35840
  v_mfma_f32_16x16x32_bf16 v[28:31], a[148:151], a[132:135], v[28:31]
  v_mfma_f32_16x16x32_bf16 v[32:35], a[152:155], a[128:131], v[32:35]
  ds_read_b128 a[176:179], v231 offset:34816
  s_add_u32 m0, s45, 20480
  v_mfma_f32_16x16x32_bf16 v[36:39], a[152:155], a[132:135], v[36:39]
  s_waitcnt lgkmcnt(3)
  v_mfma_f32_16x16x32_bf16 v[40:43], a[156:159], a[128:131], v[40:43]
  ds_read_b128 a[180:183], v231 offset:35840
  s_add_u32 s42, s45, 167936
  v_mfma_f32_16x16x32_bf16 v[44:47], a[156:159], a[132:135], v[44:47]
  buffer_load_dwordx4 v1, s[16:19], s42 offen sc1 lds
  v_mfma_f32_16x16x32_bf16 v[192:195], a[160:163], a[128:131], v[192:195]
  ds_read_b128 a[184:187], v5 offset:34816
  v_mfma_f32_16x16x32_bf16 v[196:199], a[160:163], a[132:135], v[196:199]
  v_mfma_f32_16x16x32_bf16 v[200:203], a[164:167], a[128:131], v[200:203]
  ds_read_b128 a[188:191], v5 offset:35840
  v_mfma_f32_16x16x32_bf16 v[204:207], a[164:167], a[132:135], v[204:207]
  s_waitcnt vmcnt(6) lgkmcnt(3)
  v_mfma_f32_16x16x4_4b_bf16 v[208:223], v[146:147], v[132:133], 0
  v_mfma_f32_16x16x32_bf16 v[16:19], a[168:171], a[136:139], v[16:19]
  ds_read_b128 a[144:147], v6 offset:0
  v_mfma_f32_16x16x32_bf16 v[20:23], a[168:171], a[140:143], v[20:23]
  v_mfma_f32_16x16x32_bf16 v[24:27], a[172:175], a[136:139], v[24:27]
  ds_read_b128 a[148:151], v6 offset:1024
  v_mfma_f32_16x16x32_bf16 v[28:31], a[172:175], a[140:143], v[28:31]
  v_mfma_f32_16x16x32_bf16 v[32:35], a[176:179], a[136:139], v[32:35]
  ds_read_b128 a[152:155], v6 offset:2048
  v_mfma_f32_16x16x32_bf16 v[36:39], a[176:179], a[140:143], v[36:39]
  s_waitcnt lgkmcnt(3)
  v_mfma_f32_16x16x32_bf16 v[40:43], a[180:183], a[136:139], v[40:43]
  ds_read_b128 a[156:159], v6 offset:3072
  v_mfma_f32_16x16x32_bf16 v[44:47], a[180:183], a[140:143], v[44:47]
  ds_read_b128 a[168:171], v6 offset:6144
  v_mfma_f32_16x16x32_bf16 v[192:195], a[184:187], a[136:139], v[192:195]
  ds_read_b128 a[160:163], v6 offset:4096
  v_mfma_f32_16x16x32_bf16 v[196:199], a[184:187], a[140:143], v[196:199]
  ds_read_b128 a[172:175], v6 offset:7168
  v_mfma_f32_16x16x32_bf16 v[200:203], a[188:191], a[136:139], v[200:203]
  ds_read_b128 a[164:167], v6 offset:5120
  v_mfma_f32_16x16x32_bf16 v[204:207], a[188:191], a[140:143], v[204:207]
  s_barrier
  v_mfma_f32_16x16x4_4b_bf16 v[16:31], v[140:141], v[132:133], v[16:31]
  v_mfma_f32_16x16x4_4b_bf16 v[32:47], v[142:143], v[132:133], v[32:47]
  s_waitcnt lgkmcnt(0)
  s_nop 1
  v_mfma_f32_16x16x4_4b_bf16 v[192:207], v[144:145], v[132:133], v[192:207]
  v_mfma_f32_16x16x32_bf16 v[208:211], a[144:147], a[0:3], v[208:211]
  ds_read_b128 a[176:179], v6 offset:8192
  s_add_u32 m0, s45, 24576
  v_mfma_f32_16x16x32_bf16 v[212:215], a[144:147], a[4:7], v[212:215]
  s_add_u32 s42, s45, 172032
  v_mfma_f32_16x16x32_bf16 v[216:219], a[148:151], a[0:3], v[216:219]
  ds_read_b128 a[180:183], v6 offset:9216
  v_mfma_f32_16x16x32_bf16 v[220:223], a[148:151], a[4:7], v[220:223]
  buffer_load_dwordx4 v1, s[16:19], s42 offen sc1 lds
  v_mfma_f32_16x16x32_bf16 v[208:211], a[152:155], a[8:11], v[208:211]
  ds_read_b128 a[184:187], v6 offset:10240
  v_mul_f32 v48, v10, v16
  v_mfma_f32_16x16x32_bf16 v[212:215], a[152:155], a[12:15], v[212:215]
  s_add_u32 m0, s45, 28672
  v_exp_f32 v48, v48
  v_mfma_f32_16x16x32_bf16 v[216:219], a[156:159], a[8:11], v[216:219]
  ds_read_b128 a[188:191], v6 offset:11264
  s_add_u32 s42, s45, 176128
  v_mfma_f32_16x16x32_bf16 v[220:223], a[156:159], a[12:15], v[220:223]
  s_waitcnt lgkmcnt(4)
  v_mul_f32 v49, v10, v17
  v_mul_f32 v50, v10, v18
  v_mfma_f32_16x16x32_bf16 v[208:211], a[160:163], a[16:19], v[208:211]
  ds_read_b128 a[144:147], v6 offset:12288
  v_mul_f32 v51, v10, v19
  v_mfma_f32_16x16x32_bf16 v[212:215], a[160:163], a[20:23], v[212:215]
  buffer_load_dwordx4 v1, s[16:19], s42 offen sc1 lds
  v_mfma_f32_16x16x32_bf16 v[216:219], a[164:167], a[16:19], v[216:219]
  ds_read_b128 a[148:151], v6 offset:13312
  v_mul_f32 v56, v16, v24
  v_mfma_f32_16x16x32_bf16 v[220:223], a[164:167], a[20:23], v[220:223]
  s_add_u32 m0, s45, 32768
  v_exp_f32 v49, v49
  v_mfma_f32_16x16x32_bf16 v[208:211], a[168:171], a[24:27], v[208:211]
  ds_read_b128 a[152:155], v6 offset:14336
  s_add_u32 s42, s45, 180224
  v_mfma_f32_16x16x32_bf16 v[212:215], a[168:171], a[28:31], v[212:215]
  buffer_load_dwordx4 v1, s[16:19], s42 offen sc1 lds
  v_mfma_f32_16x16x32_bf16 v[216:219], a[172:175], a[24:27], v[216:219]
  ds_read_b128 a[156:159], v6 offset:15360
  v_mul_f32 v57, v17, v25
  v_mfma_f32_16x16x32_bf16 v[220:223], a[172:175], a[28:31], v[220:223]
  s_waitcnt lgkmcnt(4)
  v_exp_f32 v50, v50
  v_mfma_f32_16x16x32_bf16 v[208:211], a[176:179], a[32:35], v[208:211]
  ds_read_b128 a[160:163], v6 offset:16384
  v_mul_f32 v58, v18, v26
  v_mfma_f32_16x16x32_bf16 v[212:215], a[176:179], a[36:39], v[212:215]
  s_add_u32 s43, s43, 36864
  v_exp_f32 v51, v51
  v_mfma_f32_16x16x32_bf16 v[216:219], a[180:183], a[32:35], v[216:219]
  ds_read_b128 a[164:167], v6 offset:17408
  s_add_u32 m0, s44, s51
  v_mfma_f32_16x16x32_bf16 v[220:223], a[180:183], a[36:39], v[220:223]
  buffer_load_dwordx4 v7, s[16:19], s43 offen sc1 lds
  v_mfma_f32_16x16x32_bf16 v[208:211], a[184:187], a[40:43], v[208:211]
  ds_read_b128 a[168:171], v6 offset:18432
  v_mul_f32 v59, v19, v27
  v_mfma_f32_16x16x32_bf16 v[212:215], a[184:187], a[44:47], v[212:215]
  v_mul_f32 v52, v11, v20
  v_mul_f32 v53, v11, v21
  v_mfma_f32_16x16x32_bf16 v[216:219], a[188:191], a[40:43], v[216:219]
  ds_read_b128 a[172:175], v6 offset:19456
  v_mul_f32 v54, v11, v22
  v_mfma_f32_16x16x32_bf16 v[220:223], a[188:191], a[44:47], v[220:223]
  s_waitcnt lgkmcnt(4)
  v_exp_f32 v52, v52
  v_mfma_f32_16x16x32_bf16 v[208:211], a[144:147], a[48:51], v[208:211]
  ds_read_b128 a[176:179], v6 offset:20480
  v_mul_f32 v55, v11, v23
  v_mfma_f32_16x16x32_bf16 v[212:215], a[144:147], a[52:55], v[212:215]
  buffer_load_dwordx4 v7, s[16:19], s43 offen offset:1024 sc1 lds
  v_mfma_f32_16x16x32_bf16 v[216:219], a[148:151], a[48:51], v[216:219]
  ds_read_b128 a[180:183], v6 offset:21504
  v_fma_f32 v48, v48, v12, v12
  v_mfma_f32_16x16x32_bf16 v[220:223], a[148:151], a[52:55], v[220:223]
  v_rcp_f32 v48, v48
  v_mfma_f32_16x16x32_bf16 v[208:211], a[152:155], a[56:59], v[208:211]
  ds_read_b128 a[184:187], v6 offset:22528
  v_fma_f32 v49, v49, v12, v12
  v_mfma_f32_16x16x32_bf16 v[212:215], a[152:155], a[60:63], v[212:215]
  buffer_load_dwordx4 v7, s[16:19], s43 offen offset:2048 sc1 lds
  v_mfma_f32_16x16x32_bf16 v[216:219], a[156:159], a[56:59], v[216:219]
  ds_read_b128 a[188:191], v6 offset:23552
  s_add_u32 m0, s44, s52
  v_mfma_f32_16x16x32_bf16 v[220:223], a[156:159], a[60:63], v[220:223]
  s_waitcnt lgkmcnt(4)
  v_rcp_f32 v49, v49
  v_mfma_f32_16x16x32_bf16 v[208:211], a[160:163], a[64:67], v[208:211]
  ds_read_b128 a[144:147], v6 offset:24576
  v_fma_f32 v50, v50, v12, v12
  v_mfma_f32_16x16x32_bf16 v[212:215], a[160:163], a[68:71], v[212:215]
  buffer_load_dwordx4 v8, s[16:19], s43 offen sc1 lds
  v_mfma_f32_16x16x32_bf16 v[216:219], a[164:167], a[64:67], v[216:219]
  ds_read_b128 a[148:151], v6 offset:25600
  v_fma_f32 v51, v51, v12, v12
  v_mfma_f32_16x16x32_bf16 v[220:223], a[164:167], a[68:71], v[220:223]
  v_rcp_f32 v50, v50
  v_mfma_f32_16x16x32_bf16 v[208:211], a[168:171], a[72:75], v[208:211]
  ds_read_b128 a[152:155], v6 offset:26624
  v_mul_f32 v160, v10, v32
  v_mfma_f32_16x16x32_bf16 v[212:215], a[168:171], a[76:79], v[212:215]
  buffer_load_dwordx4 v8, s[16:19], s43 offen offset:1024 sc1 lds
  v_mfma_f32_16x16x32_bf16 v[216:219], a[172:175], a[72:75], v[216:219]
  ds_read_b128 a[156:159], v6 offset:27648
  v_mul_f32 v161, v10, v33
  v_mfma_f32_16x16x32_bf16 v[220:223], a[172:175], a[76:79], v[220:223]
  s_waitcnt lgkmcnt(4)
  v_rcp_f32 v51, v51
  v_mfma_f32_16x16x32_bf16 v[208:211], a[176:179], a[80:83], v[208:211]
  ds_read_b128 a[160:163], v6 offset:28672
  v_xor_b32 v5, 73728, v5
  v_mfma_f32_16x16x32_bf16 v[212:215], a[176:179], a[84:87], v[212:215]
  buffer_load_dwordx4 v8, s[16:19], s43 offen offset:2048 sc1 lds
  v_mfma_f32_16x16x32_bf16 v[216:219], a[180:183], a[80:83], v[216:219]
  ds_read_b128 a[164:167], v6 offset:29696
  s_add_u32 m0, s44, s53
  v_mfma_f32_16x16x32_bf16 v[220:223], a[180:183], a[84:87], v[220:223]
  ds_read2_b32 v[140:141], v148 offset0:0 offset1:0
  v_mul_f32 v162, v10, v34
  v_mfma_f32_16x16x32_bf16 v[208:211], a[184:187], a[88:91], v[208:211]
  ds_read_b128 a[168:171], v6 offset:30720
  v_add_u32 v148, 128, v148
  v_mfma_f32_16x16x32_bf16 v[212:215], a[184:187], a[92:95], v[212:215]
  buffer_load_dwordx4 v9, s[16:19], s43 offen sc1 lds
  v_mfma_f32_16x16x32_bf16 v[216:219], a[188:191], a[88:91], v[216:219]
  ds_read_b128 a[172:175], v6 offset:31744
  v_mul_f32 v163, v10, v35
  v_mfma_f32_16x16x32_bf16 v[220:223], a[188:191], a[92:95], v[220:223]
  s_waitcnt lgkmcnt(4)
  v_exp_f32 v160, v160
  v_mfma_f32_16x16x32_bf16 v[208:211], a[144:147], a[96:99], v[208:211]
  ds_read_b128 a[176:179], v6 offset:32768
  v_mul_f32 v60, v20, v28
  v_mfma_f32_16x16x32_bf16 v[212:215], a[144:147], a[100:103], v[212:215]
  v_exp_f32 v161, v161
  v_mfma_f32_16x16x32_bf16 v[216:219], a[148:151], a[96:99], v[216:219]
  ds_read_b128 a[180:183], v6 offset:33792
  v_mul_f32 v61, v21, v29
  v_mfma_f32_16x16x32_bf16 v[220:223], a[148:151], a[100:103], v[220:223]
  buffer_load_dwordx4 v9, s[16:19], s43 offen offset:1024 sc1 lds
  v_mfma_f32_16x16x32_bf16 v[208:211], a[152:155], a[104:107], v[208:211]
  ds_read_b128 a[184:187], v6 offset:34816
  v_mul_f32 v62, v22, v30
  v_mfma_f32_16x16x32_bf16 v[212:215], a[152:155], a[108:111], v[212:215]
  v_exp_f32 v162, v162
  v_mfma_f32_16x16x32_bf16 v[216:219], a[156:159], a[104:107], v[216:219]
  ds_read_b128 a[188:191], v6 offset:35840
  v_mul_f32 v63, v23, v31
  v_mfma_f32_16x16x32_bf16 v[220:223], a[156:159], a[108:111], v[220:223]
  s_waitcnt vmcnt(8)
  s_barrier
  s_waitcnt lgkmcnt(4)
  v_mfma_f32_16x16x32_bf16 v[208:211], a[160:163], a[112:115], v[208:211]
  ds_read_b128 a[144:147], v5 offset:0
  v_mul_f32 v56, v56, v48
  v_mfma_f32_16x16x32_bf16 v[212:215], a[160:163], a[116:119], v[212:215]
  buffer_load_dwordx4 v9, s[16:19], s43 offen offset:2048 sc1 lds
  v_mfma_f32_16x16x32_bf16 v[216:219], a[164:167], a[112:115], v[216:219]
  ds_read_b128 a[148:151], v5 offset:1024
  v_mul_f32 v57, v57, v49
  v_mfma_f32_16x16x32_bf16 v[220:223], a[164:167], a[116:119], v[220:223]
  s_add_u32 s43, s43, 36864
  v_exp_f32 v163, v163
  v_mfma_f32_16x16x32_bf16 v[208:211], a[168:171], a[120:123], v[208:211]
  ds_read_b128 a[152:155], v5 offset:2048
  v_mul_f32 v58, v58, v50
  v_mfma_f32_16x16x32_bf16 v[212:215], a[168:171], a[124:127], v[212:215]
  s_xor_b32 s44, s44, 73728
  v_exp_f32 v53, v53
  v_mfma_f32_16x16x32_bf16 v[216:219], a[172:175], a[120:123], v[216:219]
  ds_read_b128 a[156:159], v5 offset:3072
  v_mul_f32 v59, v59, v51
  v_mfma_f32_16x16x32_bf16 v[220:223], a[172:175], a[124:127], v[220:223]
  s_waitcnt lgkmcnt(4)
  v_exp_f32 v54, v54
  v_mfma_f32_16x16x32_bf16 v[208:211], a[176:179], a[128:131], v[208:211]
  ds_read_b128 a[160:163], v5 offset:4096
  v_fma_f32 v160, v160, v12, v12
  v_mfma_f32_16x16x32_bf16 v[212:215], a[176:179], a[132:135], v[212:215]
  v_exp_f32 v55, v55
  v_mfma_f32_16x16x4_4b_bf16 v[16:31], v[140:141], v[132:133], 0
  v_rcp_f32 v160, v160
  v_fma_f32 v161, v161, v12, v12
  v_fma_f32 v162, v162, v12, v12
  v_fma_f32 v163, v163, v12, v12
  v_fma_f32 v52, v52, v13, v13
  v_fma_f32 v53, v53, v13, v13
  v_mfma_f32_16x16x32_bf16 v[216:219], a[180:183], a[128:131], v[216:219]
  ds_read_b128 a[164:167], v5 offset:5120
  v_fma_f32 v54, v54, v13, v13
  v_mfma_f32_16x16x32_bf16 v[220:223], a[180:183], a[132:135], v[220:223]
  v_rcp_f32 v161, v161
  v_mfma_f32_16x16x32_bf16 v[208:211], a[184:187], a[136:139], v[208:211]
  ds_read_b128 a[168:171], v5 offset:6144
  v_fma_f32 v55, v55, v13, v13
  v_mfma_f32_16x16x32_bf16 v[212:215], a[184:187], a[140:143], v[212:215]
  v_rcp_f32 v162, v162
  v_mfma_f32_16x16x32_bf16 v[216:219], a[188:191], a[136:139], v[216:219]
  ds_read_b128 a[172:175], v5 offset:7168
  v_mul_f32 v168, v32, v40
  v_mfma_f32_16x16x32_bf16 v[220:223], a[188:191], a[140:143], v[220:223]
  s_waitcnt lgkmcnt(4)
  v_rcp_f32 v163, v163
  v_mul_f32 v169, v33, v41
  v_pk_mul_f32 v[170:171], v[34:35], v[42:43]
  v_pk_mul_f32 v[164:165], v[10:11], v[36:37] op_sel:[1,0] op_sel_hi:[1,1]
  v_pk_mul_f32 v[166:167], v[10:11], v[38:39] op_sel:[1,0] op_sel_hi:[1,1]
  v_rcp_f32 v52, v52
  v_rcp_f32 v53, v53
  v_rcp_f32 v54, v54
  v_rcp_f32 v55, v55
  v_pk_mul_f32 v[168:169], v[168:169], v[160:161]
  v_pk_mul_f32 v[170:171], v[170:171], v[162:163]
  v_exp_f32 v164, v164
  v_exp_f32 v165, v165
  v_exp_f32 v166, v166
  v_exp_f32 v167, v167
  v_pk_mul_f32 v[60:61], v[60:61], v[52:53]
  v_pk_mul_f32 v[62:63], v[62:63], v[54:55]
  v_pk_fma_f32 v[164:165], v[164:165], v[12:13], v[12:13] op_sel:[0,1,1] op_sel_hi:[1,1,1]
  v_pk_fma_f32 v[166:167], v[166:167], v[12:13], v[12:13] op_sel:[0,1,1] op_sel_hi:[1,1,1]
  v_cvt_pk_bf16_f32 v176, v56, v57
  v_cvt_pk_bf16_f32 v177, v58, v59
  v_cvt_pk_bf16_f32 v180, v60, v61
  v_cvt_pk_bf16_f32 v181, v62, v63
  v_rcp_f32 v164, v164
  v_pk_mul_f32 v[172:173], v[36:37], v[44:45]
  v_rcp_f32 v165, v165
  v_rcp_f32 v166, v166
  v_pk_mul_f32 v[174:175], v[38:39], v[46:47]
  v_rcp_f32 v167, v167
  v_pk_mul_f32 v[172:173], v[172:173], v[164:165]
  v_pk_mul_f32 v[174:175], v[174:175], v[166:167]
  v_cvt_pk_bf16_f32 v178, v168, v169
  v_cvt_pk_bf16_f32 v179, v170, v171
  buffer_store_dwordx4 v[176:179], v1, s[12:15], s46 offen sc1
  v_cvt_pk_bf16_f32 v182, v172, v173
  v_cvt_pk_bf16_f32 v183, v174, v175
  buffer_store_dwordx4 v[180:183], v1, s[12:15], s46 offen offset:1024 sc1
  s_add_u32 s46, s46, 2048
  s_barrier
  v_mfma_f32_16x16x32_bf16 v[16:19], a[144:147], a[0:3], v[16:19]
  ds_read_b128 a[176:179], v5 offset:8192
  s_add_u32 m0, s44, s48
  v_mfma_f32_16x16x32_bf16 v[20:23], a[144:147], a[4:7], v[20:23]
  buffer_load_dwordx4 v7, s[16:19], s43 offen sc1 lds
  v_mfma_f32_16x16x32_bf16 v[24:27], a[148:151], a[0:3], v[24:27]
  ds_read_b128 a[180:183], v5 offset:9216
  v_mfma_f32_16x16x32_bf16 v[28:31], a[148:151], a[4:7], v[28:31]
  v_mul_f32 v48, v10, v192
  v_mul_f32 v49, v10, v193
  v_mfma_f32_16x16x32_bf16 v[16:19], a[152:155], a[8:11], v[16:19]
  ds_read_b128 a[184:187], v5 offset:10240
  v_mul_f32 v50, v10, v194
  v_mfma_f32_16x16x32_bf16 v[20:23], a[152:155], a[12:15], v[20:23]
  buffer_load_dwordx4 v7, s[16:19], s43 offen offset:1024 sc1 lds
  v_mfma_f32_16x16x32_bf16 v[24:27], a[156:159], a[8:11], v[24:27]
  ds_read_b128 a[188:191], v5 offset:11264
  v_mul_f32 v51, v10, v195
  v_mfma_f32_16x16x32_bf16 v[28:31], a[156:159], a[12:15], v[28:31]
  s_waitcnt lgkmcnt(4)
  v_exp_f32 v48, v48
  v_mfma_f32_16x16x32_bf16 v[16:19], a[160:163], a[16:19], v[16:19]
  ds_read_b128 a[144:147], v5 offset:12288
  v_fma_f32 v48, v48, v12, v12
  v_mfma_f32_16x16x32_bf16 v[20:23], a[160:163], a[20:23], v[20:23]
  buffer_load_dwordx4 v7, s[16:19], s43 offen offset:2048 sc1 lds
  v_mfma_f32_16x16x32_bf16 v[24:27], a[164:167], a[16:19], v[24:27]
  ds_read_b128 a[148:151], v5 offset:13312
  s_add_u32 m0, s44, s49
  v_mfma_f32_16x16x32_bf16 v[28:31], a[164:167], a[20:23], v[28:31]
  v_exp_f32 v49, v49
  v_mfma_f32_16x16x32_bf16 v[16:19], a[168:171], a[24:27], v[16:19]
  ds_read_b128 a[152:155], v5 offset:14336
  v_fma_f32 v49, v49, v12, v12
  v_mfma_f32_16x16x32_bf16 v[20:23], a[168:171], a[28:31], v[20:23]
  buffer_load_dwordx4 v8, s[16:19], s43 offen sc1 lds
  v_mfma_f32_16x16x32_bf16 v[24:27], a[172:175], a[24:27], v[24:27]
  ds_read_b128 a[156:159], v5 offset:15360
  v_mul_f32 v160, v10, v208
  v_mfma_f32_16x16x32_bf16 v[28:31], a[172:175], a[28:31], v[28:31]
  s_waitcnt lgkmcnt(4)
  v_exp_f32 v50, v50
  v_mfma_f32_16x16x32_bf16 v[16:19], a[176:179], a[32:35], v[16:19]
  ds_read_b128 a[160:163], v5 offset:16384
  v_fma_f32 v50, v50, v12, v12
  v_mfma_f32_16x16x32_bf16 v[20:23], a[176:179], a[36:39], v[20:23]
  buffer_load_dwordx4 v8, s[16:19], s43 offen offset:1024 sc1 lds
  v_mfma_f32_16x16x32_bf16 v[24:27], a[180:183], a[32:35], v[24:27]
  ds_read_b128 a[164:167], v5 offset:17408
  v_mul_f32 v161, v10, v209
  v_mfma_f32_16x16x32_bf16 v[28:31], a[180:183], a[36:39], v[28:31]
  v_exp_f32 v51, v51
  v_mfma_f32_16x16x32_bf16 v[16:19], a[184:187], a[40:43], v[16:19]
  ds_read_b128 a[168:171], v5 offset:18432
  v_fma_f32 v51, v51, v12, v12
  v_mfma_f32_16x16x32_bf16 v[20:23], a[184:187], a[44:47], v[20:23]
  buffer_load_dwordx4 v8, s[16:19], s43 offen offset:2048 sc1 lds
  v_mfma_f32_16x16x32_bf16 v[24:27], a[188:191], a[40:43], v[24:27]
  ds_read_b128 a[172:175], v5 offset:19456
  s_add_u32 m0, s44, s50
  v_mfma_f32_16x16x32_bf16 v[28:31], a[188:191], a[44:47], v[28:31]
  s_waitcnt lgkmcnt(4)
  v_rcp_f32 v48, v48
  v_mfma_f32_16x16x32_bf16 v[16:19], a[144:147], a[48:51], v[16:19]
  ds_read_b128 a[176:179], v5 offset:20480
  v_mul_f32 v162, v10, v210
  v_mfma_f32_16x16x32_bf16 v[20:23], a[144:147], a[52:55], v[20:23]
  buffer_load_dwordx4 v9, s[16:19], s43 offen sc1 lds
  v_mfma_f32_16x16x32_bf16 v[24:27], a[148:151], a[48:51], v[24:27]
  ds_read_b128 a[180:183], v5 offset:21504
  v_mul_f32 v163, v10, v211
  v_mfma_f32_16x16x32_bf16 v[28:31], a[148:151], a[52:55], v[28:31]
  v_rcp_f32 v49, v49
  v_mfma_f32_16x16x32_bf16 v[16:19], a[152:155], a[56:59], v[16:19]
  ds_read_b128 a[184:187], v5 offset:22528
  v_mul_f32 v56, v192, v200
  v_mfma_f32_16x16x32_bf16 v[20:23], a[152:155], a[60:63], v[20:23]
  buffer_load_dwordx4 v9, s[16:19], s43 offen offset:1024 sc1 lds
  v_mfma_f32_16x16x32_bf16 v[24:27], a[156:159], a[56:59], v[24:27]
  ds_read_b128 a[188:191], v5 offset:23552
  v_mul_f32 v57, v193, v201
  v_mfma_f32_16x16x32_bf16 v[28:31], a[156:159], a[60:63], v[28:31]
  s_waitcnt lgkmcnt(4)
  v_rcp_f32 v50, v50
  v_mfma_f32_16x16x32_bf16 v[16:19], a[160:163], a[64:67], v[16:19]
  ds_read_b128 a[144:147], v5 offset:24576
  v_mul_f32 v58, v194, v202
  v_mfma_f32_16x16x32_bf16 v[20:23], a[160:163], a[68:71], v[20:23]
  buffer_load_dwordx4 v9, s[16:19], s43 offen offset:2048 sc1 lds
  v_mfma_f32_16x16x32_bf16 v[24:27], a[164:167], a[64:67], v[24:27]
  ds_read_b128 a[148:151], v5 offset:25600
  v_mul_f32 v59, v195, v203
  v_mfma_f32_16x16x32_bf16 v[28:31], a[164:167], a[68:71], v[28:31]
  s_add_u32 s43, s43, 36864
  v_rcp_f32 v51, v51
  v_mfma_f32_16x16x32_bf16 v[16:19], a[168:171], a[72:75], v[16:19]
  ds_read_b128 a[152:155], v5 offset:26624
  s_add_u32 m0, s44, s51
  v_mfma_f32_16x16x32_bf16 v[20:23], a[168:171], a[76:79], v[20:23]
  buffer_load_dwordx4 v7, s[16:19], s43 offen sc1 lds
  v_mfma_f32_16x16x32_bf16 v[24:27], a[172:175], a[72:75], v[24:27]
  ds_read_b128 a[156:159], v5 offset:27648
  v_mul_f32 v52, v11, v196
  v_mfma_f32_16x16x32_bf16 v[28:31], a[172:175], a[76:79], v[28:31]
  s_waitcnt lgkmcnt(4)
  v_exp_f32 v160, v160
  v_mfma_f32_16x16x32_bf16 v[16:19], a[176:179], a[80:83], v[16:19]
  ds_read_b128 a[160:163], v5 offset:28672
  v_xor_b32 v6, 73728, v6
  v_mfma_f32_16x16x32_bf16 v[20:23], a[176:179], a[84:87], v[20:23]
  buffer_load_dwordx4 v7, s[16:19], s43 offen offset:1024 sc1 lds
  v_mfma_f32_16x16x32_bf16 v[24:27], a[180:183], a[80:83], v[24:27]
  ds_read_b128 a[164:167], v5 offset:29696
  v_mul_f32 v53, v11, v197
  v_mfma_f32_16x16x32_bf16 v[28:31], a[180:183], a[84:87], v[28:31]
  ds_read2_b32 v[140:141], v148 offset0:0 offset1:0
  v_mul_f32 v54, v11, v198
  v_mfma_f32_16x16x32_bf16 v[16:19], a[184:187], a[88:91], v[16:19]
  ds_read_b128 a[168:171], v5 offset:30720
  v_add_u32 v148, 128, v148
  v_mfma_f32_16x16x32_bf16 v[20:23], a[184:187], a[92:95], v[20:23]
  buffer_load_dwordx4 v7, s[16:19], s43 offen offset:2048 sc1 lds
  v_mfma_f32_16x16x32_bf16 v[24:27], a[188:191], a[88:91], v[24:27]
  ds_read_b128 a[172:175], v5 offset:31744
  s_add_u32 m0, s44, s52
  v_mfma_f32_16x16x32_bf16 v[28:31], a[188:191], a[92:95], v[28:31]
  s_waitcnt lgkmcnt(4)
  v_exp_f32 v161, v161
  v_mfma_f32_16x16x32_bf16 v[16:19], a[144:147], a[96:99], v[16:19]
  ds_read_b128 a[176:179], v5 offset:32768
  v_mul_f32 v55, v11, v199
  v_mfma_f32_16x16x32_bf16 v[20:23], a[144:147], a[100:103], v[20:23]
  buffer_load_dwordx4 v8, s[16:19], s43 offen sc1 lds
  v_mfma_f32_16x16x32_bf16 v[24:27], a[148:151], a[96:99], v[24:27]
  ds_read_b128 a[180:183], v5 offset:33792
  v_mul_f32 v56, v56, v48
  v_mfma_f32_16x16x32_bf16 v[28:31], a[148:151], a[100:103], v[28:31]
  v_exp_f32 v162, v162
  v_mfma_f32_16x16x32_bf16 v[16:19], a[152:155], a[104:107], v[16:19]
  ds_read_b128 a[184:187], v5 offset:34816
  v_mul_f32 v57, v57, v49
  v_mfma_f32_16x16x32_bf16 v[20:23], a[152:155], a[108:111], v[20:23]
  buffer_load_dwordx4 v8, s[16:19], s43 offen offset:1024 sc1 lds
  v_mfma_f32_16x16x32_bf16 v[24:27], a[156:159], a[104:107], v[24:27]
  ds_read_b128 a[188:191], v5 offset:35840
  v_mul_f32 v58, v58, v50
  v_mfma_f32_16x16x32_bf16 v[28:31], a[156:159], a[108:111], v[28:31]
  s_waitcnt vmcnt(16)
  s_barrier
  s_waitcnt lgkmcnt(4)
  v_mfma_f32_16x16x32_bf16 v[16:19], a[160:163], a[112:115], v[16:19]
  ds_read_b128 a[144:147], v6 offset:0
  v_mul_f32 v59, v59, v51
  v_mfma_f32_16x16x32_bf16 v[20:23], a[160:163], a[116:119], v[20:23]
  buffer_load_dwordx4 v8, s[16:19], s43 offen offset:2048 sc1 lds
  v_mfma_f32_16x16x32_bf16 v[24:27], a[164:167], a[112:115], v[24:27]
  ds_read_b128 a[148:151], v6 offset:1024
  s_add_u32 m0, s44, s53
  v_mfma_f32_16x16x32_bf16 v[28:31], a[164:167], a[116:119], v[28:31]
  v_exp_f32 v163, v163
  v_mfma_f32_16x16x32_bf16 v[16:19], a[168:171], a[120:123], v[16:19]
  ds_read_b128 a[152:155], v6 offset:2048
  v_fma_f32 v160, v160, v12, v12
  v_mfma_f32_16x16x32_bf16 v[20:23], a[168:171], a[124:127], v[20:23]
  buffer_load_dwordx4 v9, s[16:19], s43 offen sc1 lds
  v_mfma_f32_16x16x32_bf16 v[24:27], a[172:175], a[120:123], v[24:27]
  ds_read_b128 a[156:159], v6 offset:3072
  v_fma_f32 v161, v161, v12, v12
  v_mfma_f32_16x16x32_bf16 v[28:31], a[172:175], a[124:127], v[28:31]
  s_waitcnt lgkmcnt(4)
  v_exp_f32 v52, v52
  v_mfma_f32_16x16x32_bf16 v[16:19], a[176:179], a[128:131], v[16:19]
  ds_read_b128 a[160:163], v6 offset:4096
  v_fma_f32 v162, v162, v12, v12
  v_mfma_f32_16x16x32_bf16 v[20:23], a[176:179], a[132:135], v[20:23]
  buffer_load_dwordx4 v9, s[16:19], s43 offen offset:1024 sc1 lds
  v_mfma_f32_16x16x4_4b_bf16 v[32:47], v[140:141], v[132:133], 0
  v_exp_f32 v53, v53
  v_exp_f32 v54, v54
  v_exp_f32 v55, v55
  v_fma_f32 v163, v163, v12, v12
  v_mfma_f32_16x16x32_bf16 v[24:27], a[180:183], a[128:131], v[24:27]
  ds_read_b128 a[164:167], v6 offset:5120
  v_fma_f32 v52, v52, v13, v13
  v_mfma_f32_16x16x32_bf16 v[28:31], a[180:183], a[132:135], v[28:31]
  v_rcp_f32 v160, v160
  v_mfma_f32_16x16x32_bf16 v[16:19], a[184:187], a[136:139], v[16:19]
  ds_read_b128 a[168:171], v6 offset:6144
  v_fma_f32 v53, v53, v13, v13
  v_mfma_f32_16x16x32_bf16 v[20:23], a[184:187], a[140:143], v[20:23]
  buffer_load_dwordx4 v9, s[16:19], s43 offen offset:2048 sc1 lds
  v_mfma_f32_16x16x32_bf16 v[24:27], a[188:191], a[136:139], v[24:27]
  ds_read_b128 a[172:175], v6 offset:7168
  v_fma_f32 v54, v54, v13, v13
  v_mfma_f32_16x16x32_bf16 v[28:31], a[188:191], a[140:143], v[28:31]
  s_waitcnt vmcnt(9) lgkmcnt(4)
  v_rcp_f32 v161, v161
  v_fma_f32 v55, v55, v13, v13
  v_pk_mul_f32 v[168:169], v[208:209], v[216:217]
  v_rcp_f32 v162, v162
  v_pk_mul_f32 v[170:171], v[210:211], v[218:219]
  v_rcp_f32 v163, v163
  v_pk_mul_f32 v[164:165], v[10:11], v[212:213] op_sel:[1,0] op_sel_hi:[1,1]
  v_pk_mul_f32 v[166:167], v[10:11], v[214:215] op_sel:[1,0] op_sel_hi:[1,1]
  v_rcp_f32 v52, v52
  v_pk_mul_f32 v[60:61], v[196:197], v[204:205]
  v_rcp_f32 v53, v53
  v_rcp_f32 v54, v54
  v_pk_mul_f32 v[62:63], v[198:199], v[206:207]
  v_rcp_f32 v55, v55
  v_pk_mul_f32 v[168:169], v[168:169], v[160:161]
  v_pk_mul_f32 v[170:171], v[170:171], v[162:163]
  v_exp_f32 v164, v164
  v_exp_f32 v165, v165
  v_exp_f32 v166, v166
  v_exp_f32 v167, v167
  v_pk_mul_f32 v[60:61], v[60:61], v[52:53]
  v_pk_mul_f32 v[62:63], v[62:63], v[54:55]
  v_pk_fma_f32 v[164:165], v[164:165], v[12:13], v[12:13] op_sel:[0,1,1] op_sel_hi:[1,1,1]
  v_pk_fma_f32 v[166:167], v[166:167], v[12:13], v[12:13] op_sel:[0,1,1] op_sel_hi:[1,1,1]
  v_cvt_pk_bf16_f32 v184, v56, v57
  v_cvt_pk_bf16_f32 v185, v58, v59
  v_cvt_pk_bf16_f32 v188, v60, v61
  v_cvt_pk_bf16_f32 v189, v62, v63
  v_rcp_f32 v164, v164
  v_pk_mul_f32 v[172:173], v[212:213], v[220:221]
  v_rcp_f32 v165, v165
  v_rcp_f32 v166, v166
  v_pk_mul_f32 v[174:175], v[214:215], v[222:223]
  v_rcp_f32 v167, v167
  v_pk_mul_f32 v[172:173], v[172:173], v[164:165]
  v_pk_mul_f32 v[174:175], v[174:175], v[166:167]
  v_cvt_pk_bf16_f32 v186, v168, v169
  v_cvt_pk_bf16_f32 v187, v170, v171
  buffer_store_dwordx4 v[184:187], v1, s[12:15], s46 offen sc1
  v_cvt_pk_bf16_f32 v190, v172, v173
  v_cvt_pk_bf16_f32 v191, v174, v175
  buffer_store_dwordx4 v[188:191], v1, s[12:15], s46 offen offset:1024 sc1
  s_add_u32 s43, s43, 36864
  s_xor_b32 s44, s44, 73728
  s_add_u32 s46, s46, 2048
  s_barrier
.p2align 3
f_p1:
  v_mfma_f32_16x16x32_bf16 v[32:35], a[144:147], a[0:3], v[32:35]
  ds_read_b128 a[176:179], v6 offset:8192
  v_add_u32 v14, 1, v14
  v_mfma_f32_16x16x32_bf16 v[36:39], a[144:147], a[4:7], v[36:39]
  ds_read_b32 v224, v230
  s_add_u32 m0, s44, s48
  v_mfma_f32_16x16x32_bf16 v[40:43], a[148:151], a[0:3], v[40:43]
  ds_read_b128 a[180:183], v6 offset:9216
  v_mfma_f32_16x16x32_bf16 v[44:47], a[148:151], a[4:7], v[44:47]
  v_mul_f32 v48, v10, v16
  v_mul_f32 v49, v10, v17
  v_mfma_f32_16x16x32_bf16 v[32:35], a[152:155], a[8:11], v[32:35]
  ds_read_b128 a[184:187], v6 offset:10240
  v_mul_f32 v50, v10, v18
  v_mfma_f32_16x16x32_bf16 v[36:39], a[152:155], a[12:15], v[36:39]
  v_exp_f32 v48, v48
  v_mfma_f32_16x16x32_bf16 v[40:43], a[156:159], a[8:11], v[40:43]
  ds_read_b128 a[188:191], v6 offset:11264
  v_mul_f32 v51, v10, v19
  v_mfma_f32_16x16x32_bf16 v[44:47], a[156:159], a[12:15], v[44:47]
  s_waitcnt lgkmcnt(3)
  v_cmp_gt_u32 vcc, v228, v224
  v_mul_f32 v56, v16, v24
  v_mfma_f32_16x16x32_bf16 v[32:35], a[160:163], a[16:19], v[32:35]
  ds_read_b128 a[144:147], v6 offset:12288
  v_mul_f32 v57, v17, v25
  v_mfma_f32_16x16x32_bf16 v[36:39], a[160:163], a[20:23], v[36:39]
  s_cbranch_vccnz fs0_spin
fs0_back:
  v_exp_f32 v49, v49
  v_mfma_f32_16x16x32_bf16 v[40:43], a[164:167], a[16:19], v[40:43]
  ds_read_b128 a[148:151], v6 offset:13312
  v_mul_f32 v58, v18, v26
  v_mfma_f32_16x16x32_bf16 v[44:47], a[164:167], a[20:23], v[44:47]
  buffer_store_dword v14, v15, s[12:15], s41 offen sc1
  v_mfma_f32_16x16x32_bf16 v[32:35], a[168:171], a[24:27], v[32:35]
  ds_read_b128 a[152:155], v6 offset:14336
  v_mul_f32 v59, v19, v27
  v_mfma_f32_16x16x32_bf16 v[36:39], a[168:171], a[28:31], v[36:39]
  buffer_load_dwordx4 v7, s[16:19], s43 offen sc1 lds
  v_mfma_f32_16x16x32_bf16 v[40:43], a[172:175], a[24:27], v[40:43]
  ds_read_b128 a[156:159], v6 offset:15360
  v_mul_f32 v52, v11, v20
  v_mfma_f32_16x16x32_bf16 v[44:47], a[172:175], a[28:31], v[44:47]
  s_waitcnt lgkmcnt(4)
  v_exp_f32 v50, v50
  v_mfma_f32_16x16x32_bf16 v[32:35], a[176:179], a[32:35], v[32:35]
  ds_read_b128 a[160:163], v6 offset:16384
  v_mul_f32 v53, v11, v21
  v_mfma_f32_16x16x32_bf16 v[36:39], a[176:179], a[36:39], v[36:39]
  v_exp_f32 v51, v51
  v_mfma_f32_16x16x32_bf16 v[40:43], a[180:183], a[32:35], v[40:43]
  ds_read_b128 a[164:167], v6 offset:17408
  v_mul_f32 v54, v11, v22
  v_mfma_f32_16x16x32_bf16 v[44:47], a[180:183], a[36:39], v[44:47]
  buffer_load_dwordx4 v7, s[16:19], s43 offen offset:1024 sc1 lds
  v_mfma_f32_16x16x32_bf16 v[32:35], a[184:187], a[40:43], v[32:35]
  ds_read_b128 a[168:171], v6 offset:18432
  v_mul_f32 v55, v11, v23
  v_mfma_f32_16x16x32_bf16 v[36:39], a[184:187], a[44:47], v[36:39]
  v_exp_f32 v52, v52
  v_mfma_f32_16x16x32_bf16 v[40:43], a[188:191], a[40:43], v[40:43]
  ds_read_b128 a[172:175], v6 offset:19456
  v_fma_f32 v48, v48, v12, v12
  v_mfma_f32_16x16x32_bf16 v[44:47], a[188:191], a[44:47], v[44:47]
  s_waitcnt lgkmcnt(4)
  v_rcp_f32 v48, v48
  v_mfma_f32_16x16x32_bf16 v[32:35], a[144:147], a[48:51], v[32:35]
  ds_read_b128 a[176:179], v6 offset:20480
  v_fma_f32 v49, v49, v12, v12
  v_mfma_f32_16x16x32_bf16 v[36:39], a[144:147], a[52:55], v[36:39]
  buffer_load_dwordx4 v7, s[16:19], s43 offen offset:2048 sc1 lds
  v_mfma_f32_16x16x32_bf16 v[40:43], a[148:151], a[48:51], v[40:43]
  ds_read_b128 a[180:183], v6 offset:21504
  v_fma_f32 v50, v50, v12, v12
  v_mfma_f32_16x16x32_bf16 v[44:47], a[148:151], a[52:55], v[44:47]
  s_add_u32 m0, s44, s49
  v_rcp_f32 v49, v49
  v_mfma_f32_16x16x32_bf16 v[32:35], a[152:155], a[56:59], v[32:35]
  ds_read_b128 a[184:187], v6 offset:22528
  v_fma_f32 v51, v51, v12, v12
  v_mfma_f32_16x16x32_bf16 v[36:39], a[152:155], a[60:63], v[36:39]
  v_rcp_f32 v50, v50
  v_mfma_f32_16x16x32_bf16 v[40:43], a[156:159], a[56:59], v[40:43]
  ds_read_b128 a[188:191], v6 offset:23552
  v_mul_f32 v60, v20, v28
  v_mfma_f32_16x16x32_bf16 v[44:47], a[156:159], a[60:63], v[44:47]
  s_waitcnt lgkmcnt(4)
  v_rcp_f32 v51, v51
  v_mfma_f32_16x16x32_bf16 v[32:35], a[160:163], a[64:67], v[32:35]
  ds_read_b128 a[144:147], v6 offset:24576
  v_mul_f32 v61, v21, v29
  v_mfma_f32_16x16x32_bf16 v[36:39], a[160:163], a[68:71], v[36:39]
  buffer_load_dwordx4 v8, s[16:19], s43 offen sc1 lds
  v_mfma_f32_16x16x32_bf16 v[40:43], a[164:167], a[64:67], v[40:43]
  ds_read_b128 a[148:151], v6 offset:25600
  v_mul_f32 v62, v22, v30
  v_mfma_f32_16x16x32_bf16 v[44:47], a[164:167], a[68:71], v[44:47]
  v_exp_f32 v53, v53
  v_mfma_f32_16x16x32_bf16 v[32:35], a[168:171], a[72:75], v[32:35]
  ds_read_b128 a[152:155], v6 offset:26624
  v_mul_f32 v63, v23, v31
  v_mfma_f32_16x16x32_bf16 v[36:39], a[168:171], a[76:79], v[36:39]
  v_exp_f32 v54, v54
  v_mfma_f32_16x16x32_bf16 v[40:43], a[172:175], a[72:75], v[40:43]
  ds_read_b128 a[156:159], v6 offset:27648
  v_mul_f32 v56, v56, v48
  v_mfma_f32_16x16x32_bf16 v[44:47], a[172:175], a[76:79], v[44:47]
  s_waitcnt lgkmcnt(4)
  v_exp_f32 v55, v55
  v_mfma_f32_16x16x32_bf16 v[32:35], a[176:179], a[80:83], v[32:35]
  ds_read_b128 a[160:163], v6 offset:28672
  v_xor_b32 v5, 73728, v5
  v_mfma_f32_16x16x32_bf16 v[36:39], a[176:179], a[84:87], v[36:39]
  buffer_load_dwordx4 v8, s[16:19], s43 offen offset:1024 sc1 lds
  v_mfma_f32_16x16x32_bf16 v[40:43], a[180:183], a[80:83], v[40:43]
  ds_read_b128 a[164:167], v6 offset:29696
  v_mul_f32 v57, v57, v49
  v_mfma_f32_16x16x32_bf16 v[44:47], a[180:183], a[84:87], v[44:47]
  ds_read2_b32 v[140:141], v148 offset0:0 offset1:0
  v_mul_f32 v58, v58, v50
  v_mfma_f32_16x16x32_bf16 v[32:35], a[184:187], a[88:91], v[32:35]
  ds_read_b128 a[168:171], v6 offset:30720
  v_add_u32 v148, 128, v148
  v_mfma_f32_16x16x32_bf16 v[36:39], a[184:187], a[92:95], v[36:39]
  v_mul_f32 v59, v59, v51
  v_fma_f32 v52, v52, v13, v13
  v_mfma_f32_16x16x32_bf16 v[40:43], a[188:191], a[88:91], v[40:43]
  ds_read_b128 a[172:175], v6 offset:31744
  v_fma_f32 v53, v53, v13, v13
  v_mfma_f32_16x16x32_bf16 v[44:47], a[188:191], a[92:95], v[44:47]
  s_waitcnt lgkmcnt(4)
  v_rcp_f32 v52, v52
  v_mfma_f32_16x16x32_bf16 v[32:35], a[144:147], a[96:99], v[32:35]
  ds_read_b128 a[176:179], v6 offset:32768
  v_fma_f32 v54, v54, v13, v13
  v_mfma_f32_16x16x32_bf16 v[36:39], a[144:147], a[100:103], v[36:39]
  buffer_load_dwordx4 v8, s[16:19], s43 offen offset:2048 sc1 lds
  v_mfma_f32_16x16x32_bf16 v[40:43], a[148:151], a[96:99], v[40:43]
  ds_read_b128 a[180:183], v6 offset:33792
  v_fma_f32 v55, v55, v13, v13
  v_mfma_f32_16x16x32_bf16 v[44:47], a[148:151], a[100:103], v[44:47]
  s_add_u32 m0, s44, s50
  v_rcp_f32 v53, v53
  v_mfma_f32_16x16x32_bf16 v[32:35], a[152:155], a[104:107], v[32:35]
  ds_read_b128 a[184:187], v6 offset:34816
  v_mul_f32 v60, v60, v52
  v_mfma_f32_16x16x32_bf16 v[36:39], a[152:155], a[108:111], v[36:39]
  v_rcp_f32 v54, v54
  v_mfma_f32_16x16x32_bf16 v[40:43], a[156:159], a[104:107], v[40:43]
  ds_read_b128 a[188:191], v6 offset:35840
  v_mul_f32 v61, v61, v53
  v_mfma_f32_16x16x32_bf16 v[44:47], a[156:159], a[108:111], v[44:47]
  s_waitcnt lgkmcnt(4)
  v_rcp_f32 v55, v55
  v_mfma_f32_16x16x32_bf16 v[32:35], a[160:163], a[112:115], v[32:35]
  ds_read_b128 a[144:147], v5 offset:0
  v_mul_f32 v62, v62, v54
  v_mfma_f32_16x16x32_bf16 v[36:39], a[160:163], a[116:119], v[36:39]
  buffer_load_dwordx4 v9, s[16:19], s43 offen sc1 lds
  v_mfma_f32_16x16x32_bf16 v[40:43], a[164:167], a[112:115], v[40:43]
  ds_read_b128 a[148:151], v5 offset:1024
  v_mul_f32 v63, v63, v55
  v_mfma_f32_16x16x32_bf16 v[44:47], a[164:167], a[116:119], v[44:47]
  v_cvt_pk_bf16_f32 v64, v56, v57
  v_cvt_pk_bf16_f32 v65, v58, v59
  v_mfma_f32_16x16x32_bf16 v[32:35], a[168:171], a[120:123], v[32:35]
  ds_read_b128 a[152:155], v5 offset:2048
  v_cvt_pk_bf16_f32 v68, v60, v61
  v_mfma_f32_16x16x32_bf16 v[36:39], a[168:171], a[124:127], v[36:39]
  v_cvt_pk_bf16_f32 v69, v62, v63
  v_mfma_f32_16x16x32_bf16 v[40:43], a[172:175], a[120:123], v[40:43]
  ds_read_b128 a[156:159], v5 offset:3072
  v_add_u32 v228, 1, v228
  v_mfma_f32_16x16x32_bf16 v[44:47], a[172:175], a[124:127], v[44:47]
  s_waitcnt vmcnt(10) lgkmcnt(4)
  v_mfma_f32_16x16x32_bf16 v[32:35], a[176:179], a[128:131], v[32:35]
  ds_read_b128 a[160:163], v5 offset:4096
  v_mfma_f32_16x16x32_bf16 v[36:39], a[176:179], a[132:135], v[36:39]
  ds_write_b32 v229, v228
  v_mfma_f32_16x16x4_4b_bf16 v[16:31], v[140:141], v[132:133], 0
  buffer_load_dwordx4 v9, s[16:19], s43 offen offset:1024 sc1 lds
  v_mfma_f32_16x16x32_bf16 v[40:43], a[180:183], a[128:131], v[40:43]
  ds_read_b128 a[164:167], v5 offset:5120
  v_mfma_f32_16x16x32_bf16 v[44:47], a[180:183], a[132:135], v[44:47]
  v_mfma_f32_16x16x32_bf16 v[32:35], a[184:187], a[136:139], v[32:35]
  ds_read_b128 a[168:171], v5 offset:6144
  v_mfma_f32_16x16x32_bf16 v[36:39], a[184:187], a[140:143], v[36:39]
  buffer_load_dwordx4 v9, s[16:19], s43 offen offset:2048 sc1 lds
  v_mfma_f32_16x16x32_bf16 v[40:43], a[188:191], a[136:139], v[40:43]
  ds_read_b128 a[172:175], v5 offset:7168
  s_add_u32 s43, s43, 36864
  v_mfma_f32_16x16x32_bf16 v[44:47], a[188:191], a[140:143], v[44:47]
  s_waitcnt lgkmcnt(5)
f_p1b:
  v_mfma_f32_16x16x32_bf16 v[16:19], a[144:147], a[0:3], v[16:19]
  ds_read_b128 a[176:179], v5 offset:8192
  s_add_u32 m0, s44, s51
  v_mfma_f32_16x16x32_bf16 v[20:23], a[144:147], a[4:7], v[20:23]
  ds_read_b32 v224, v230
  s_sub_u32 s47, s47, 1
  v_mfma_f32_16x16x32_bf16 v[24:27], a[148:151], a[0:3], v[24:27]
  ds_read_b128 a[180:183], v5 offset:9216
  v_mfma_f32_16x16x32_bf16 v[28:31], a[148:151], a[4:7], v[28:31]
  v_mul_f32 v48, v10, v32
  v_mul_f32 v49, v10, v33
  v_mfma_f32_16x16x32_bf16 v[16:19], a[152:155], a[8:11], v[16:19]
  ds_read_b128 a[184:187], v5 offset:10240
  v_mul_f32 v50, v10, v34
  v_mfma_f32_16x16x32_bf16 v[20:23], a[152:155], a[12:15], v[20:23]
  v_exp_f32 v48, v48
  v_mfma_f32_16x16x32_bf16 v[24:27], a[156:159], a[8:11], v[24:27]
  ds_read_b128 a[188:191], v5 offset:11264
  v_mul_f32 v51, v10, v35
  v_mfma_f32_16x16x32_bf16 v[28:31], a[156:159], a[12:15], v[28:31]
  s_waitcnt lgkmcnt(3)
  v_cmp_gt_u32 vcc, v228, v224
  v_mul_f32 v56, v32, v40
  v_mfma_f32_16x16x32_bf16 v[16:19], a[160:163], a[16:19], v[16:19]
  ds_read_b128 a[144:147], v5 offset:12288
  v_mul_f32 v57, v33, v41
  v_mfma_f32_16x16x32_bf16 v[20:23], a[160:163], a[20:23], v[20:23]
  s_cbranch_vccnz fs1_spin
fs1_back:
  v_exp_f32 v49, v49
  v_mfma_f32_16x16x32_bf16 v[24:27], a[164:167], a[16:19], v[24:27]
  ds_read_b128 a[148:151], v5 offset:13312
  v_mul_f32 v58, v34, v42
  v_mfma_f32_16x16x32_bf16 v[28:31], a[164:167], a[20:23], v[28:31]
  buffer_load_dwordx4 v7, s[16:19], s43 offen sc1 lds
  v_mfma_f32_16x16x32_bf16 v[16:19], a[168:171], a[24:27], v[16:19]
  ds_read_b128 a[152:155], v5 offset:14336
  v_mul_f32 v59, v35, v43
  v_mfma_f32_16x16x32_bf16 v[20:23], a[168:171], a[28:31], v[20:23]
  v_exp_f32 v50, v50
  v_mfma_f32_16x16x32_bf16 v[24:27], a[172:175], a[24:27], v[24:27]
  ds_read_b128 a[156:159], v5 offset:15360
  v_mul_f32 v52, v11, v36
  v_mfma_f32_16x16x32_bf16 v[28:31], a[172:175], a[28:31], v[28:31]
  s_waitcnt lgkmcnt(4)
  v_exp_f32 v51, v51
  v_mfma_f32_16x16x32_bf16 v[16:19], a[176:179], a[32:35], v[16:19]
  ds_read_b128 a[160:163], v5 offset:16384
  v_mul_f32 v53, v11, v37
  v_mfma_f32_16x16x32_bf16 v[20:23], a[176:179], a[36:39], v[20:23]
  buffer_load_dwordx4 v7, s[16:19], s43 offen offset:1024 sc1 lds
  v_mfma_f32_16x16x32_bf16 v[24:27], a[180:183], a[32:35], v[24:27]
  ds_read_b128 a[164:167], v5 offset:17408
  v_mul_f32 v54, v11, v38
  v_mfma_f32_16x16x32_bf16 v[28:31], a[180:183], a[36:39], v[28:31]
  v_exp_f32 v52, v52
  v_mfma_f32_16x16x32_bf16 v[16:19], a[184:187], a[40:43], v[16:19]
  ds_read_b128 a[168:171], v5 offset:18432
  v_mul_f32 v55, v11, v39
  v_mfma_f32_16x16x32_bf16 v[20:23], a[184:187], a[44:47], v[20:23]
  v_exp_f32 v53, v53
  v_mfma_f32_16x16x32_bf16 v[24:27], a[188:191], a[40:43], v[24:27]
  ds_read_b128 a[172:175], v5 offset:19456
  v_fma_f32 v48, v48, v12, v12
  v_mfma_f32_16x16x32_bf16 v[28:31], a[188:191], a[44:47], v[28:31]
  s_waitcnt lgkmcnt(4)
  v_rcp_f32 v48, v48
  v_mfma_f32_16x16x32_bf16 v[16:19], a[144:147], a[48:51], v[16:19]
  ds_read_b128 a[176:179], v5 offset:20480
  v_fma_f32 v49, v49, v12, v12
  v_mfma_f32_16x16x32_bf16 v[20:23], a[144:147], a[52:55], v[20:23]
  buffer_load_dwordx4 v7, s[16:19], s43 offen offset:2048 sc1 lds
  v_mfma_f32_16x16x32_bf16 v[24:27], a[148:151], a[48:51], v[24:27]
  ds_read_b128 a[180:183], v5 offset:21504
  s_add_u32 m0, s44, s52
  v_mfma_f32_16x16x32_bf16 v[28:31], a[148:151], a[52:55], v[28:31]
  v_rcp_f32 v49, v49
  v_mfma_f32_16x16x32_bf16 v[16:19], a[152:155], a[56:59], v[16:19]
  ds_read_b128 a[184:187], v5 offset:22528
  v_fma_f32 v50, v50, v12, v12
  v_mfma_f32_16x16x32_bf16 v[20:23], a[152:155], a[60:63], v[20:23]
  buffer_load_dwordx4 v8, s[16:19], s43 offen sc1 lds
  v_mfma_f32_16x16x32_bf16 v[24:27], a[156:159], a[56:59], v[24:27]
  ds_read_b128 a[188:191], v5 offset:23552
  v_fma_f32 v51, v51, v12, v12
  v_mfma_f32_16x16x32_bf16 v[28:31], a[156:159], a[60:63], v[28:31]
  s_waitcnt lgkmcnt(4)
  v_rcp_f32 v50, v50
  v_mfma_f32_16x16x32_bf16 v[16:19], a[160:163], a[64:67], v[16:19]
  ds_read_b128 a[144:147], v5 offset:24576
  v_mul_f32 v60, v36, v44
  v_mfma_f32_16x16x32_bf16 v[20:23], a[160:163], a[68:71], v[20:23]
  v_rcp_f32 v51, v51
  v_mfma_f32_16x16x32_bf16 v[24:27], a[164:167], a[64:67], v[24:27]
  ds_read_b128 a[148:151], v5 offset:25600
  v_mul_f32 v61, v37, v45
  v_mfma_f32_16x16x32_bf16 v[28:31], a[164:167], a[68:71], v[28:31]
  buffer_load_dwordx4 v8, s[16:19], s43 offen offset:1024 sc1 lds
  v_mfma_f32_16x16x32_bf16 v[16:19], a[168:171], a[72:75], v[16:19]
  ds_read_b128 a[152:155], v5 offset:26624
  v_mul_f32 v62, v38, v46
  v_mfma_f32_16x16x32_bf16 v[20:23], a[168:171], a[76:79], v[20:23]
  v_exp_f32 v54, v54
  v_mfma_f32_16x16x32_bf16 v[24:27], a[172:175], a[72:75], v[24:27]
  ds_read_b128 a[156:159], v5 offset:27648
  v_mul_f32 v63, v39, v47
  v_mfma_f32_16x16x32_bf16 v[28:31], a[172:175], a[76:79], v[28:31]
  s_waitcnt lgkmcnt(4)
  v_exp_f32 v55, v55
  v_mfma_f32_16x16x32_bf16 v[16:19], a[176:179], a[80:83], v[16:19]
  ds_read_b128 a[160:163], v5 offset:28672
  v_xor_b32 v6, 73728, v6
  v_mfma_f32_16x16x32_bf16 v[20:23], a[176:179], a[84:87], v[20:23]
  buffer_load_dwordx4 v8, s[16:19], s43 offen offset:2048 sc1 lds
  v_mfma_f32_16x16x32_bf16 v[24:27], a[180:183], a[80:83], v[24:27]
  ds_read_b128 a[164:167], v5 offset:29696
  s_add_u32 m0, s44, s53
  v_mfma_f32_16x16x32_bf16 v[28:31], a[180:183], a[84:87], v[28:31]
  ds_read2_b32 v[140:141], v148 offset0:0 offset1:0
  v_mul_f32 v56, v56, v48
  v_mfma_f32_16x16x32_bf16 v[16:19], a[184:187], a[88:91], v[16:19]
  ds_read_b128 a[168:171], v5 offset:30720
  v_add_u32 v148, 128, v148
  v_mfma_f32_16x16x32_bf16 v[20:23], a[184:187], a[92:95], v[20:23]
  buffer_load_dwordx4 v9, s[16:19], s43 offen sc1 lds
  v_mfma_f32_16x16x32_bf16 v[24:27], a[188:191], a[88:91], v[24:27]
  ds_read_b128 a[172:175], v5 offset:31744
  v_mul_f32 v57, v57, v49
  v_mfma_f32_16x16x32_bf16 v[28:31], a[188:191], a[92:95], v[28:31]
  s_waitcnt lgkmcnt(4)
  v_mul_f32 v58, v58, v50
  v_mul_f32 v59, v59, v51
  v_mfma_f32_16x16x32_bf16 v[16:19], a[144:147], a[96:99], v[16:19]
  ds_read_b128 a[176:179], v5 offset:32768
  v_fma_f32 v52, v52, v13, v13
  v_mfma_f32_16x16x32_bf16 v[20:23], a[144:147], a[100:103], v[20:23]
  v_rcp_f32 v52, v52
  v_mfma_f32_16x16x32_bf16 v[24:27], a[148:151], a[96:99], v[24:27]
  ds_read_b128 a[180:183], v5 offset:33792
  v_fma_f32 v53, v53, v13, v13
  v_mfma_f32_16x16x32_bf16 v[28:31], a[148:151], a[100:103], v[28:31]
  buffer_load_dwordx4 v9, s[16:19], s43 offen offset:1024 sc1 lds
  v_mfma_f32_16x16x32_bf16 v[16:19], a[152:155], a[104:107], v[16:19]
  ds_read_b128 a[184:187], v5 offset:34816
  v_fma_f32 v54, v54, v13, v13
  v_mfma_f32_16x16x32_bf16 v[20:23], a[152:155], a[108:111], v[20:23]
  v_rcp_f32 v53, v53
  v_mfma_f32_16x16x32_bf16 v[24:27], a[156:159], a[104:107], v[24:27]
  ds_read_b128 a[188:191], v5 offset:35840
  v_fma_f32 v55, v55, v13, v13
  v_mfma_f32_16x16x32_bf16 v[28:31], a[156:159], a[108:111], v[28:31]
  s_waitcnt lgkmcnt(4)
  v_rcp_f32 v54, v54
  v_mfma_f32_16x16x32_bf16 v[16:19], a[160:163], a[112:115], v[16:19]
  ds_read_b128 a[144:147], v6 offset:0
  v_mul_f32 v60, v60, v52
  v_mfma_f32_16x16x32_bf16 v[20:23], a[160:163], a[116:119], v[20:23]
  buffer_load_dwordx4 v9, s[16:19], s43 offen offset:2048 sc1 lds
  v_mfma_f32_16x16x32_bf16 v[24:27], a[164:167], a[112:115], v[24:27]
  ds_read_b128 a[148:151], v6 offset:1024
  v_mul_f32 v61, v61, v53
  v_mfma_f32_16x16x32_bf16 v[28:31], a[164:167], a[116:119], v[28:31]
  s_add_u32 s43, s43, 36864
  v_rcp_f32 v55, v55
  v_mfma_f32_16x16x32_bf16 v[16:19], a[168:171], a[120:123], v[16:19]
  ds_read_b128 a[152:155], v6 offset:2048
  v_mul_f32 v62, v62, v54
  v_mfma_f32_16x16x32_bf16 v[20:23], a[168:171], a[124:127], v[20:23]
  s_xor_b32 s44, s44, 73728
  v_mul_f32 v63, v63, v55
  v_cvt_pk_bf16_f32 v66, v56, v57
  v_mfma_f32_16x16x32_bf16 v[24:27], a[172:175], a[120:123], v[24:27]
  ds_read_b128 a[156:159], v6 offset:3072
  v_add_u32 v228, 1, v228
  v_mfma_f32_16x16x32_bf16 v[28:31], a[172:175], a[124:127], v[28:31]
  s_waitcnt vmcnt(9) lgkmcnt(4)
  v_cvt_pk_bf16_f32 v67, v58, v59
  v_cvt_pk_bf16_f32 v70, v60, v61
  v_mfma_f32_16x16x32_bf16 v[16:19], a[176:179], a[128:131], v[16:19]
  ds_read_b128 a[160:163], v6 offset:4096
  v_cvt_pk_bf16_f32 v71, v62, v63
  v_mfma_f32_16x16x32_bf16 v[20:23], a[176:179], a[132:135], v[20:23]
  ds_write_b32 v229, v228
  v_mfma_f32_16x16x4_4b_bf16 v[32:47], v[140:141], v[132:133], 0
  buffer_store_dwordx4 v[64:67], v1, s[12:15], s46 offen sc1
  v_mfma_f32_16x16x32_bf16 v[24:27], a[180:183], a[128:131], v[24:27]
  ds_read_b128 a[164:167], v6 offset:5120
  v_mfma_f32_16x16x32_bf16 v[28:31], a[180:183], a[132:135], v[28:31]
  v_mfma_f32_16x16x32_bf16 v[16:19], a[184:187], a[136:139], v[16:19]
  ds_read_b128 a[168:171], v6 offset:6144
  v_mfma_f32_16x16x32_bf16 v[20:23], a[184:187], a[140:143], v[20:23]
  buffer_store_dwordx4 v[68:71], v1, s[12:15], s46 offen offset:1024 sc1
  v_mfma_f32_16x16x32_bf16 v[24:27], a[188:191], a[136:139], v[24:27]
  ds_read_b128 a[172:175], v6 offset:7168
  s_add_u32 s46, s46, 2048
  v_mfma_f32_16x16x32_bf16 v[28:31], a[188:191], a[140:143], v[28:31]
  s_waitcnt lgkmcnt(5)
  s_cmp_lg_u32 s47, 0
  s_cbranch_scc1 f_p1
  v_mfma_f32_16x16x32_bf16 v[32:35], a[144:147], a[0:3], v[32:35]
  ds_read_b128 a[176:179], v6 offset:8192
  s_add_u32 m0, s44, s48
  v_mfma_f32_16x16x32_bf16 v[36:39], a[144:147], a[4:7], v[36:39]
  ds_read_b32 v224, v230
  v_mfma_f32_16x16x32_bf16 v[40:43], a[148:151], a[0:3], v[40:43]
  ds_read_b128 a[180:183], v6 offset:9216
  v_mfma_f32_16x16x32_bf16 v[44:47], a[148:151], a[4:7], v[44:47]
  v_mul_f32 v48, v10, v16
  v_mul_f32 v49, v10, v17
  v_mfma_f32_16x16x32_bf16 v[32:35], a[152:155], a[8:11], v[32:35]
  ds_read_b128 a[184:187], v6 offset:10240
  v_mul_f32 v50, v10, v18
  v_mfma_f32_16x16x32_bf16 v[36:39], a[152:155], a[12:15], v[36:39]
  v_exp_f32 v48, v48
  v_mfma_f32_16x16x32_bf16 v[40:43], a[156:159], a[8:11], v[40:43]
  ds_read_b128 a[188:191], v6 offset:11264
  v_mul_f32 v51, v10, v19
  v_mfma_f32_16x16x32_bf16 v[44:47], a[156:159], a[12:15], v[44:47]
  s_waitcnt lgkmcnt(3)
  v_cmp_gt_u32 vcc, v228, v224
  v_mul_f32 v56, v16, v24
  v_mfma_f32_16x16x32_bf16 v[32:35], a[160:163], a[16:19], v[32:35]
  ds_read_b128 a[144:147], v6 offset:12288
  v_mul_f32 v57, v17, v25
  v_mfma_f32_16x16x32_bf16 v[36:39], a[160:163], a[20:23], v[36:39]
  s_cbranch_vccnz fs2_spin
fs2_back:
  v_exp_f32 v49, v49
  v_mfma_f32_16x16x32_bf16 v[40:43], a[164:167], a[16:19], v[40:43]
  ds_read_b128 a[148:151], v6 offset:13312
  v_mul_f32 v58, v18, v26
  v_mfma_f32_16x16x32_bf16 v[44:47], a[164:167], a[20:23], v[44:47]
  buffer_load_dwordx4 v7, s[16:19], s43 offen sc1 lds
  v_mfma_f32_16x16x32_bf16 v[32:35], a[168:171], a[24:27], v[32:35]
  ds_read_b128 a[152:155], v6 offset:14336
  v_mul_f32 v59, v19, v27
  v_mfma_f32_16x16x32_bf16 v[36:39], a[168:171], a[28:31], v[36:39]
  v_exp_f32 v50, v50
  v_mfma_f32_16x16x32_bf16 v[40:43], a[172:175], a[24:27], v[40:43]
  ds_read_b128 a[156:159], v6 offset:15360
  v_mul_f32 v52, v11, v20
  v_mfma_f32_16x16x32_bf16 v[44:47], a[172:175], a[28:31], v[44:47]
  s_waitcnt lgkmcnt(4)
  v_exp_f32 v51, v51
  v_mfma_f32_16x16x32_bf16 v[32:35], a[176:179], a[32:35], v[32:35]
  ds_read_b128 a[160:163], v6 offset:16384
  v_mul_f32 v53, v11, v21
  v_mfma_f32_16x16x32_bf16 v[36:39], a[176:179], a[36:39], v[36:39]
  buffer_load_dwordx4 v7, s[16:19], s43 offen offset:1024 sc1 lds
  v_mfma_f32_16x16x32_bf16 v[40:43], a[180:183], a[32:35], v[40:43]
  ds_read_b128 a[164:167], v6 offset:17408
  v_mul_f32 v54, v11, v22
  v_mfma_f32_16x16x32_bf16 v[44:47], a[180:183], a[36:39], v[44:47]
  v_exp_f32 v52, v52
  v_mfma_f32_16x16x32_bf16 v[32:35], a[184:187], a[40:43], v[32:35]
  ds_read_b128 a[168:171], v6 offset:18432
  v_mul_f32 v55, v11, v23
  v_mfma_f32_16x16x32_bf16 v[36:39], a[184:187], a[44:47], v[36:39]
  buffer_load_dword v72, v74, s[12:15], s41 offen sc1
  v_mfma_f32_16x16x32_bf16 v[40:43], a[188:191], a[40:43], v[40:43]
  ds_read_b128 a[172:175], v6 offset:19456
  v_fma_f32 v48, v48, v12, v12
  v_mfma_f32_16x16x32_bf16 v[44:47], a[188:191], a[44:47], v[44:47]
  s_waitcnt lgkmcnt(4)
  v_rcp_f32 v48, v48
  v_mfma_f32_16x16x32_bf16 v[32:35], a[144:147], a[48:51], v[32:35]
  ds_read_b128 a[176:179], v6 offset:20480
  v_fma_f32 v49, v49, v12, v12
  v_mfma_f32_16x16x32_bf16 v[36:39], a[144:147], a[52:55], v[36:39]
  buffer_load_dwordx4 v7, s[16:19], s43 offen offset:2048 sc1 lds
  v_mfma_f32_16x16x32_bf16 v[40:43], a[148:151], a[48:51], v[40:43]
  ds_read_b128 a[180:183], v6 offset:21504
  v_fma_f32 v50, v50, v12, v12
  v_mfma_f32_16x16x32_bf16 v[44:47], a[148:151], a[52:55], v[44:47]
  s_add_u32 m0, s44, s49
  v_rcp_f32 v49, v49
  v_mfma_f32_16x16x32_bf16 v[32:35], a[152:155], a[56:59], v[32:35]
  ds_read_b128 a[184:187], v6 offset:22528
  v_fma_f32 v51, v51, v12, v12
  v_mfma_f32_16x16x32_bf16 v[36:39], a[152:155], a[60:63], v[36:39]
  v_rcp_f32 v50, v50
  v_mfma_f32_16x16x32_bf16 v[40:43], a[156:159], a[56:59], v[40:43]
  ds_read_b128 a[188:191], v6 offset:23552
  v_mul_f32 v60, v20, v28
  v_mfma_f32_16x16x32_bf16 v[44:47], a[156:159], a[60:63], v[44:47]
  s_waitcnt lgkmcnt(4)
  v_rcp_f32 v51, v51
  v_mfma_f32_16x16x32_bf16 v[32:35], a[160:163], a[64:67], v[32:35]
  ds_read_b128 a[144:147], v6 offset:24576
  v_mul_f32 v61, v21, v29
  v_mfma_f32_16x16x32_bf16 v[36:39], a[160:163], a[68:71], v[36:39]
  buffer_load_dwordx4 v8, s[16:19], s43 offen sc1 lds
  v_mfma_f32_16x16x32_bf16 v[40:43], a[164:167], a[64:67], v[40:43]
  ds_read_b128 a[148:151], v6 offset:25600
  v_mul_f32 v62, v22, v30
  v_mfma_f32_16x16x32_bf16 v[44:47], a[164:167], a[68:71], v[44:47]
  v_exp_f32 v53, v53
  v_mfma_f32_16x16x32_bf16 v[32:35], a[168:171], a[72:75], v[32:35]
  ds_read_b128 a[152:155], v6 offset:26624
  v_mul_f32 v63, v23, v31
  v_mfma_f32_16x16x32_bf16 v[36:39], a[168:171], a[76:79], v[36:39]
  v_exp_f32 v54, v54
  v_mfma_f32_16x16x32_bf16 v[40:43], a[172:175], a[72:75], v[40:43]
  ds_read_b128 a[156:159], v6 offset:27648
  v_mul_f32 v56, v56, v48
  v_mfma_f32_16x16x32_bf16 v[44:47], a[172:175], a[76:79], v[44:47]
  s_waitcnt lgkmcnt(4)
  v_exp_f32 v55, v55
  v_mfma_f32_16x16x32_bf16 v[32:35], a[176:179], a[80:83], v[32:35]
  ds_read_b128 a[160:163], v6 offset:28672
  v_xor_b32 v5, 73728, v5
  v_mfma_f32_16x16x32_bf16 v[36:39], a[176:179], a[84:87], v[36:39]
  buffer_load_dwordx4 v8, s[16:19], s43 offen offset:1024 sc1 lds
  v_mfma_f32_16x16x32_bf16 v[40:43], a[180:183], a[80:83], v[40:43]
  ds_read_b128 a[164:167], v6 offset:29696
  v_mul_f32 v57, v57, v49
  v_mfma_f32_16x16x32_bf16 v[44:47], a[180:183], a[84:87], v[44:47]
  ds_read2_b32 v[140:141], v148 offset0:0 offset1:0
  v_mul_f32 v58, v58, v50
  v_mfma_f32_16x16x32_bf16 v[32:35], a[184:187], a[88:91], v[32:35]
  ds_read_b128 a[168:171], v6 offset:30720
  v_add_u32 v148, 128, v148
  v_mfma_f32_16x16x32_bf16 v[36:39], a[184:187], a[92:95], v[36:39]
  v_mul_f32 v59, v59, v51
  v_fma_f32 v52, v52, v13, v13
  v_mfma_f32_16x16x32_bf16 v[40:43], a[188:191], a[88:91], v[40:43]
  ds_read_b128 a[172:175], v6 offset:31744
  v_fma_f32 v53, v53, v13, v13
  v_mfma_f32_16x16x32_bf16 v[44:47], a[188:191], a[92:95], v[44:47]
  s_waitcnt lgkmcnt(4)
  v_rcp_f32 v52, v52
  v_mfma_f32_16x16x32_bf16 v[32:35], a[144:147], a[96:99], v[32:35]
  ds_read_b128 a[176:179], v6 offset:32768
  v_fma_f32 v54, v54, v13, v13
  v_mfma_f32_16x16x32_bf16 v[36:39], a[144:147], a[100:103], v[36:39]
  buffer_load_dwordx4 v8, s[16:19], s43 offen offset:2048 sc1 lds
  v_mfma_f32_16x16x32_bf16 v[40:43], a[148:151], a[96:99], v[40:43]
  ds_read_b128 a[180:183], v6 offset:33792
  v_fma_f32 v55, v55, v13, v13
  v_mfma_f32_16x16x32_bf16 v[44:47], a[148:151], a[100:103], v[44:47]
  s_add_u32 m0, s44, s50
  v_rcp_f32 v53, v53
  v_mfma_f32_16x16x32_bf16 v[32:35], a[152:155], a[104:107], v[32:35]
  ds_read_b128 a[184:187], v6 offset:34816
  v_mul_f32 v60, v60, v52
  v_mfma_f32_16x16x32_bf16 v[36:39], a[152:155], a[108:111], v[36:39]
  v_rcp_f32 v54, v54
  v_mfma_f32_16x16x32_bf16 v[40:43], a[156:159], a[104:107], v[40:43]
  ds_read_b128 a[188:191], v6 offset:35840
  v_mul_f32 v61, v61, v53
  v_mfma_f32_16x16x32_bf16 v[44:47], a[156:159], a[108:111], v[44:47]
  s_waitcnt lgkmcnt(4)
  v_rcp_f32 v55, v55
  v_mfma_f32_16x16x32_bf16 v[32:35], a[160:163], a[112:115], v[32:35]
  ds_read_b128 a[144:147], v5 offset:0
  v_mul_f32 v62, v62, v54
  v_mfma_f32_16x16x32_bf16 v[36:39], a[160:163], a[116:119], v[36:39]
  buffer_load_dwordx4 v9, s[16:19], s43 offen sc1 lds
  v_mfma_f32_16x16x32_bf16 v[40:43], a[164:167], a[112:115], v[40:43]
  ds_read_b128 a[148:151], v5 offset:1024
  v_mul_f32 v63, v63, v55
  v_mfma_f32_16x16x32_bf16 v[44:47], a[164:167], a[116:119], v[44:47]
  v_cvt_pk_bf16_f32 v192, v56, v57
  v_cvt_pk_bf16_f32 v193, v58, v59
  v_mfma_f32_16x16x32_bf16 v[32:35], a[168:171], a[120:123], v[32:35]
  ds_read_b128 a[152:155], v5 offset:2048
  v_cvt_pk_bf16_f32 v196, v60, v61
  v_mfma_f32_16x16x32_bf16 v[36:39], a[168:171], a[124:127], v[36:39]
  v_cvt_pk_bf16_f32 v197, v62, v63
  v_mfma_f32_16x16x32_bf16 v[40:43], a[172:175], a[120:123], v[40:43]
  ds_read_b128 a[156:159], v5 offset:3072
  v_add_u32 v228, 1, v228
  v_mfma_f32_16x16x32_bf16 v[44:47], a[172:175], a[124:127], v[44:47]
  s_waitcnt vmcnt(10) lgkmcnt(4)
  v_mfma_f32_16x16x32_bf16 v[32:35], a[176:179], a[128:131], v[32:35]
  ds_read_b128 a[160:163], v5 offset:4096
  v_mfma_f32_16x16x32_bf16 v[36:39], a[176:179], a[132:135], v[36:39]
  ds_write_b32 v229, v228
  v_mfma_f32_16x16x4_4b_bf16 v[16:31], v[140:141], v[132:133], 0
  buffer_load_dwordx4 v9, s[16:19], s43 offen offset:1024 sc1 lds
  v_mfma_f32_16x16x32_bf16 v[40:43], a[180:183], a[128:131], v[40:43]
  ds_read_b128 a[164:167], v5 offset:5120
  v_mfma_f32_16x16x32_bf16 v[44:47], a[180:183], a[132:135], v[44:47]
  v_mfma_f32_16x16x32_bf16 v[32:35], a[184:187], a[136:139], v[32:35]
  ds_read_b128 a[168:171], v5 offset:6144
  v_mfma_f32_16x16x32_bf16 v[36:39], a[184:187], a[140:143], v[36:39]
  buffer_load_dwordx4 v9, s[16:19], s43 offen offset:2048 sc1 lds
  v_mfma_f32_16x16x32_bf16 v[40:43], a[188:191], a[136:139], v[40:43]
  ds_read_b128 a[172:175], v5 offset:7168
  s_add_u32 s43, s43, 36864
  v_mfma_f32_16x16x32_bf16 v[44:47], a[188:191], a[140:143], v[44:47]
  s_waitcnt vmcnt(7) lgkmcnt(5)
  v_mfma_f32_16x16x32_bf16 v[16:19], a[144:147], a[0:3], v[16:19]
  ds_read_b128 a[176:179], v5 offset:8192
  v_cmp_gt_u32 vcc, 5, v72
  v_mfma_f32_16x16x32_bf16 v[20:23], a[144:147], a[4:7], v[20:23]
  ds_read_b32 v224, v230
  s_mov_b32 s47, 0
  v_mfma_f32_16x16x32_bf16 v[24:27], a[148:151], a[0:3], v[24:27]
  ds_read_b128 a[180:183], v5 offset:9216
  s_cbranch_vccnz f12_spin
f12_back:
  v_mfma_f32_16x16x32_bf16 v[28:31], a[148:151], a[4:7], v[28:31]
  buffer_load_dwordx4 a[192:195], v81, s[12:15], s47 offen sc1
  v_mfma_f32_16x16x32_bf16 v[16:19], a[152:155], a[8:11], v[16:19]
  ds_read_b128 a[184:187], v5 offset:10240
  v_mul_f32 v48, v10, v32
  v_mfma_f32_16x16x32_bf16 v[20:23], a[152:155], a[12:15], v[20:23]
  v_exp_f32 v48, v48
  v_mfma_f32_16x16x32_bf16 v[24:27], a[156:159], a[8:11], v[24:27]
  ds_read_b128 a[188:191], v5 offset:11264
  v_mul_f32 v49, v10, v33
  v_mfma_f32_16x16x32_bf16 v[28:31], a[156:159], a[12:15], v[28:31]
  s_waitcnt lgkmcnt(3)
  v_cmp_gt_u32 vcc, v228, v224
  v_mul_f32 v50, v10, v34
  v_mfma_f32_16x16x32_bf16 v[16:19], a[160:163], a[16:19], v[16:19]
  ds_read_b128 a[144:147], v5 offset:12288
  v_mul_f32 v51, v10, v35
  v_mfma_f32_16x16x32_bf16 v[20:23], a[160:163], a[20:23], v[20:23]
  buffer_load_dwordx4 a[196:199], v81, s[12:15], s47 offen offset:1024 sc1
  v_mfma_f32_16x16x32_bf16 v[24:27], a[164:167], a[16:19], v[24:27]
  ds_read_b128 a[148:151], v5 offset:13312
  s_cbranch_vccnz fs4_spin
fs4_back:
  v_mfma_f32_16x16x32_bf16 v[28:31], a[164:167], a[20:23], v[28:31]
  s_add_u32 m0, s44, s51
  v_exp_f32 v49, v49
  v_mfma_f32_16x16x32_bf16 v[16:19], a[168:171], a[24:27], v[16:19]
  ds_read_b128 a[152:155], v5 offset:14336
  v_mul_f32 v56, v32, v40
  v_mfma_f32_16x16x32_bf16 v[20:23], a[168:171], a[28:31], v[20:23]
  buffer_load_dwordx4 v7, s[16:19], s43 offen sc1 lds
  v_mfma_f32_16x16x32_bf16 v[24:27], a[172:175], a[24:27], v[24:27]
  ds_read_b128 a[156:159], v5 offset:15360
  v_mul_f32 v57, v33, v41
  v_mfma_f32_16x16x32_bf16 v[28:31], a[172:175], a[28:31], v[28:31]
  s_waitcnt lgkmcnt(4)
  v_exp_f32 v50, v50
  v_mfma_f32_16x16x32_bf16 v[16:19], a[176:179], a[32:35], v[16:19]
  ds_read_b128 a[160:163], v5 offset:16384
  v_mul_f32 v58, v34, v42
  v_mfma_f32_16x16x32_bf16 v[20:23], a[176:179], a[36:39], v[20:23]
  buffer_load_dwordx4 a[200:203], v82, s[12:15], s47 offen sc1
  v_mfma_f32_16x16x32_bf16 v[24:27], a[180:183], a[32:35], v[24:27]
  ds_read_b128 a[164:167], v5 offset:17408
  v_mul_f32 v59, v35, v43
  v_mfma_f32_16x16x32_bf16 v[28:31], a[180:183], a[36:39], v[28:31]
  v_exp_f32 v51, v51
  v_mfma_f32_16x16x32_bf16 v[16:19], a[184:187], a[40:43], v[16:19]
  ds_read_b128 a[168:171], v5 offset:18432
  v_mul_f32 v52, v11, v36
  v_mfma_f32_16x16x32_bf16 v[20:23], a[184:187], a[44:47], v[20:23]
  buffer_load_dwordx4 v7, s[16:19], s43 offen offset:1024 sc1 lds
  v_mfma_f32_16x16x32_bf16 v[24:27], a[188:191], a[40:43], v[24:27]
  ds_read_b128 a[172:175], v5 offset:19456
  v_mul_f32 v53, v11, v37
  v_mfma_f32_16x16x32_bf16 v[28:31], a[188:191], a[44:47], v[28:31]
  s_waitcnt lgkmcnt(4)
  v_exp_f32 v52, v52
  v_mfma_f32_16x16x32_bf16 v[16:19], a[144:147], a[48:51], v[16:19]
  ds_read_b128 a[176:179], v5 offset:20480
  v_mul_f32 v54, v11, v38
  v_mfma_f32_16x16x32_bf16 v[20:23], a[144:147], a[52:55], v[20:23]
  buffer_load_dwordx4 v7, s[16:19], s43 offen offset:2048 sc1 lds
  v_mfma_f32_16x16x32_bf16 v[24:27], a[148:151], a[48:51], v[24:27]
  ds_read_b128 a[180:183], v5 offset:21504
  s_add_u32 m0, s44, s52
  v_mfma_f32_16x16x32_bf16 v[28:31], a[148:151], a[52:55], v[28:31]
  v_exp_f32 v53, v53
  v_mfma_f32_16x16x32_bf16 v[16:19], a[152:155], a[56:59], v[16:19]
  ds_read_b128 a[184:187], v5 offset:22528
  v_mul_f32 v55, v11, v39
  v_mfma_f32_16x16x32_bf16 v[20:23], a[152:155], a[60:63], v[20:23]
  buffer_load_dwordx4 v8, s[16:19], s43 offen sc1 lds
  v_mfma_f32_16x16x32_bf16 v[24:27], a[156:159], a[56:59], v[24:27]
  ds_read_b128 a[188:191], v5 offset:23552
  v_fma_f32 v48, v48, v12, v12
  v_mfma_f32_16x16x32_bf16 v[28:31], a[156:159], a[60:63], v[28:31]
  s_waitcnt lgkmcnt(4)
  v_rcp_f32 v48, v48
  v_mfma_f32_16x16x32_bf16 v[16:19], a[160:163], a[64:67], v[16:19]
  ds_read_b128 a[144:147], v5 offset:24576
  v_fma_f32 v49, v49, v12, v12
  v_mfma_f32_16x16x32_bf16 v[20:23], a[160:163], a[68:71], v[20:23]
  v_rcp_f32 v49, v49
  v_mfma_f32_16x16x32_bf16 v[24:27], a[164:167], a[64:67], v[24:27]
  ds_read_b128 a[148:151], v5 offset:25600
  v_fma_f32 v50, v50, v12, v12
  v_mfma_f32_16x16x32_bf16 v[28:31], a[164:167], a[68:71], v[28:31]
  buffer_load_dwordx4 v8, s[16:19], s43 offen offset:1024 sc1 lds
  v_mfma_f32_16x16x32_bf16 v[16:19], a[168:171], a[72:75], v[16:19]
  ds_read_b128 a[152:155], v5 offset:26624
  v_fma_f32 v51, v51, v12, v12
  v_mfma_f32_16x16x32_bf16 v[20:23], a[168:171], a[76:79], v[20:23]
  v_rcp_f32 v50, v50
  v_mfma_f32_16x16x32_bf16 v[24:27], a[172:175], a[72:75], v[24:27]
  ds_read_b128 a[156:159], v5 offset:27648
  v_mul_f32 v60, v36, v44
  v_mfma_f32_16x16x32_bf16 v[28:31], a[172:175], a[76:79], v[28:31]
  s_waitcnt lgkmcnt(4)
  v_rcp_f32 v51, v51
  v_mfma_f32_16x16x32_bf16 v[16:19], a[176:179], a[80:83], v[16:19]
  ds_read_b128 a[160:163], v5 offset:28672
  v_xor_b32 v6, 73728, v6
  v_mfma_f32_16x16x32_bf16 v[20:23], a[176:179], a[84:87], v[20:23]
  buffer_load_dwordx4 v8, s[16:19], s43 offen offset:2048 sc1 lds
  v_mfma_f32_16x16x32_bf16 v[24:27], a[180:183], a[80:83], v[24:27]
  ds_read_b128 a[164:167], v5 offset:29696
  s_add_u32 m0, s44, s53
  v_mfma_f32_16x16x32_bf16 v[28:31], a[180:183], a[84:87], v[28:31]
  ds_read2_b32 v[140:141], v148 offset0:0 offset1:0
  v_mul_f32 v61, v37, v45
  v_mfma_f32_16x16x32_bf16 v[16:19], a[184:187], a[88:91], v[16:19]
  ds_read_b128 a[168:171], v5 offset:30720
  v_add_u32 v148, 128, v148
  v_mfma_f32_16x16x32_bf16 v[20:23], a[184:187], a[92:95], v[20:23]
  buffer_load_dwordx4 v9, s[16:19], s43 offen sc1 lds
  v_mfma_f32_16x16x32_bf16 v[24:27], a[188:191], a[88:91], v[24:27]
  ds_read_b128 a[172:175], v5 offset:31744
  v_mul_f32 v62, v38, v46
  v_mfma_f32_16x16x32_bf16 v[28:31], a[188:191], a[92:95], v[28:31]
  s_waitcnt lgkmcnt(4)
  v_exp_f32 v54, v54
  v_mfma_f32_16x16x32_bf16 v[16:19], a[144:147], a[96:99], v[16:19]
  ds_read_b128 a[176:179], v5 offset:32768
  v_mul_f32 v63, v39, v47
  v_mfma_f32_16x16x32_bf16 v[20:23], a[144:147], a[100:103], v[20:23]
  v_exp_f32 v55, v55
  v_mfma_f32_16x16x32_bf16 v[24:27], a[148:151], a[96:99], v[24:27]
  ds_read_b128 a[180:183], v5 offset:33792
  v_mul_f32 v56, v56, v48
  v_mfma_f32_16x16x32_bf16 v[28:31], a[148:151], a[100:103], v[28:31]
  buffer_load_dwordx4 v9, s[16:19], s43 offen offset:1024 sc1 lds
  v_mfma_f32_16x16x32_bf16 v[16:19], a[152:155], a[104:107], v[16:19]
  ds_read_b128 a[184:187], v5 offset:34816
  v_mul_f32 v57, v57, v49
  v_mfma_f32_16x16x32_bf16 v[20:23], a[152:155], a[108:111], v[20:23]
  v_mul_f32 v58, v58, v50
  v_mul_f32 v59, v59, v51
  v_mfma_f32_16x16x32_bf16 v[24:27], a[156:159], a[104:107], v[24:27]
  ds_read_b128 a[188:191], v5 offset:35840
  v_fma_f32 v52, v52, v13, v13
  v_mfma_f32_16x16x32_bf16 v[28:31], a[156:159], a[108:111], v[28:31]
  s_waitcnt lgkmcnt(4)
  v_rcp_f32 v52, v52
  v_mfma_f32_16x16x32_bf16 v[16:19], a[160:163], a[112:115], v[16:19]
  ds_read_b128 a[144:147], v6 offset:0
  v_fma_f32 v53, v53, v13, v13
  v_mfma_f32_16x16x32_bf16 v[20:23], a[160:163], a[116:119], v[20:23]
  buffer_load_dwordx4 v9, s[16:19], s43 offen offset:2048 sc1 lds
  v_mfma_f32_16x16x32_bf16 v[24:27], a[164:167], a[112:115], v[24:27]
  ds_read_b128 a[148:151], v6 offset:1024
  v_fma_f32 v54, v54, v13, v13
  v_mfma_f32_16x16x32_bf16 v[28:31], a[164:167], a[116:119], v[28:31]
  s_add_u32 s43, s43, 36864
  v_rcp_f32 v53, v53
  v_mfma_f32_16x16x32_bf16 v[16:19], a[168:171], a[120:123], v[16:19]
  ds_read_b128 a[152:155], v6 offset:2048
  v_fma_f32 v55, v55, v13, v13
  v_mfma_f32_16x16x32_bf16 v[20:23], a[168:171], a[124:127], v[20:23]
  s_xor_b32 s44, s44, 73728
  v_rcp_f32 v54, v54
  v_mfma_f32_16x16x32_bf16 v[24:27], a[172:175], a[120:123], v[24:27]
  ds_read_b128 a[156:159], v6 offset:3072
  v_add_u32 v228, 1, v228
  v_mfma_f32_16x16x32_bf16 v[28:31], a[172:175], a[124:127], v[28:31]
  s_waitcnt vmcnt(12) lgkmcnt(4)
  v_rcp_f32 v55, v55
  v_mfma_f32_16x16x32_bf16 v[16:19], a[176:179], a[128:131], v[16:19]
  ds_read_b128 a[160:163], v6 offset:4096
  v_mul_f32 v60, v60, v52
  v_mfma_f32_16x16x32_bf16 v[20:23], a[176:179], a[132:135], v[20:23]
  ds_write_b32 v229, v228
  v_mul_f32 v61, v61, v53
  v_mfma_f32_16x16x4_4b_bf16 v[32:47], v[140:141], v[132:133], 0
  v_mul_f32 v62, v62, v54
  v_mul_f32 v63, v63, v55
  v_cvt_pk_bf16_f32 v194, v56, v57
  v_cvt_pk_bf16_f32 v195, v58, v59
  v_cvt_pk_bf16_f32 v198, v60, v61
  v_cvt_pk_bf16_f32 v199, v62, v63
  v_mfma_f32_16x16x32_bf16 v[24:27], a[180:183], a[128:131], v[24:27]
  ds_read_b128 a[164:167], v6 offset:5120
  v_mfma_f32_16x16x32_bf16 v[28:31], a[180:183], a[132:135], v[28:31]
  buffer_store_dwordx4 v[192:195], v1, s[12:15], s46 offen sc1
  v_mfma_f32_16x16x32_bf16 v[16:19], a[184:187], a[136:139], v[16:19]
  ds_read_b128 a[168:171], v6 offset:6144
  v_mfma_f32_16x16x32_bf16 v[20:23], a[184:187], a[140:143], v[20:23]
  v_mfma_f32_16x16x32_bf16 v[24:27], a[188:191], a[136:139], v[24:27]
  ds_read_b128 a[172:175], v6 offset:7168
  v_mfma_f32_16x16x32_bf16 v[28:31], a[188:191], a[140:143], v[28:31]
  s_waitcnt lgkmcnt(5)
  buffer_store_dwordx4 v[196:199], v1, s[12:15], s46 offen offset:1024 sc1
  s_add_u32 s46, s46, 2048
  v_mfma_f32_16x16x32_bf16 v[32:35], a[144:147], a[0:3], v[32:35]
  ds_read_b128 a[176:179], v6 offset:8192
  s_mov_b32 s47, 0
  v_mfma_f32_16x16x32_bf16 v[36:39], a[144:147], a[4:7], v[36:39]
  ds_read_b32 v224, v230
  v_mfma_f32_16x16x32_bf16 v[40:43], a[148:151], a[0:3], v[40:43]
  ds_read_b128 a[180:183], v6 offset:9216
  v_mfma_f32_16x16x32_bf16 v[44:47], a[148:151], a[4:7], v[44:47]
  buffer_load_dwordx4 a[204:207], v82, s[12:15], s47 offen offset:1024 sc1
  v_mfma_f32_16x16x32_bf16 v[32:35], a[152:155], a[8:11], v[32:35]
  ds_read_b128 a[184:187], v6 offset:10240
  v_mul_f32 v48, v10, v16
  v_mfma_f32_16x16x32_bf16 v[36:39], a[152:155], a[12:15], v[36:39]
  v_exp_f32 v48, v48
  v_mfma_f32_16x16x32_bf16 v[40:43], a[156:159], a[8:11], v[40:43]
  ds_read_b128 a[188:191], v6 offset:11264
  v_mul_f32 v49, v10, v17
  v_mfma_f32_16x16x32_bf16 v[44:47], a[156:159], a[12:15], v[44:47]
  s_waitcnt lgkmcnt(3)
  v_cmp_gt_u32 vcc, v228, v224
  v_mul_f32 v50, v10, v18
  v_mfma_f32_16x16x32_bf16 v[32:35], a[160:163], a[16:19], v[32:35]
  ds_read_b128 a[144:147], v6 offset:12288
  v_mul_f32 v51, v10, v19
  v_mfma_f32_16x16x32_bf16 v[36:39], a[160:163], a[20:23], v[36:39]
  buffer_load_dwordx4 a[208:211], v83, s[12:15], s47 offen sc1
  v_mfma_f32_16x16x32_bf16 v[40:43], a[164:167], a[16:19], v[40:43]
  ds_read_b128 a[148:151], v6 offset:13312
  s_cbranch_vccnz fs5_spin
fs5_back:
  v_mfma_f32_16x16x32_bf16 v[44:47], a[164:167], a[20:23], v[44:47]
  s_add_u32 m0, s44, s48
  v_exp_f32 v49, v49
  v_mfma_f32_16x16x32_bf16 v[32:35], a[168:171], a[24:27], v[32:35]
  ds_read_b128 a[152:155], v6 offset:14336
  v_mul_f32 v56, v16, v24
  v_mfma_f32_16x16x32_bf16 v[36:39], a[168:171], a[28:31], v[36:39]
  buffer_load_dwordx4 v7, s[16:19], s43 offen sc1 lds
  v_mfma_f32_16x16x32_bf16 v[40:43], a[172:175], a[24:27], v[40:43]
  ds_read_b128 a[156:159], v6 offset:15360
  v_mul_f32 v57, v17, v25
  v_mfma_f32_16x16x32_bf16 v[44:47], a[172:175], a[28:31], v[44:47]
  s_waitcnt lgkmcnt(4)
  v_exp_f32 v50, v50
  v_mfma_f32_16x16x32_bf16 v[32:35], a[176:179], a[32:35], v[32:35]
  ds_read_b128 a[160:163], v6 offset:16384
  v_mul_f32 v58, v18, v26
  v_mfma_f32_16x16x32_bf16 v[36:39], a[176:179], a[36:39], v[36:39]
  v_exp_f32 v51, v51
  v_mfma_f32_16x16x32_bf16 v[40:43], a[180:183], a[32:35], v[40:43]
  ds_read_b128 a[164:167], v6 offset:17408
  v_mul_f32 v59, v19, v27
  v_mfma_f32_16x16x32_bf16 v[44:47], a[180:183], a[36:39], v[44:47]
  buffer_load_dwordx4 a[212:215], v83, s[12:15], s47 offen offset:1024 sc1
  v_mfma_f32_16x16x32_bf16 v[32:35], a[184:187], a[40:43], v[32:35]
  ds_read_b128 a[168:171], v6 offset:18432
  v_mul_f32 v52, v11, v20
  v_mfma_f32_16x16x32_bf16 v[36:39], a[184:187], a[44:47], v[36:39]
  v_exp_f32 v52, v52
  v_mfma_f32_16x16x32_bf16 v[40:43], a[188:191], a[40:43], v[40:43]
  ds_read_b128 a[172:175], v6 offset:19456
  v_mul_f32 v53, v11, v21
  v_mfma_f32_16x16x32_bf16 v[44:47], a[188:191], a[44:47], v[44:47]
  s_waitcnt lgkmcnt(4)
  v_exp_f32 v53, v53
  v_mfma_f32_16x16x32_bf16 v[32:35], a[144:147], a[48:51], v[32:35]
  ds_read_b128 a[176:179], v6 offset:20480
  v_mul_f32 v54, v11, v22
  v_mfma_f32_16x16x32_bf16 v[36:39], a[144:147], a[52:55], v[36:39]
  buffer_load_dwordx4 v7, s[16:19], s43 offen offset:1024 sc1 lds
  v_mfma_f32_16x16x32_bf16 v[40:43], a[148:151], a[48:51], v[40:43]
  ds_read_b128 a[180:183], v6 offset:21504
  v_mul_f32 v55, v11, v23
  v_mfma_f32_16x16x32_bf16 v[44:47], a[148:151], a[52:55], v[44:47]
  v_exp_f32 v54, v54
  v_mfma_f32_16x16x32_bf16 v[32:35], a[152:155], a[56:59], v[32:35]
  ds_read_b128 a[184:187], v6 offset:22528
  v_fma_f32 v48, v48, v12, v12
  v_mfma_f32_16x16x32_bf16 v[36:39], a[152:155], a[60:63], v[36:39]
  buffer_load_dwordx4 v7, s[16:19], s43 offen offset:2048 sc1 lds
  v_mfma_f32_16x16x32_bf16 v[40:43], a[156:159], a[56:59], v[40:43]
  ds_read_b128 a[188:191], v6 offset:23552
  v_fma_f32 v49, v49, v12, v12
  v_mfma_f32_16x16x32_bf16 v[44:47], a[156:159], a[60:63], v[44:47]
  s_waitcnt lgkmcnt(4)
  v_rcp_f32 v48, v48
  v_mfma_f32_16x16x32_bf16 v[32:35], a[160:163], a[64:67], v[32:35]
  ds_read_b128 a[144:147], v6 offset:24576
  s_add_u32 m0, s44, s49
  v_mfma_f32_16x16x32_bf16 v[36:39], a[160:163], a[68:71], v[36:39]
  v_rcp_f32 v49, v49
  v_mfma_f32_16x16x32_bf16 v[40:43], a[164:167], a[64:67], v[40:43]
  ds_read_b128 a[148:151], v6 offset:25600
  v_fma_f32 v50, v50, v12, v12
  v_mfma_f32_16x16x32_bf16 v[44:47], a[164:167], a[68:71], v[44:47]
  buffer_load_dwordx4 v8, s[16:19], s43 offen sc1 lds
  v_mfma_f32_16x16x32_bf16 v[32:35], a[168:171], a[72:75], v[32:35]
  ds_read_b128 a[152:155], v6 offset:26624
  v_fma_f32 v51, v51, v12, v12
  v_mfma_f32_16x16x32_bf16 v[36:39], a[168:171], a[76:79], v[36:39]
  v_rcp_f32 v50, v50
  v_mfma_f32_16x16x32_bf16 v[40:43], a[172:175], a[72:75], v[40:43]
  ds_read_b128 a[156:159], v6 offset:27648
  v_mul_f32 v60, v20, v28
  v_mfma_f32_16x16x32_bf16 v[44:47], a[172:175], a[76:79], v[44:47]
  s_waitcnt lgkmcnt(4)
  v_rcp_f32 v51, v51
  v_mfma_f32_16x16x32_bf16 v[32:35], a[176:179], a[80:83], v[32:35]
  ds_read_b128 a[160:163], v6 offset:28672
  v_xor_b32 v5, 73728, v5
  v_mfma_f32_16x16x32_bf16 v[36:39], a[176:179], a[84:87], v[36:39]
  buffer_load_dwordx4 v8, s[16:19], s43 offen offset:1024 sc1 lds
  v_mfma_f32_16x16x32_bf16 v[40:43], a[180:183], a[80:83], v[40:43]
  ds_read_b128 a[164:167], v6 offset:29696
  v_mul_f32 v61, v21, v29
  v_mfma_f32_16x16x32_bf16 v[44:47], a[180:183], a[84:87], v[44:47]
  ds_read2_b32 v[140:141], v148 offset0:0 offset1:0
  v_mul_f32 v62, v22, v30
  v_mfma_f32_16x16x32_bf16 v[32:35], a[184:187], a[88:91], v[32:35]
  ds_read_b128 a[168:171], v6 offset:30720
  v_add_u32 v148, 128, v148
  v_mfma_f32_16x16x32_bf16 v[36:39], a[184:187], a[92:95], v[36:39]
  buffer_load_dwordx4 a[216:219], v81, s[12:15], s47 offen offset:2048 sc1
  v_mfma_f32_16x16x32_bf16 v[40:43], a[188:191], a[88:91], v[40:43]
  ds_read_b128 a[172:175], v6 offset:31744
  v_mul_f32 v63, v23, v31
  v_mfma_f32_16x16x32_bf16 v[44:47], a[188:191], a[92:95], v[44:47]
  s_waitcnt lgkmcnt(4)
  v_exp_f32 v55, v55
  v_mfma_f32_16x16x32_bf16 v[32:35], a[144:147], a[96:99], v[32:35]
  ds_read_b128 a[176:179], v6 offset:32768
  v_mul_f32 v56, v56, v48
  v_mfma_f32_16x16x32_bf16 v[36:39], a[144:147], a[100:103], v[36:39]
  v_mul_f32 v57, v57, v49
  v_mul_f32 v58, v58, v50
  v_mfma_f32_16x16x32_bf16 v[40:43], a[148:151], a[96:99], v[40:43]
  ds_read_b128 a[180:183], v6 offset:33792
  v_mul_f32 v59, v59, v51
  v_mfma_f32_16x16x32_bf16 v[44:47], a[148:151], a[100:103], v[44:47]
  buffer_load_dwordx4 v8, s[16:19], s43 offen offset:2048 sc1 lds
  v_mfma_f32_16x16x32_bf16 v[32:35], a[152:155], a[104:107], v[32:35]
  ds_read_b128 a[184:187], v6 offset:34816
  v_fma_f32 v52, v52, v13, v13
  v_mfma_f32_16x16x32_bf16 v[36:39], a[152:155], a[108:111], v[36:39]
  s_add_u32 m0, s44, s50
  v_rcp_f32 v52, v52
  v_mfma_f32_16x16x32_bf16 v[40:43], a[156:159], a[104:107], v[40:43]
  ds_read_b128 a[188:191], v6 offset:35840
  v_fma_f32 v53, v53, v13, v13
  v_mfma_f32_16x16x32_bf16 v[44:47], a[156:159], a[108:111], v[44:47]
  s_waitcnt lgkmcnt(4)
  v_rcp_f32 v53, v53
  v_mfma_f32_16x16x32_bf16 v[32:35], a[160:163], a[112:115], v[32:35]
  ds_read_b128 a[144:147], v5 offset:0
  v_fma_f32 v54, v54, v13, v13
  v_mfma_f32_16x16x32_bf16 v[36:39], a[160:163], a[116:119], v[36:39]
  buffer_load_dwordx4 v9, s[16:19], s43 offen sc1 lds
  v_mfma_f32_16x16x32_bf16 v[40:43], a[164:167], a[112:115], v[40:43]
  ds_read_b128 a[148:151], v5 offset:1024
  v_fma_f32 v55, v55, v13, v13
  v_mfma_f32_16x16x32_bf16 v[44:47], a[164:167], a[116:119], v[44:47]
  v_rcp_f32 v54, v54
  v_mfma_f32_16x16x32_bf16 v[32:35], a[168:171], a[120:123], v[32:35]
  ds_read_b128 a[152:155], v5 offset:2048
  v_mul_f32 v60, v60, v52
  v_mfma_f32_16x16x32_bf16 v[36:39], a[168:171], a[124:127], v[36:39]
  v_rcp_f32 v55, v55
  v_mfma_f32_16x16x32_bf16 v[40:43], a[172:175], a[120:123], v[40:43]
  ds_read_b128 a[156:159], v5 offset:3072
  v_add_u32 v228, 1, v228
  v_mfma_f32_16x16x32_bf16 v[44:47], a[172:175], a[124:127], v[44:47]
  s_waitcnt vmcnt(13) lgkmcnt(4)
  v_mul_f32 v61, v61, v53
  v_mul_f32 v62, v62, v54
  v_mfma_f32_16x16x32_bf16 v[32:35], a[176:179], a[128:131], v[32:35]
  ds_read_b128 a[160:163], v5 offset:4096
  v_mul_f32 v63, v63, v55
  v_mfma_f32_16x16x32_bf16 v[36:39], a[176:179], a[132:135], v[36:39]
  ds_write_b32 v229, v228
  v_cvt_pk_bf16_f32 v200, v56, v57
  v_mfma_f32_16x16x4_4b_bf16 v[16:31], v[140:141], v[132:133], 0
  buffer_load_dwordx4 v9, s[16:19], s43 offen offset:1024 sc1 lds
  v_cvt_pk_bf16_f32 v201, v58, v59
  v_cvt_pk_bf16_f32 v204, v60, v61
  v_cvt_pk_bf16_f32 v205, v62, v63
  v_mfma_f32_16x16x32_bf16 v[40:43], a[180:183], a[128:131], v[40:43]
  ds_read_b128 a[164:167], v5 offset:5120
  v_mfma_f32_16x16x32_bf16 v[44:47], a[180:183], a[132:135], v[44:47]
  v_mfma_f32_16x16x32_bf16 v[32:35], a[184:187], a[136:139], v[32:35]
  ds_read_b128 a[168:171], v5 offset:6144
  v_mfma_f32_16x16x32_bf16 v[36:39], a[184:187], a[140:143], v[36:39]
  buffer_load_dwordx4 v9, s[16:19], s43 offen offset:2048 sc1 lds
  v_mfma_f32_16x16x32_bf16 v[40:43], a[188:191], a[136:139], v[40:43]
  ds_read_b128 a[172:175], v5 offset:7168
  s_add_u32 s43, s43, 36864
  v_mfma_f32_16x16x32_bf16 v[44:47], a[188:191], a[140:143], v[44:47]
  s_waitcnt lgkmcnt(5)
  v_mfma_f32_16x16x32_bf16 v[16:19], a[144:147], a[0:3], v[16:19]
  ds_read_b128 a[176:179], v5 offset:8192
  s_mov_b32 s47, 0
  v_mfma_f32_16x16x32_bf16 v[20:23], a[144:147], a[4:7], v[20:23]
  ds_read_b32 v224, v230
  v_mfma_f32_16x16x32_bf16 v[24:27], a[148:151], a[0:3], v[24:27]
  ds_read_b128 a[180:183], v5 offset:9216
  v_mfma_f32_16x16x32_bf16 v[28:31], a[148:151], a[4:7], v[28:31]
  buffer_load_dwordx4 a[220:223], v81, s[12:15], s47 offen offset:3072 sc1
  v_mfma_f32_16x16x32_bf16 v[16:19], a[152:155], a[8:11], v[16:19]
  ds_read_b128 a[184:187], v5 offset:10240
  v_mul_f32 v48, v10, v32
  v_mfma_f32_16x16x32_bf16 v[20:23], a[152:155], a[12:15], v[20:23]
  v_exp_f32 v48, v48
  v_mfma_f32_16x16x32_bf16 v[24:27], a[156:159], a[8:11], v[24:27]
  ds_read_b128 a[188:191], v5 offset:11264
  v_mul_f32 v49, v10, v33
  v_mfma_f32_16x16x32_bf16 v[28:31], a[156:159], a[12:15], v[28:31]
  s_waitcnt lgkmcnt(3)
  v_cmp_gt_u32 vcc, v228, v224
  v_mul_f32 v50, v10, v34
  v_mfma_f32_16x16x32_bf16 v[16:19], a[160:163], a[16:19], v[16:19]
  ds_read_b128 a[144:147], v5 offset:12288
  v_mul_f32 v51, v10, v35
  v_mfma_f32_16x16x32_bf16 v[20:23], a[160:163], a[20:23], v[20:23]
  buffer_load_dwordx4 a[224:227], v82, s[12:15], s47 offen offset:2048 sc1
  v_mfma_f32_16x16x32_bf16 v[24:27], a[164:167], a[16:19], v[24:27]
  ds_read_b128 a[148:151], v5 offset:13312
  s_cbranch_vccnz fs6_spin
fs6_back:
  v_mfma_f32_16x16x32_bf16 v[28:31], a[164:167], a[20:23], v[28:31]
  s_add_u32 m0, s44, s51
  v_exp_f32 v49, v49
  v_mfma_f32_16x16x32_bf16 v[16:19], a[168:171], a[24:27], v[16:19]
  ds_read_b128 a[152:155], v5 offset:14336
  v_mul_f32 v56, v32, v40
  v_mfma_f32_16x16x32_bf16 v[20:23], a[168:171], a[28:31], v[20:23]
  buffer_load_dwordx4 v7, s[16:19], s43 offen sc1 lds
  v_mfma_f32_16x16x32_bf16 v[24:27], a[172:175], a[24:27], v[24:27]
  ds_read_b128 a[156:159], v5 offset:15360
  v_mul_f32 v57, v33, v41
  v_mfma_f32_16x16x32_bf16 v[28:31], a[172:175], a[28:31], v[28:31]
  s_waitcnt lgkmcnt(4)
  v_exp_f32 v50, v50
  v_mfma_f32_16x16x32_bf16 v[16:19], a[176:179], a[32:35], v[16:19]
  ds_read_b128 a[160:163], v5 offset:16384
  v_mul_f32 v58, v34, v42
  v_mfma_f32_16x16x32_bf16 v[20:23], a[176:179], a[36:39], v[20:23]
  buffer_load_dwordx4 a[228:231], v82, s[12:15], s47 offen offset:3072 sc1
  v_mfma_f32_16x16x32_bf16 v[24:27], a[180:183], a[32:35], v[24:27]
  ds_read_b128 a[164:167], v5 offset:17408
  v_mul_f32 v59, v35, v43
  v_mfma_f32_16x16x32_bf16 v[28:31], a[180:183], a[36:39], v[28:31]
  v_exp_f32 v51, v51
  v_mfma_f32_16x16x32_bf16 v[16:19], a[184:187], a[40:43], v[16:19]
  ds_read_b128 a[168:171], v5 offset:18432
  v_mul_f32 v52, v11, v36
  v_mfma_f32_16x16x32_bf16 v[20:23], a[184:187], a[44:47], v[20:23]
  buffer_load_dwordx4 v7, s[16:19], s43 offen offset:1024 sc1 lds
  v_mfma_f32_16x16x32_bf16 v[24:27], a[188:191], a[40:43], v[24:27]
  ds_read_b128 a[172:175], v5 offset:19456
  v_mul_f32 v53, v11, v37
  v_mfma_f32_16x16x32_bf16 v[28:31], a[188:191], a[44:47], v[28:31]
  s_waitcnt lgkmcnt(4)
  v_exp_f32 v52, v52
  v_mfma_f32_16x16x32_bf16 v[16:19], a[144:147], a[48:51], v[16:19]
  ds_read_b128 a[176:179], v5 offset:20480
  v_mul_f32 v54, v11, v38
  v_mfma_f32_16x16x32_bf16 v[20:23], a[144:147], a[52:55], v[20:23]
  buffer_load_dwordx4 v7, s[16:19], s43 offen offset:2048 sc1 lds
  v_mfma_f32_16x16x32_bf16 v[24:27], a[148:151], a[48:51], v[24:27]
  ds_read_b128 a[180:183], v5 offset:21504
  s_add_u32 m0, s44, s52
  v_mfma_f32_16x16x32_bf16 v[28:31], a[148:151], a[52:55], v[28:31]
  v_exp_f32 v53, v53
  v_mfma_f32_16x16x32_bf16 v[16:19], a[152:155], a[56:59], v[16:19]
  ds_read_b128 a[184:187], v5 offset:22528
  v_mul_f32 v55, v11, v39
  v_mfma_f32_16x16x32_bf16 v[20:23], a[152:155], a[60:63], v[20:23]
  buffer_load_dwordx4 v8, s[16:19], s43 offen sc1 lds
  v_mfma_f32_16x16x32_bf16 v[24:27], a[156:159], a[56:59], v[24:27]
  ds_read_b128 a[188:191], v5 offset:23552
  v_fma_f32 v48, v48, v12, v12
  v_mfma_f32_16x16x32_bf16 v[28:31], a[156:159], a[60:63], v[28:31]
  s_waitcnt lgkmcnt(4)
  v_rcp_f32 v48, v48
  v_mfma_f32_16x16x32_bf16 v[16:19], a[160:163], a[64:67], v[16:19]
  ds_read_b128 a[144:147], v5 offset:24576
  v_fma_f32 v49, v49, v12, v12
  v_mfma_f32_16x16x32_bf16 v[20:23], a[160:163], a[68:71], v[20:23]
  v_rcp_f32 v49, v49
  v_mfma_f32_16x16x32_bf16 v[24:27], a[164:167], a[64:67], v[24:27]
  ds_read_b128 a[148:151], v5 offset:25600
  v_fma_f32 v50, v50, v12, v12
  v_mfma_f32_16x16x32_bf16 v[28:31], a[164:167], a[68:71], v[28:31]
  buffer_load_dwordx4 v8, s[16:19], s43 offen offset:1024 sc1 lds
  v_mfma_f32_16x16x32_bf16 v[16:19], a[168:171], a[72:75], v[16:19]
  ds_read_b128 a[152:155], v5 offset:26624
  v_fma_f32 v51, v51, v12, v12
  v_mfma_f32_16x16x32_bf16 v[20:23], a[168:171], a[76:79], v[20:23]
  v_rcp_f32 v50, v50
  v_mfma_f32_16x16x32_bf16 v[24:27], a[172:175], a[72:75], v[24:27]
  ds_read_b128 a[156:159], v5 offset:27648
  v_mul_f32 v60, v36, v44
  v_mfma_f32_16x16x32_bf16 v[28:31], a[172:175], a[76:79], v[28:31]
  s_waitcnt lgkmcnt(4)
  v_rcp_f32 v51, v51
  v_mfma_f32_16x16x32_bf16 v[16:19], a[176:179], a[80:83], v[16:19]
  ds_read_b128 a[160:163], v5 offset:28672
  v_xor_b32 v6, 73728, v6
  v_mfma_f32_16x16x32_bf16 v[20:23], a[176:179], a[84:87], v[20:23]
  buffer_load_dwordx4 v8, s[16:19], s43 offen offset:2048 sc1 lds
  v_mfma_f32_16x16x32_bf16 v[24:27], a[180:183], a[80:83], v[24:27]
  ds_read_b128 a[164:167], v5 offset:29696
  s_add_u32 m0, s44, s53
  v_mfma_f32_16x16x32_bf16 v[28:31], a[180:183], a[84:87], v[28:31]
  ds_read2_b32 v[140:141], v148 offset0:0 offset1:0
  v_mul_f32 v61, v37, v45
  v_mfma_f32_16x16x32_bf16 v[16:19], a[184:187], a[88:91], v[16:19]
  ds_read_b128 a[168:171], v5 offset:30720
  v_add_u32 v148, 128, v148
  v_mfma_f32_16x16x32_bf16 v[20:23], a[184:187], a[92:95], v[20:23]
  buffer_load_dwordx4 v9, s[16:19], s43 offen sc1 lds
  v_mfma_f32_16x16x32_bf16 v[24:27], a[188:191], a[88:91], v[24:27]
  ds_read_b128 a[172:175], v5 offset:31744
  v_mul_f32 v62, v38, v46
  v_mfma_f32_16x16x32_bf16 v[28:31], a[188:191], a[92:95], v[28:31]
  s_waitcnt lgkmcnt(4)
  v_exp_f32 v54, v54
  v_mfma_f32_16x16x32_bf16 v[16:19], a[144:147], a[96:99], v[16:19]
  ds_read_b128 a[176:179], v5 offset:32768
  v_mul_f32 v63, v39, v47
  v_mfma_f32_16x16x32_bf16 v[20:23], a[144:147], a[100:103], v[20:23]
  v_exp_f32 v55, v55
  v_mfma_f32_16x16x32_bf16 v[24:27], a[148:151], a[96:99], v[24:27]
  ds_read_b128 a[180:183], v5 offset:33792
  v_mul_f32 v56, v56, v48
  v_mfma_f32_16x16x32_bf16 v[28:31], a[148:151], a[100:103], v[28:31]
  buffer_load_dwordx4 v9, s[16:19], s43 offen offset:1024 sc1 lds
  v_mfma_f32_16x16x32_bf16 v[16:19], a[152:155], a[104:107], v[16:19]
  ds_read_b128 a[184:187], v5 offset:34816
  v_mul_f32 v57, v57, v49
  v_mfma_f32_16x16x32_bf16 v[20:23], a[152:155], a[108:111], v[20:23]
  v_mul_f32 v58, v58, v50
  v_mul_f32 v59, v59, v51
  v_mfma_f32_16x16x32_bf16 v[24:27], a[156:159], a[104:107], v[24:27]
  ds_read_b128 a[188:191], v5 offset:35840
  v_fma_f32 v52, v52, v13, v13
  v_mfma_f32_16x16x32_bf16 v[28:31], a[156:159], a[108:111], v[28:31]
  s_waitcnt lgkmcnt(4)
  v_rcp_f32 v52, v52
  v_mfma_f32_16x16x32_bf16 v[16:19], a[160:163], a[112:115], v[16:19]
  ds_read_b128 a[144:147], v6 offset:0
  v_fma_f32 v53, v53, v13, v13
  v_mfma_f32_16x16x32_bf16 v[20:23], a[160:163], a[116:119], v[20:23]
  buffer_load_dwordx4 v9, s[16:19], s43 offen offset:2048 sc1 lds
  v_mfma_f32_16x16x32_bf16 v[24:27], a[164:167], a[112:115], v[24:27]
  ds_read_b128 a[148:151], v6 offset:1024
  v_fma_f32 v54, v54, v13, v13
  v_mfma_f32_16x16x32_bf16 v[28:31], a[164:167], a[116:119], v[28:31]
  s_add_u32 s43, s43, 36864
  v_rcp_f32 v53, v53
  v_mfma_f32_16x16x32_bf16 v[16:19], a[168:171], a[120:123], v[16:19]
  ds_read_b128 a[152:155], v6 offset:2048
  v_fma_f32 v55, v55, v13, v13
  v_mfma_f32_16x16x32_bf16 v[20:23], a[168:171], a[124:127], v[20:23]
  s_xor_b32 s44, s44, 73728
  v_rcp_f32 v54, v54
  v_mfma_f32_16x16x32_bf16 v[24:27], a[172:175], a[120:123], v[24:27]
  ds_read_b128 a[156:159], v6 offset:3072
  v_add_u32 v228, 1, v228
  v_mfma_f32_16x16x32_bf16 v[28:31], a[172:175], a[124:127], v[28:31]
  s_waitcnt vmcnt(12) lgkmcnt(4)
  v_rcp_f32 v55, v55
  v_mfma_f32_16x16x32_bf16 v[16:19], a[176:179], a[128:131], v[16:19]
  ds_read_b128 a[160:163], v6 offset:4096
  v_mul_f32 v60, v60, v52
  v_mfma_f32_16x16x32_bf16 v[20:23], a[176:179], a[132:135], v[20:23]
  ds_write_b32 v229, v228
  v_mul_f32 v61, v61, v53
  v_mfma_f32_16x16x4_4b_bf16 v[32:47], v[140:141], v[132:133], 0
  v_mul_f32 v62, v62, v54
  v_mul_f32 v63, v63, v55
  v_cvt_pk_bf16_f32 v202, v56, v57
  v_cvt_pk_bf16_f32 v203, v58, v59
  v_cvt_pk_bf16_f32 v206, v60, v61
  v_cvt_pk_bf16_f32 v207, v62, v63
  v_mfma_f32_16x16x32_bf16 v[24:27], a[180:183], a[128:131], v[24:27]
  ds_read_b128 a[164:167], v6 offset:5120
  v_mfma_f32_16x16x32_bf16 v[28:31], a[180:183], a[132:135], v[28:31]
  buffer_store_dwordx4 v[200:203], v1, s[12:15], s46 offen sc1
  v_mfma_f32_16x16x32_bf16 v[16:19], a[184:187], a[136:139], v[16:19]
  ds_read_b128 a[168:171], v6 offset:6144
  v_mfma_f32_16x16x32_bf16 v[20:23], a[184:187], a[140:143], v[20:23]
  v_mfma_f32_16x16x32_bf16 v[24:27], a[188:191], a[136:139], v[24:27]
  ds_read_b128 a[172:175], v6 offset:7168
  v_mfma_f32_16x16x32_bf16 v[28:31], a[188:191], a[140:143], v[28:31]
  s_waitcnt lgkmcnt(5)
  buffer_store_dwordx4 v[204:207], v1, s[12:15], s46 offen offset:1024 sc1
  s_add_u32 s46, s46, 2048
  v_mfma_f32_16x16x32_bf16 v[32:35], a[144:147], a[0:3], v[32:35]
  ds_read_b128 a[176:179], v6 offset:8192
  v_mov_b32 v14, 8
  v_mfma_f32_16x16x32_bf16 v[36:39], a[144:147], a[4:7], v[36:39]
  ds_read_b32 v224, v230
  s_mov_b32 s47, 0
  v_mfma_f32_16x16x32_bf16 v[40:43], a[148:151], a[0:3], v[40:43]
  ds_read_b128 a[180:183], v6 offset:9216
  v_mfma_f32_16x16x32_bf16 v[44:47], a[148:151], a[4:7], v[44:47]
  buffer_load_dwordx4 a[232:235], v83, s[12:15], s47 offen offset:2048 sc1
  v_mfma_f32_16x16x32_bf16 v[32:35], a[152:155], a[8:11], v[32:35]
  ds_read_b128 a[184:187], v6 offset:10240
  v_mul_f32 v48, v10, v16
  v_mfma_f32_16x16x32_bf16 v[36:39], a[152:155], a[12:15], v[36:39]
  v_exp_f32 v48, v48
  v_mfma_f32_16x16x32_bf16 v[40:43], a[156:159], a[8:11], v[40:43]
  ds_read_b128 a[188:191], v6 offset:11264
  v_mul_f32 v49, v10, v17
  v_mfma_f32_16x16x32_bf16 v[44:47], a[156:159], a[12:15], v[44:47]
  s_waitcnt lgkmcnt(3)
  v_cmp_gt_u32 vcc, v228, v224
  v_mul_f32 v50, v10, v18
  v_mfma_f32_16x16x32_bf16 v[32:35], a[160:163], a[16:19], v[32:35]
  ds_read_b128 a[144:147], v6 offset:12288
  v_mul_f32 v51, v10, v19
  v_mfma_f32_16x16x32_bf16 v[36:39], a[160:163], a[20:23], v[36:39]
  buffer_load_dwordx4 a[236:239], v83, s[12:15], s47 offen offset:3072 sc1
  v_mfma_f32_16x16x32_bf16 v[40:43], a[164:167], a[16:19], v[40:43]
  ds_read_b128 a[148:151], v6 offset:13312
  s_cbranch_vccnz fs7_spin
fs7_back:
  v_mfma_f32_16x16x32_bf16 v[44:47], a[164:167], a[20:23], v[44:47]
  buffer_store_dword v14, v15, s[12:15], s41 offen sc1
  v_mfma_f32_16x16x32_bf16 v[32:35], a[168:171], a[24:27], v[32:35]
  ds_read_b128 a[152:155], v6 offset:14336
  s_add_u32 m0, s44, s48
  v_mfma_f32_16x16x32_bf16 v[36:39], a[168:171], a[28:31], v[36:39]
  buffer_load_dwordx4 v7, s[16:19], s43 offen sc1 lds
  v_mfma_f32_16x16x32_bf16 v[40:43], a[172:175], a[24:27], v[40:43]
  ds_read_b128 a[156:159], v6 offset:15360
  v_mul_f32 v56, v16, v24
  v_mfma_f32_16x16x32_bf16 v[44:47], a[172:175], a[28:31], v[44:47]
  s_waitcnt lgkmcnt(4)
  v_exp_f32 v49, v49
  v_mfma_f32_16x16x32_bf16 v[32:35], a[176:179], a[32:35], v[32:35]
  ds_read_b128 a[160:163], v6 offset:16384
  s_mov_b32 s47, 4096
  v_mfma_f32_16x16x32_bf16 v[36:39], a[176:179], a[36:39], v[36:39]
  v_exp_f32 v50, v50
  v_mfma_f32_16x16x32_bf16 v[40:43], a[180:183], a[32:35], v[40:43]
  ds_read_b128 a[164:167], v6 offset:17408
  v_mul_f32 v57, v17, v25
  v_mfma_f32_16x16x32_bf16 v[44:47], a[180:183], a[36:39], v[44:47]
  buffer_load_dwordx4 a[240:243], v80, s[12:15], s47 offen sc1
  v_mfma_f32_16x16x32_bf16 v[32:35], a[184:187], a[40:43], v[32:35]
  ds_read_b128 a[168:171], v6 offset:18432
  v_mul_f32 v58, v18, v26
  v_mfma_f32_16x16x32_bf16 v[36:39], a[184:187], a[44:47], v[36:39]
  v_exp_f32 v51, v51
  v_mfma_f32_16x16x32_bf16 v[40:43], a[188:191], a[40:43], v[40:43]
  ds_read_b128 a[172:175], v6 offset:19456
  v_mul_f32 v59, v19, v27
  v_mfma_f32_16x16x32_bf16 v[44:47], a[188:191], a[44:47], v[44:47]
  s_waitcnt lgkmcnt(4)
  v_mul_f32 v52, v11, v20
  v_mul_f32 v53, v11, v21
  v_mfma_f32_16x16x32_bf16 v[32:35], a[144:147], a[48:51], v[32:35]
  ds_read_b128 a[176:179], v6 offset:20480
  v_mul_f32 v54, v11, v22
  v_mfma_f32_16x16x32_bf16 v[36:39], a[144:147], a[52:55], v[36:39]
  buffer_load_dwordx4 v7, s[16:19], s43 offen offset:1024 sc1 lds
  v_mfma_f32_16x16x32_bf16 v[40:43], a[148:151], a[48:51], v[40:43]
  ds_read_b128 a[180:183], v6 offset:21504
  v_mul_f32 v55, v11, v23
  v_mfma_f32_16x16x32_bf16 v[44:47], a[148:151], a[52:55], v[44:47]
  v_exp_f32 v52, v52
  v_mfma_f32_16x16x32_bf16 v[32:35], a[152:155], a[56:59], v[32:35]
  ds_read_b128 a[184:187], v6 offset:22528
  v_fma_f32 v48, v48, v12, v12
  v_mfma_f32_16x16x32_bf16 v[36:39], a[152:155], a[60:63], v[36:39]
  buffer_load_dwordx4 v7, s[16:19], s43 offen offset:2048 sc1 lds
  v_mfma_f32_16x16x32_bf16 v[40:43], a[156:159], a[56:59], v[40:43]
  ds_read_b128 a[188:191], v6 offset:23552
  v_fma_f32 v49, v49, v12, v12
  v_mfma_f32_16x16x32_bf16 v[44:47], a[156:159], a[60:63], v[44:47]
  s_waitcnt lgkmcnt(4)
  v_rcp_f32 v48, v48
  v_mfma_f32_16x16x32_bf16 v[32:35], a[160:163], a[64:67], v[32:35]
  ds_read_b128 a[144:147], v6 offset:24576
  s_add_u32 m0, s44, s49
  v_mfma_f32_16x16x32_bf16 v[36:39], a[160:163], a[68:71], v[36:39]
  v_rcp_f32 v49, v49
  v_mfma_f32_16x16x32_bf16 v[40:43], a[164:167], a[64:67], v[40:43]
  ds_read_b128 a[148:151], v6 offset:25600
  v_fma_f32 v50, v50, v12, v12
  v_mfma_f32_16x16x32_bf16 v[44:47], a[164:167], a[68:71], v[44:47]
  buffer_load_dwordx4 v8, s[16:19], s43 offen sc1 lds
  v_mfma_f32_16x16x32_bf16 v[32:35], a[168:171], a[72:75], v[32:35]
  ds_read_b128 a[152:155], v6 offset:26624
  v_fma_f32 v51, v51, v12, v12
  v_mfma_f32_16x16x32_bf16 v[36:39], a[168:171], a[76:79], v[36:39]
  v_rcp_f32 v50, v50
  v_mfma_f32_16x16x32_bf16 v[40:43], a[172:175], a[72:75], v[40:43]
  ds_read_b128 a[156:159], v6 offset:27648
  v_mul_f32 v60, v20, v28
  v_mfma_f32_16x16x32_bf16 v[44:47], a[172:175], a[76:79], v[44:47]
  s_waitcnt lgkmcnt(4)
  v_rcp_f32 v51, v51
  v_mfma_f32_16x16x32_bf16 v[32:35], a[176:179], a[80:83], v[32:35]
  ds_read_b128 a[160:163], v6 offset:28672
  v_xor_b32 v5, 73728, v5
  v_mfma_f32_16x16x32_bf16 v[36:39], a[176:179], a[84:87], v[36:39]
  buffer_load_dwordx4 v8, s[16:19], s43 offen offset:1024 sc1 lds
  v_mfma_f32_16x16x32_bf16 v[40:43], a[180:183], a[80:83], v[40:43]
  ds_read_b128 a[164:167], v6 offset:29696
  v_mul_f32 v61, v21, v29
  v_mfma_f32_16x16x32_bf16 v[44:47], a[180:183], a[84:87], v[44:47]
  ds_read2_b32 v[140:141], v148 offset0:0 offset1:0
  v_mul_f32 v62, v22, v30
  v_mfma_f32_16x16x32_bf16 v[32:35], a[184:187], a[88:91], v[32:35]
  ds_read_b128 a[168:171], v6 offset:30720
  v_add_u32 v148, 128, v148
  v_mfma_f32_16x16x32_bf16 v[36:39], a[184:187], a[92:95], v[36:39]
  buffer_load_dwordx4 a[244:247], v80, s[12:15], s47 offen offset:1024 sc1
  v_mfma_f32_16x16x32_bf16 v[40:43], a[188:191], a[88:91], v[40:43]
  ds_read_b128 a[172:175], v6 offset:31744
  v_mul_f32 v63, v23, v31
  v_mfma_f32_16x16x32_bf16 v[44:47], a[188:191], a[92:95], v[44:47]
  s_waitcnt lgkmcnt(4)
  v_exp_f32 v53, v53
  v_mfma_f32_16x16x32_bf16 v[32:35], a[144:147], a[96:99], v[32:35]
  ds_read_b128 a[176:179], v6 offset:32768
  v_mul_f32 v56, v56, v48
  v_mfma_f32_16x16x32_bf16 v[36:39], a[144:147], a[100:103], v[36:39]
  v_exp_f32 v54, v54
  v_mfma_f32_16x16x32_bf16 v[40:43], a[148:151], a[96:99], v[40:43]
  ds_read_b128 a[180:183], v6 offset:33792
  v_mul_f32 v57, v57, v49
  v_mfma_f32_16x16x32_bf16 v[44:47], a[148:151], a[100:103], v[44:47]
  buffer_load_dwordx4 v8, s[16:19], s43 offen offset:2048 sc1 lds
  v_mfma_f32_16x16x32_bf16 v[32:35], a[152:155], a[104:107], v[32:35]
  ds_read_b128 a[184:187], v6 offset:34816
  v_mul_f32 v58, v58, v50
  v_mfma_f32_16x16x32_bf16 v[36:39], a[152:155], a[108:111], v[36:39]
  s_add_u32 m0, s44, s50
  v_exp_f32 v55, v55
  v_mfma_f32_16x16x32_bf16 v[40:43], a[156:159], a[104:107], v[40:43]
  ds_read_b128 a[188:191], v6 offset:35840
  v_mul_f32 v59, v59, v51
  v_mfma_f32_16x16x32_bf16 v[44:47], a[156:159], a[108:111], v[44:47]
  s_waitcnt lgkmcnt(4)
  v_fma_f32 v52, v52, v13, v13
  v_fma_f32 v53, v53, v13, v13
  v_mfma_f32_16x16x32_bf16 v[32:35], a[160:163], a[112:115], v[32:35]
  ds_read_b128 a[144:147], v5 offset:0
  v_fma_f32 v54, v54, v13, v13
  v_mfma_f32_16x16x32_bf16 v[36:39], a[160:163], a[116:119], v[36:39]
  buffer_load_dwordx4 v9, s[16:19], s43 offen sc1 lds
  v_mfma_f32_16x16x32_bf16 v[40:43], a[164:167], a[112:115], v[40:43]
  ds_read_b128 a[148:151], v5 offset:1024
  v_fma_f32 v55, v55, v13, v13
  v_mfma_f32_16x16x32_bf16 v[44:47], a[164:167], a[116:119], v[44:47]
  v_rcp_f32 v52, v52
  v_mfma_f32_16x16x32_bf16 v[32:35], a[168:171], a[120:123], v[32:35]
  ds_read_b128 a[152:155], v5 offset:2048
  v_mul_f32 v60, v60, v52
  v_mfma_f32_16x16x32_bf16 v[36:39], a[168:171], a[124:127], v[36:39]
  v_rcp_f32 v53, v53
  v_mfma_f32_16x16x32_bf16 v[40:43], a[172:175], a[120:123], v[40:43]
  ds_read_b128 a[156:159], v5 offset:3072
  v_add_u32 v228, 1, v228
  v_mfma_f32_16x16x32_bf16 v[44:47], a[172:175], a[124:127], v[44:47]
  s_waitcnt vmcnt(14) lgkmcnt(4)
  v_rcp_f32 v54, v54
  v_mfma_f32_16x16x32_bf16 v[32:35], a[176:179], a[128:131], v[32:35]
  ds_read_b128 a[160:163], v5 offset:4096
  v_mul_f32 v61, v61, v53
  v_mfma_f32_16x16x32_bf16 v[36:39], a[176:179], a[132:135], v[36:39]
  ds_write_b32 v229, v228
  v_mul_f32 v62, v62, v54
  v_mfma_f32_16x16x4_4b_bf16 v[16:31], v[140:141], v[132:133], 0
  buffer_load_dwordx4 v9, s[16:19], s43 offen offset:1024 sc1 lds
  v_rcp_f32 v55, v55
  v_cvt_pk_bf16_f32 v208, v56, v57
  v_cvt_pk_bf16_f32 v209, v58, v59
  v_cvt_pk_bf16_f32 v212, v60, v61
  v_mfma_f32_16x16x32_bf16 v[40:43], a[180:183], a[128:131], v[40:43]
  ds_read_b128 a[164:167], v5 offset:5120
  v_mul_f32 v63, v63, v55
  v_mfma_f32_16x16x32_bf16 v[44:47], a[180:183], a[132:135], v[44:47]
  v_cvt_pk_bf16_f32 v213, v62, v63
  v_mfma_f32_16x16x32_bf16 v[32:35], a[184:187], a[136:139], v[32:35]
  ds_read_b128 a[168:171], v5 offset:6144
  v_mfma_f32_16x16x32_bf16 v[36:39], a[184:187], a[140:143], v[36:39]
  buffer_load_dwordx4 v9, s[16:19], s43 offen offset:2048 sc1 lds
  v_mfma_f32_16x16x32_bf16 v[40:43], a[188:191], a[136:139], v[40:43]
  ds_read_b128 a[172:175], v5 offset:7168
  s_add_u32 s43, s43, 36864
  v_mfma_f32_16x16x32_bf16 v[44:47], a[188:191], a[140:143], v[44:47]
  s_waitcnt lgkmcnt(5)
  v_mfma_f32_16x16x32_bf16 v[16:19], a[144:147], a[0:3], v[16:19]
  ds_read_b128 a[176:179], v5 offset:8192
  s_mov_b32 s47, 4096
  v_mfma_f32_16x16x32_bf16 v[20:23], a[144:147], a[4:7], v[20:23]
  ds_read_b32 v224, v230
  v_mfma_f32_16x16x32_bf16 v[24:27], a[148:151], a[0:3], v[24:27]
  ds_read_b128 a[180:183], v5 offset:9216
  v_mfma_f32_16x16x32_bf16 v[28:31], a[148:151], a[4:7], v[28:31]
  buffer_load_dwordx4 a[248:251], v81, s[12:15], s47 offen sc1
  v_mfma_f32_16x16x32_bf16 v[16:19], a[152:155], a[8:11], v[16:19]
  ds_read_b128 a[184:187], v5 offset:10240
  v_mul_f32 v48, v10, v32
  v_mfma_f32_16x16x32_bf16 v[20:23], a[152:155], a[12:15], v[20:23]
  v_exp_f32 v48, v48
  v_mfma_f32_16x16x32_bf16 v[24:27], a[156:159], a[8:11], v[24:27]
  ds_read_b128 a[188:191], v5 offset:11264
  v_mul_f32 v49, v10, v33
  v_mfma_f32_16x16x32_bf16 v[28:31], a[156:159], a[12:15], v[28:31]
  s_waitcnt lgkmcnt(3)
  v_cmp_gt_u32 vcc, v228, v224
  v_mul_f32 v50, v10, v34
  v_mfma_f32_16x16x32_bf16 v[16:19], a[160:163], a[16:19], v[16:19]
  ds_read_b128 a[144:147], v5 offset:12288
  v_mul_f32 v51, v10, v35
  v_mfma_f32_16x16x32_bf16 v[20:23], a[160:163], a[20:23], v[20:23]
  buffer_load_dwordx4 a[252:255], v81, s[12:15], s47 offen offset:1024 sc1
  v_mfma_f32_16x16x32_bf16 v[24:27], a[164:167], a[16:19], v[24:27]
  ds_read_b128 a[148:151], v5 offset:13312
  s_cbranch_vccnz fs8_spin
fs8_back:
  v_mfma_f32_16x16x32_bf16 v[28:31], a[164:167], a[20:23], v[28:31]
  s_add_u32 m0, s44, s51
  v_exp_f32 v49, v49
  v_mfma_f32_16x16x32_bf16 v[16:19], a[168:171], a[24:27], v[16:19]
  ds_read_b128 a[152:155], v5 offset:14336
  v_mul_f32 v56, v32, v40
  v_mfma_f32_16x16x32_bf16 v[20:23], a[168:171], a[28:31], v[20:23]
  buffer_load_dwordx4 v7, s[16:19], s43 offen sc1 lds
  v_mfma_f32_16x16x32_bf16 v[24:27], a[172:175], a[24:27], v[24:27]
  ds_read_b128 a[156:159], v5 offset:15360
  v_mul_f32 v57, v33, v41
  v_mfma_f32_16x16x32_bf16 v[28:31], a[172:175], a[28:31], v[28:31]
  s_waitcnt lgkmcnt(4)
  v_exp_f32 v50, v50
  v_mfma_f32_16x16x32_bf16 v[16:19], a[176:179], a[32:35], v[16:19]
  ds_read_b128 a[160:163], v5 offset:16384
  v_mul_f32 v58, v34, v42
  v_mfma_f32_16x16x32_bf16 v[20:23], a[176:179], a[36:39], v[20:23]
  buffer_load_dwordx4 v[160:163], v82, s[12:15], s47 offen sc1
  v_mfma_f32_16x16x32_bf16 v[24:27], a[180:183], a[32:35], v[24:27]
  ds_read_b128 a[164:167], v5 offset:17408
  v_mul_f32 v59, v35, v43
  v_mfma_f32_16x16x32_bf16 v[28:31], a[180:183], a[36:39], v[28:31]
  v_exp_f32 v51, v51
  v_mfma_f32_16x16x32_bf16 v[16:19], a[184:187], a[40:43], v[16:19]
  ds_read_b128 a[168:171], v5 offset:18432
  v_mul_f32 v52, v11, v36
  v_mfma_f32_16x16x32_bf16 v[20:23], a[184:187], a[44:47], v[20:23]
  buffer_load_dword v72, v74, s[12:15], s41 offen sc1
  v_mfma_f32_16x16x32_bf16 v[24:27], a[188:191], a[40:43], v[24:27]
  ds_read_b128 a[172:175], v5 offset:19456
  v_mul_f32 v53, v11, v37
  v_mfma_f32_16x16x32_bf16 v[28:31], a[188:191], a[44:47], v[28:31]
  s_waitcnt lgkmcnt(4)
  v_exp_f32 v52, v52
  v_mfma_f32_16x16x32_bf16 v[16:19], a[144:147], a[48:51], v[16:19]
  ds_read_b128 a[176:179], v5 offset:20480
  v_mul_f32 v54, v11, v38
  v_mfma_f32_16x16x32_bf16 v[20:23], a[144:147], a[52:55], v[20:23]
  buffer_load_dwordx4 v7, s[16:19], s43 offen offset:1024 sc1 lds
  v_mfma_f32_16x16x32_bf16 v[24:27], a[148:151], a[48:51], v[24:27]
  ds_read_b128 a[180:183], v5 offset:21504
  v_mul_f32 v55, v11, v39
  v_mfma_f32_16x16x32_bf16 v[28:31], a[148:151], a[52:55], v[28:31]
  v_exp_f32 v53, v53
  v_mfma_f32_16x16x32_bf16 v[16:19], a[152:155], a[56:59], v[16:19]
  ds_read_b128 a[184:187], v5 offset:22528
  v_fma_f32 v48, v48, v12, v12
  v_mfma_f32_16x16x32_bf16 v[20:23], a[152:155], a[60:63], v[20:23]
  buffer_load_dwordx4 v7, s[16:19], s43 offen offset:2048 sc1 lds
  v_mfma_f32_16x16x32_bf16 v[24:27], a[156:159], a[56:59], v[24:27]
  ds_read_b128 a[188:191], v5 offset:23552
  s_add_u32 m0, s44, s52
  v_mfma_f32_16x16x32_bf16 v[28:31], a[156:159], a[60:63], v[28:31]
  s_waitcnt lgkmcnt(4)
  v_rcp_f32 v48, v48
  v_mfma_f32_16x16x32_bf16 v[16:19], a[160:163], a[64:67], v[16:19]
  ds_read_b128 a[144:147], v5 offset:24576
  v_fma_f32 v49, v49, v12, v12
  v_mfma_f32_16x16x32_bf16 v[20:23], a[160:163], a[68:71], v[20:23]
  buffer_load_dwordx4 v8, s[16:19], s43 offen sc1 lds
  v_mfma_f32_16x16x32_bf16 v[24:27], a[164:167], a[64:67], v[24:27]
  ds_read_b128 a[148:151], v5 offset:25600
  v_fma_f32 v50, v50, v12, v12
  v_mfma_f32_16x16x32_bf16 v[28:31], a[164:167], a[68:71], v[28:31]
  v_rcp_f32 v49, v49
  v_mfma_f32_16x16x32_bf16 v[16:19], a[168:171], a[72:75], v[16:19]
  ds_read_b128 a[152:155], v5 offset:26624
  v_fma_f32 v51, v51, v12, v12
  v_mfma_f32_16x16x32_bf16 v[20:23], a[168:171], a[76:79], v[20:23]
  buffer_load_dwordx4 v8, s[16:19], s43 offen offset:1024 sc1 lds
  v_mfma_f32_16x16x32_bf16 v[24:27], a[172:175], a[72:75], v[24:27]
  ds_read_b128 a[156:159], v5 offset:27648
  v_mul_f32 v60, v36, v44
  v_mfma_f32_16x16x32_bf16 v[28:31], a[172:175], a[76:79], v[28:31]
  s_waitcnt lgkmcnt(4)
  v_rcp_f32 v50, v50
  v_mfma_f32_16x16x32_bf16 v[16:19], a[176:179], a[80:83], v[16:19]
  ds_read_b128 a[160:163], v5 offset:28672
  v_xor_b32 v6, 73728, v6
  v_mfma_f32_16x16x32_bf16 v[20:23], a[176:179], a[84:87], v[20:23]
  buffer_load_dwordx4 v8, s[16:19], s43 offen offset:2048 sc1 lds
  v_mfma_f32_16x16x32_bf16 v[24:27], a[180:183], a[80:83], v[24:27]
  ds_read_b128 a[164:167], v5 offset:29696
  s_add_u32 m0, s44, s53
  v_mfma_f32_16x16x32_bf16 v[28:31], a[180:183], a[84:87], v[28:31]
  ds_read2_b32 v[140:141], v148 offset0:0 offset1:0
  v_mul_f32 v61, v37, v45
  v_mfma_f32_16x16x32_bf16 v[16:19], a[184:187], a[88:91], v[16:19]
  ds_read_b128 a[168:171], v5 offset:30720
  v_add_u32 v148, 128, v148
  v_mfma_f32_16x16x32_bf16 v[20:23], a[184:187], a[92:95], v[20:23]
  buffer_load_dwordx4 v9, s[16:19], s43 offen sc1 lds
  v_mfma_f32_16x16x32_bf16 v[24:27], a[188:191], a[88:91], v[24:27]
  ds_read_b128 a[172:175], v5 offset:31744
  v_mul_f32 v62, v38, v46
  v_mfma_f32_16x16x32_bf16 v[28:31], a[188:191], a[92:95], v[28:31]
  s_waitcnt lgkmcnt(4)
  v_rcp_f32 v51, v51
  v_mfma_f32_16x16x32_bf16 v[16:19], a[144:147], a[96:99], v[16:19]
  ds_read_b128 a[176:179], v5 offset:32768
  v_mul_f32 v63, v39, v47
  v_mfma_f32_16x16x32_bf16 v[20:23], a[144:147], a[100:103], v[20:23]
  v_exp_f32 v54, v54
  v_mfma_f32_16x16x32_bf16 v[24:27], a[148:151], a[96:99], v[24:27]
  ds_read_b128 a[180:183], v5 offset:33792
  v_mul_f32 v56, v56, v48
  v_mfma_f32_16x16x32_bf16 v[28:31], a[148:151], a[100:103], v[28:31]
  buffer_load_dwordx4 v9, s[16:19], s43 offen offset:1024 sc1 lds
  v_mfma_f32_16x16x32_bf16 v[16:19], a[152:155], a[104:107], v[16:19]
  ds_read_b128 a[184:187], v5 offset:34816
  v_mul_f32 v57, v57, v49
  v_mfma_f32_16x16x32_bf16 v[20:23], a[152:155], a[108:111], v[20:23]
  v_exp_f32 v55, v55
  v_mfma_f32_16x16x32_bf16 v[24:27], a[156:159], a[104:107], v[24:27]
  ds_read_b128 a[188:191], v5 offset:35840
  v_mul_f32 v58, v58, v50
  v_mfma_f32_16x16x32_bf16 v[28:31], a[156:159], a[108:111], v[28:31]
  s_waitcnt lgkmcnt(4)
  v_mul_f32 v59, v59, v51
  v_fma_f32 v52, v52, v13, v13
  v_mfma_f32_16x16x32_bf16 v[16:19], a[160:163], a[112:115], v[16:19]
  ds_read_b128 a[144:147], v6 offset:0
  v_fma_f32 v53, v53, v13, v13
  v_mfma_f32_16x16x32_bf16 v[20:23], a[160:163], a[116:119], v[20:23]
  buffer_load_dwordx4 v9, s[16:19], s43 offen offset:2048 sc1 lds
  v_mfma_f32_16x16x32_bf16 v[24:27], a[164:167], a[112:115], v[24:27]
  ds_read_b128 a[148:151], v6 offset:1024
  v_fma_f32 v54, v54, v13, v13
  v_mfma_f32_16x16x32_bf16 v[28:31], a[164:167], a[116:119], v[28:31]
  s_add_u32 s43, s43, 36864
  v_rcp_f32 v52, v52
  v_mfma_f32_16x16x32_bf16 v[16:19], a[168:171], a[120:123], v[16:19]
  ds_read_b128 a[152:155], v6 offset:2048
  v_fma_f32 v55, v55, v13, v13
  v_mfma_f32_16x16x32_bf16 v[20:23], a[168:171], a[124:127], v[20:23]
  s_xor_b32 s44, s44, 73728
  v_rcp_f32 v53, v53
  v_mfma_f32_16x16x32_bf16 v[24:27], a[172:175], a[120:123], v[24:27]
  ds_read_b128 a[156:159], v6 offset:3072
  v_add_u32 v228, 1, v228
  v_mfma_f32_16x16x32_bf16 v[28:31], a[172:175], a[124:127], v[28:31]
  s_waitcnt vmcnt(13) lgkmcnt(4)
  v_rcp_f32 v54, v54
  v_mfma_f32_16x16x32_bf16 v[16:19], a[176:179], a[128:131], v[16:19]
  ds_read_b128 a[160:163], v6 offset:4096
  v_mul_f32 v60, v60, v52
  v_mfma_f32_16x16x32_bf16 v[20:23], a[176:179], a[132:135], v[20:23]
  ds_write_b32 v229, v228
  v_mul_f32 v61, v61, v53
  v_mfma_f32_16x16x4_4b_bf16 v[32:47], v[140:141], v[132:133], 0
  v_rcp_f32 v55, v55
  v_mul_f32 v62, v62, v54
  v_cvt_pk_bf16_f32 v210, v56, v57
  v_cvt_pk_bf16_f32 v211, v58, v59
  v_cvt_pk_bf16_f32 v214, v60, v61
  v_mfma_f32_16x16x32_bf16 v[24:27], a[180:183], a[128:131], v[24:27]
  ds_read_b128 a[164:167], v6 offset:5120
  v_mul_f32 v63, v63, v55
  v_mfma_f32_16x16x32_bf16 v[28:31], a[180:183], a[132:135], v[28:31]
  buffer_store_dwordx4 v[208:211], v1, s[12:15], s46 offen sc1
  v_mfma_f32_16x16x32_bf16 v[16:19], a[184:187], a[136:139], v[16:19]
  ds_read_b128 a[168:171], v6 offset:6144
  v_cvt_pk_bf16_f32 v215, v62, v63
  v_mfma_f32_16x16x32_bf16 v[20:23], a[184:187], a[140:143], v[20:23]
  v_mfma_f32_16x16x32_bf16 v[24:27], a[188:191], a[136:139], v[24:27]
  ds_read_b128 a[172:175], v6 offset:7168
  v_mfma_f32_16x16x32_bf16 v[28:31], a[188:191], a[140:143], v[28:31]
  s_waitcnt vmcnt(9) lgkmcnt(5)
  buffer_store_dwordx4 v[212:215], v1, s[12:15], s46 offen offset:1024 sc1
  s_add_u32 s46, s46, 2048
  v_mfma_f32_16x16x32_bf16 v[32:35], a[144:147], a[0:3], v[32:35]
  ds_read_b128 a[176:179], v6 offset:8192
  v_cmp_gt_u32 vcc, 8, v72
  v_mfma_f32_16x16x32_bf16 v[36:39], a[144:147], a[4:7], v[36:39]
  ds_read_b32 v224, v230
  s_mov_b32 s47, 4096
  v_mfma_f32_16x16x32_bf16 v[40:43], a[148:151], a[0:3], v[40:43]
  ds_read_b128 a[180:183], v6 offset:9216
  s_cbranch_vccnz f17_spin
f17_back:
  v_mfma_f32_16x16x32_bf16 v[44:47], a[148:151], a[4:7], v[44:47]
  buffer_load_dwordx4 v[164:167], v82, s[12:15], s47 offen offset:1024 sc1
  v_mfma_f32_16x16x32_bf16 v[32:35], a[152:155], a[8:11], v[32:35]
  ds_read_b128 a[184:187], v6 offset:10240
  v_mul_f32 v48, v10, v16
  v_mfma_f32_16x16x32_bf16 v[36:39], a[152:155], a[12:15], v[36:39]
  v_exp_f32 v48, v48
  v_mfma_f32_16x16x32_bf16 v[40:43], a[156:159], a[8:11], v[40:43]
  ds_read_b128 a[188:191], v6 offset:11264
  v_mul_f32 v49, v10, v17
  v_mfma_f32_16x16x32_bf16 v[44:47], a[156:159], a[12:15], v[44:47]
  s_waitcnt lgkmcnt(3)
  v_cmp_gt_u32 vcc, v228, v224
  v_mul_f32 v50, v10, v18
  v_mfma_f32_16x16x32_bf16 v[32:35], a[160:163], a[16:19], v[32:35]
  ds_read_b128 a[144:147], v6 offset:12288
  v_mul_f32 v51, v10, v19
  v_mfma_f32_16x16x32_bf16 v[36:39], a[160:163], a[20:23], v[36:39]
  buffer_load_dwordx4 v[168:171], v83, s[12:15], s47 offen sc1
  v_mfma_f32_16x16x32_bf16 v[40:43], a[164:167], a[16:19], v[40:43]
  ds_read_b128 a[148:151], v6 offset:13312
  s_cbranch_vccnz fs10_spin
fs10_back:
  v_mfma_f32_16x16x32_bf16 v[44:47], a[164:167], a[20:23], v[44:47]
  s_add_u32 m0, s44, s48
  v_exp_f32 v49, v49
  v_mfma_f32_16x16x32_bf16 v[32:35], a[168:171], a[24:27], v[32:35]
  ds_read_b128 a[152:155], v6 offset:14336
  v_fma_f32 v48, v48, v12, v12
  v_mfma_f32_16x16x32_bf16 v[36:39], a[168:171], a[28:31], v[36:39]
  v_exp_f32 v50, v50
  v_mfma_f32_16x16x32_bf16 v[40:43], a[172:175], a[24:27], v[40:43]
  ds_read_b128 a[156:159], v6 offset:15360
  v_fma_f32 v49, v49, v12, v12
  v_mfma_f32_16x16x32_bf16 v[44:47], a[172:175], a[28:31], v[44:47]
  s_waitcnt lgkmcnt(4)
  v_exp_f32 v51, v51
  v_mfma_f32_16x16x32_bf16 v[32:35], a[176:179], a[32:35], v[32:35]
  ds_read_b128 a[160:163], v6 offset:16384
  v_fma_f32 v50, v50, v12, v12
  v_mfma_f32_16x16x32_bf16 v[36:39], a[176:179], a[36:39], v[36:39]
  buffer_load_dwordx4 v7, s[16:19], s43 offen sc1 lds
  v_mfma_f32_16x16x32_bf16 v[40:43], a[180:183], a[32:35], v[40:43]
  ds_read_b128 a[164:167], v6 offset:17408
  v_fma_f32 v51, v51, v12, v12
  v_mfma_f32_16x16x32_bf16 v[44:47], a[180:183], a[36:39], v[44:47]
  v_rcp_f32 v48, v48
  v_mfma_f32_16x16x32_bf16 v[32:35], a[184:187], a[40:43], v[32:35]
  ds_read_b128 a[168:171], v6 offset:18432
  v_mul_f32 v56, v16, v24
  v_mfma_f32_16x16x32_bf16 v[36:39], a[184:187], a[44:47], v[36:39]
  v_rcp_f32 v49, v49
  v_mfma_f32_16x16x32_bf16 v[40:43], a[188:191], a[40:43], v[40:43]
  ds_read_b128 a[172:175], v6 offset:19456
  v_mul_f32 v57, v17, v25
  v_mfma_f32_16x16x32_bf16 v[44:47], a[188:191], a[44:47], v[44:47]
  s_waitcnt lgkmcnt(4)
  v_rcp_f32 v50, v50
  v_mfma_f32_16x16x32_bf16 v[32:35], a[144:147], a[48:51], v[32:35]
  ds_read_b128 a[176:179], v6 offset:20480
  v_mul_f32 v58, v18, v26
  v_mfma_f32_16x16x32_bf16 v[36:39], a[144:147], a[52:55], v[36:39]
  buffer_load_dwordx4 v[172:175], v83, s[12:15], s47 offen offset:1024 sc1
  v_mfma_f32_16x16x32_bf16 v[40:43], a[148:151], a[48:51], v[40:43]
  ds_read_b128 a[180:183], v6 offset:21504
  v_mul_f32 v59, v19, v27
  v_mfma_f32_16x16x32_bf16 v[44:47], a[148:151], a[52:55], v[44:47]
  v_rcp_f32 v51, v51
  v_mfma_f32_16x16x32_bf16 v[32:35], a[152:155], a[56:59], v[32:35]
  ds_read_b128 a[184:187], v6 offset:22528
  v_mul_f32 v52, v11, v20
  v_mfma_f32_16x16x32_bf16 v[36:39], a[152:155], a[60:63], v[36:39]
  buffer_load_dwordx4 v7, s[16:19], s43 offen offset:1024 sc1 lds
  v_mfma_f32_16x16x32_bf16 v[40:43], a[156:159], a[56:59], v[40:43]
  ds_read_b128 a[188:191], v6 offset:23552
  v_mul_f32 v53, v11, v21
  v_mfma_f32_16x16x32_bf16 v[44:47], a[156:159], a[60:63], v[44:47]
  s_waitcnt lgkmcnt(4)
  v_exp_f32 v52, v52
  v_mfma_f32_16x16x32_bf16 v[32:35], a[160:163], a[64:67], v[32:35]
  ds_read_b128 a[144:147], v6 offset:24576
  v_mul_f32 v54, v11, v22
  v_mfma_f32_16x16x32_bf16 v[36:39], a[160:163], a[68:71], v[36:39]
  buffer_load_dwordx4 v7, s[16:19], s43 offen offset:2048 sc1 lds
  v_mfma_f32_16x16x32_bf16 v[40:43], a[164:167], a[64:67], v[40:43]
  ds_read_b128 a[148:151], v6 offset:25600
  v_mul_f32 v55, v11, v23
  v_mfma_f32_16x16x32_bf16 v[44:47], a[164:167], a[68:71], v[44:47]
  s_add_u32 m0, s44, s49
  v_exp_f32 v53, v53
  v_mfma_f32_16x16x32_bf16 v[32:35], a[168:171], a[72:75], v[32:35]
  ds_read_b128 a[152:155], v6 offset:26624
  v_mul_f32 v56, v56, v48
  v_mfma_f32_16x16x32_bf16 v[36:39], a[168:171], a[76:79], v[36:39]
  v_exp_f32 v54, v54
  v_mfma_f32_16x16x32_bf16 v[40:43], a[172:175], a[72:75], v[40:43]
  ds_read_b128 a[156:159], v6 offset:27648
  v_mul_f32 v57, v57, v49
  v_mfma_f32_16x16x32_bf16 v[44:47], a[172:175], a[76:79], v[44:47]
  s_waitcnt lgkmcnt(4)
  v_exp_f32 v55, v55
  v_mfma_f32_16x16x32_bf16 v[32:35], a[176:179], a[80:83], v[32:35]
  ds_read_b128 a[160:163], v6 offset:28672
  v_xor_b32 v5, 73728, v5
  v_mfma_f32_16x16x32_bf16 v[36:39], a[176:179], a[84:87], v[36:39]
  buffer_load_dwordx4 v8, s[16:19], s43 offen sc1 lds
  v_mfma_f32_16x16x32_bf16 v[40:43], a[180:183], a[80:83], v[40:43]
  ds_read_b128 a[164:167], v6 offset:29696
  v_mul_f32 v58, v58, v50
  v_mfma_f32_16x16x32_bf16 v[44:47], a[180:183], a[84:87], v[44:47]
  v_mul_f32 v59, v59, v51
  v_fma_f32 v52, v52, v13, v13
  v_mfma_f32_16x16x32_bf16 v[32:35], a[184:187], a[88:91], v[32:35]
  ds_read_b128 a[168:171], v6 offset:30720
  v_fma_f32 v53, v53, v13, v13
  v_mfma_f32_16x16x32_bf16 v[36:39], a[184:187], a[92:95], v[36:39]
  buffer_load_dwordx4 v8, s[16:19], s43 offen offset:1024 sc1 lds
  v_mfma_f32_16x16x32_bf16 v[40:43], a[188:191], a[88:91], v[40:43]
  ds_read_b128 a[172:175], v6 offset:31744
  v_fma_f32 v54, v54, v13, v13
  v_mfma_f32_16x16x32_bf16 v[44:47], a[188:191], a[92:95], v[44:47]
  s_waitcnt lgkmcnt(4)
  v_rcp_f32 v52, v52
  v_mfma_f32_16x16x32_bf16 v[32:35], a[144:147], a[96:99], v[32:35]
  ds_read_b128 a[176:179], v6 offset:32768
  v_fma_f32 v55, v55, v13, v13
  v_mfma_f32_16x16x32_bf16 v[36:39], a[144:147], a[100:103], v[36:39]
  v_rcp_f32 v53, v53
  v_mfma_f32_16x16x32_bf16 v[40:43], a[148:151], a[96:99], v[40:43]
  ds_read_b128 a[180:183], v6 offset:33792
  v_mul_f32 v60, v20, v28
  v_mfma_f32_16x16x32_bf16 v[44:47], a[148:151], a[100:103], v[44:47]
  buffer_load_dwordx4 v8, s[16:19], s43 offen offset:2048 sc1 lds
  v_mfma_f32_16x16x32_bf16 v[32:35], a[152:155], a[104:107], v[32:35]
  ds_read_b128 a[184:187], v6 offset:34816
  s_add_u32 m0, s44, s50
  v_mfma_f32_16x16x32_bf16 v[36:39], a[152:155], a[108:111], v[36:39]
  v_rcp_f32 v54, v54
  v_mfma_f32_16x16x32_bf16 v[40:43], a[156:159], a[104:107], v[40:43]
  ds_read_b128 a[188:191], v6 offset:35840
  v_mul_f32 v61, v21, v29
  v_mfma_f32_16x16x32_bf16 v[44:47], a[156:159], a[108:111], v[44:47]
  s_waitcnt lgkmcnt(4)
  v_rcp_f32 v55, v55
  v_mfma_f32_16x16x32_bf16 v[32:35], a[160:163], a[112:115], v[32:35]
  ds_read_b128 a[144:147], v5 offset:0
  v_mul_f32 v62, v22, v30
  v_mfma_f32_16x16x32_bf16 v[36:39], a[160:163], a[116:119], v[36:39]
  buffer_load_dwordx4 v9, s[16:19], s43 offen sc1 lds
  v_mfma_f32_16x16x32_bf16 v[40:43], a[164:167], a[112:115], v[40:43]
  ds_read_b128 a[148:151], v5 offset:1024
  v_mul_f32 v63, v23, v31
  v_mfma_f32_16x16x32_bf16 v[44:47], a[164:167], a[116:119], v[44:47]
  v_mul_f32 v60, v60, v52
  v_mul_f32 v61, v61, v53
  v_mfma_f32_16x16x32_bf16 v[32:35], a[168:171], a[120:123], v[32:35]
  ds_read_b128 a[152:155], v5 offset:2048
  v_mul_f32 v62, v62, v54
  v_mfma_f32_16x16x32_bf16 v[36:39], a[168:171], a[124:127], v[36:39]
  buffer_load_dwordx4 v9, s[16:19], s43 offen offset:1024 sc1 lds
  v_mfma_f32_16x16x32_bf16 v[40:43], a[172:175], a[120:123], v[40:43]
  ds_read_b128 a[156:159], v5 offset:3072
  v_add_u32 v228, 1, v228
  v_mfma_f32_16x16x32_bf16 v[44:47], a[172:175], a[124:127], v[44:47]
  s_waitcnt vmcnt(13) lgkmcnt(4)
  v_mul_f32 v63, v63, v55
  v_cvt_pk_bf16_f32 v216, v56, v57
  v_mfma_f32_16x16x32_bf16 v[32:35], a[176:179], a[128:131], v[32:35]
  ds_read_b128 a[160:163], v5 offset:4096
  v_cvt_pk_bf16_f32 v217, v58, v59
  v_mfma_f32_16x16x32_bf16 v[36:39], a[176:179], a[132:135], v[36:39]
  ds_write_b32 v229, v228
  v_cvt_pk_bf16_f32 v220, v60, v61
  v_mfma_f32_16x16x32_bf16 v[40:43], a[180:183], a[128:131], v[40:43]
  ds_read_b128 a[164:167], v5 offset:5120
  v_cvt_pk_bf16_f32 v221, v62, v63
  v_mfma_f32_16x16x32_bf16 v[44:47], a[180:183], a[132:135], v[44:47]
  buffer_load_dwordx4 v9, s[16:19], s43 offen offset:2048 sc1 lds
  v_mfma_f32_16x16x32_bf16 v[32:35], a[184:187], a[136:139], v[32:35]
  ds_read_b128 a[168:171], v5 offset:6144
  s_add_u32 s43, s43, 36864
  v_mfma_f32_16x16x32_bf16 v[36:39], a[184:187], a[140:143], v[36:39]
  v_mfma_f32_16x16x32_bf16 v[40:43], a[188:191], a[136:139], v[40:43]
  ds_read_b128 a[172:175], v5 offset:7168
  v_mfma_f32_16x16x32_bf16 v[44:47], a[188:191], a[140:143], v[44:47]
  s_waitcnt vmcnt(63) lgkmcnt(5)
  v_mfma_f32_16x16x32_bf16 v[84:87], a[144:147], v[176:179], 0
  ds_read_b128 a[176:179], v5 offset:8192
  s_mov_b32 s47, 4096
  v_mfma_f32_16x16x32_bf16 v[88:91], a[144:147], v[180:183], 0
  ds_read_b32 v224, v230
  v_mfma_f32_16x16x32_bf16 v[92:95], a[148:151], v[176:179], 0
  ds_read_b128 a[180:183], v5 offset:9216
  v_mfma_f32_16x16x32_bf16 v[96:99], a[148:151], v[180:183], 0
  buffer_load_dwordx4 a[0:3], v80, s[12:15], s47 offen offset:2048 sc1
  v_mfma_f32_16x16x32_bf16 v[100:103], a[152:155], v[176:179], 0
  ds_read_b128 a[184:187], v5 offset:10240
  v_mul_f32 v48, v10, v32
  v_mfma_f32_16x16x32_bf16 v[104:107], a[152:155], v[180:183], 0
  v_exp_f32 v48, v48
  v_mfma_f32_16x16x32_bf16 v[108:111], a[156:159], v[176:179], 0
  ds_read_b128 a[188:191], v5 offset:11264
  v_mul_f32 v49, v10, v33
  v_mfma_f32_16x16x32_bf16 v[112:115], a[156:159], v[180:183], 0
  s_waitcnt lgkmcnt(3)
  v_cmp_gt_u32 vcc, v228, v224
  v_mul_f32 v50, v10, v34
  v_mfma_f32_16x16x32_bf16 v[116:119], a[160:163], v[176:179], 0
  ds_read_b128 a[144:147], v5 offset:12288
  v_mul_f32 v51, v10, v35
  v_mfma_f32_16x16x32_bf16 v[120:123], a[160:163], v[180:183], 0
  buffer_load_dwordx4 a[4:7], v80, s[12:15], s47 offen offset:3072 sc1
  v_mfma_f32_16x16x32_bf16 v[124:127], a[164:167], v[176:179], 0
  ds_read_b128 a[148:151], v5 offset:13312
  s_cbranch_vccnz fs11_spin
fs11_back:
  v_mfma_f32_16x16x32_bf16 v[128:131], a[164:167], v[180:183], 0
  s_add_u32 m0, s44, s51
  v_exp_f32 v49, v49
  v_mfma_f32_16x16x32_bf16 v[132:135], a[168:171], v[176:179], 0
  ds_read_b128 a[152:155], v5 offset:14336
  v_fma_f32 v48, v48, v12, v12
  v_mfma_f32_16x16x32_bf16 v[136:139], a[168:171], v[180:183], 0
  buffer_load_dwordx4 v7, s[16:19], s43 offen sc1 lds
  v_mfma_f32_16x16x32_bf16 v[140:143], a[172:175], v[176:179], 0
  ds_read_b128 a[156:159], v5 offset:15360
  v_fma_f32 v49, v49, v12, v12
  v_mfma_f32_16x16x32_bf16 v[144:147], a[172:175], v[180:183], 0
  s_waitcnt lgkmcnt(4)
  v_exp_f32 v50, v50
  v_mfma_f32_16x16x32_bf16 v[148:151], a[176:179], v[176:179], 0
  ds_read_b128 a[160:163], v5 offset:16384
  v_fma_f32 v50, v50, v12, v12
  v_mfma_f32_16x16x32_bf16 v[152:155], a[176:179], v[180:183], 0
  buffer_load_dwordx4 a[8:11], v81, s[12:15], s47 offen offset:2048 sc1
  v_mfma_f32_16x16x32_bf16 v[84:87], a[180:183], a[192:195], v[84:87]
  ds_read_b128 a[164:167], v5 offset:17408
  v_mul_f32 v56, v32, v40
  v_mfma_f32_16x16x32_bf16 v[88:91], a[180:183], a[196:199], v[88:91]
  v_exp_f32 v51, v51
  v_mfma_f32_16x16x32_bf16 v[92:95], a[184:187], a[192:195], v[92:95]
  ds_read_b128 a[168:171], v5 offset:18432
  v_fma_f32 v51, v51, v12, v12
  v_mfma_f32_16x16x32_bf16 v[96:99], a[184:187], a[196:199], v[96:99]
  buffer_load_dwordx4 v7, s[16:19], s43 offen offset:1024 sc1 lds
  v_mfma_f32_16x16x32_bf16 v[100:103], a[188:191], a[192:195], v[100:103]
  ds_read_b128 a[172:175], v5 offset:19456
  v_mul_f32 v57, v33, v41
  v_mfma_f32_16x16x32_bf16 v[104:107], a[188:191], a[196:199], v[104:107]
  s_waitcnt lgkmcnt(4)
  v_rcp_f32 v48, v48
  v_mfma_f32_16x16x32_bf16 v[108:111], a[144:147], a[192:195], v[108:111]
  ds_read_b128 a[176:179], v5 offset:20480
  v_mul_f32 v58, v34, v42
  v_mfma_f32_16x16x32_bf16 v[112:115], a[144:147], a[196:199], v[112:115]
  buffer_load_dwordx4 v7, s[16:19], s43 offen offset:2048 sc1 lds
  v_mfma_f32_16x16x32_bf16 v[116:119], a[148:151], a[192:195], v[116:119]
  ds_read_b128 a[180:183], v5 offset:21504
  v_mul_f32 v59, v35, v43
  v_mfma_f32_16x16x32_bf16 v[120:123], a[148:151], a[196:199], v[120:123]
  v_rcp_f32 v49, v49
  v_mfma_f32_16x16x32_bf16 v[124:127], a[152:155], a[192:195], v[124:127]
  ds_read_b128 a[184:187], v5 offset:22528
  v_mul_f32 v52, v11, v36
  v_mfma_f32_16x16x32_bf16 v[128:131], a[152:155], a[196:199], v[128:131]
  buffer_load_dwordx4 a[12:15], v81, s[12:15], s47 offen offset:3072 sc1
  v_mfma_f32_16x16x32_bf16 v[132:135], a[156:159], a[192:195], v[132:135]
  ds_read_b128 a[188:191], v5 offset:23552
  s_add_u32 m0, s44, s52
  v_mfma_f32_16x16x32_bf16 v[136:139], a[156:159], a[196:199], v[136:139]
  s_waitcnt lgkmcnt(4)
  v_rcp_f32 v50, v50
  v_mfma_f32_16x16x32_bf16 v[140:143], a[160:163], a[192:195], v[140:143]
  ds_read_b128 a[144:147], v5 offset:24576
  v_mul_f32 v53, v11, v37
  v_mfma_f32_16x16x32_bf16 v[144:147], a[160:163], a[196:199], v[144:147]
  buffer_load_dwordx4 v8, s[16:19], s43 offen sc1 lds
  v_mfma_f32_16x16x32_bf16 v[148:151], a[164:167], a[192:195], v[148:151]
  ds_read_b128 a[148:151], v5 offset:25600
  v_mul_f32 v54, v11, v38
  v_mfma_f32_16x16x32_bf16 v[152:155], a[164:167], a[196:199], v[152:155]
  v_rcp_f32 v51, v51
  v_mfma_f32_16x16x32_bf16 v[84:87], a[168:171], a[200:203], v[84:87]
  ds_read_b128 a[152:155], v5 offset:26624
  v_mul_f32 v55, v11, v39
  v_mfma_f32_16x16x32_bf16 v[88:91], a[168:171], a[204:207], v[88:91]
  buffer_load_dwordx4 v8, s[16:19], s43 offen offset:1024 sc1 lds
  v_mfma_f32_16x16x32_bf16 v[92:95], a[172:175], a[200:203], v[92:95]
  ds_read_b128 a[156:159], v5 offset:27648
  v_mul_f32 v56, v56, v48
  v_mfma_f32_16x16x32_bf16 v[96:99], a[172:175], a[204:207], v[96:99]
  s_waitcnt lgkmcnt(4)
  v_exp_f32 v52, v52
  v_mfma_f32_16x16x32_bf16 v[100:103], a[176:179], a[200:203], v[100:103]
  ds_read_b128 a[160:163], v5 offset:28672
  v_xor_b32 v6, 73728, v6
  v_mfma_f32_16x16x32_bf16 v[104:107], a[176:179], a[204:207], v[104:107]
  buffer_load_dwordx4 a[16:19], v82, s[12:15], s47 offen offset:2048 sc1
  v_mfma_f32_16x16x32_bf16 v[108:111], a[180:183], a[200:203], v[108:111]
  ds_read_b128 a[164:167], v5 offset:29696
  v_mul_f32 v57, v57, v49
  v_mfma_f32_16x16x32_bf16 v[112:115], a[180:183], a[204:207], v[112:115]
  v_exp_f32 v53, v53
  v_mfma_f32_16x16x32_bf16 v[116:119], a[184:187], a[200:203], v[116:119]
  ds_read_b128 a[168:171], v5 offset:30720
  v_mul_f32 v58, v58, v50
  v_mfma_f32_16x16x32_bf16 v[120:123], a[184:187], a[204:207], v[120:123]
  buffer_load_dwordx4 v8, s[16:19], s43 offen offset:2048 sc1 lds
  v_mfma_f32_16x16x32_bf16 v[124:127], a[188:191], a[200:203], v[124:127]
  ds_read_b128 a[172:175], v5 offset:31744
  s_add_u32 m0, s44, s53
  v_mfma_f32_16x16x32_bf16 v[128:131], a[188:191], a[204:207], v[128:131]
  s_waitcnt lgkmcnt(4)
  v_exp_f32 v54, v54
  v_mfma_f32_16x16x32_bf16 v[132:135], a[144:147], a[200:203], v[132:135]
  ds_read_b128 a[176:179], v5 offset:32768
  v_mul_f32 v59, v59, v51
  v_mfma_f32_16x16x32_bf16 v[136:139], a[144:147], a[204:207], v[136:139]
  buffer_load_dwordx4 v9, s[16:19], s43 offen sc1 lds
  v_mfma_f32_16x16x32_bf16 v[140:143], a[148:151], a[200:203], v[140:143]
  ds_read_b128 a[180:183], v5 offset:33792
  v_fma_f32 v52, v52, v13, v13
  v_mfma_f32_16x16x32_bf16 v[144:147], a[148:151], a[204:207], v[144:147]
  v_exp_f32 v55, v55
  v_mfma_f32_16x16x32_bf16 v[148:151], a[152:155], a[200:203], v[148:151]
  ds_read_b128 a[184:187], v5 offset:34816
  v_fma_f32 v53, v53, v13, v13
  v_mfma_f32_16x16x32_bf16 v[152:155], a[152:155], a[204:207], v[152:155]
  buffer_load_dwordx4 a[20:23], v82, s[12:15], s47 offen offset:3072 sc1
  v_mfma_f32_16x16x32_bf16 v[84:87], a[156:159], a[208:211], v[84:87]
  ds_read_b128 a[188:191], v5 offset:35840
  v_fma_f32 v54, v54, v13, v13
  v_mfma_f32_16x16x32_bf16 v[88:91], a[156:159], a[212:215], v[88:91]
  s_waitcnt lgkmcnt(4)
  v_rcp_f32 v52, v52
  v_mfma_f32_16x16x32_bf16 v[92:95], a[160:163], a[208:211], v[92:95]
  ds_read_b128 a[144:147], v6 offset:0
  v_fma_f32 v55, v55, v13, v13
  v_mfma_f32_16x16x32_bf16 v[96:99], a[160:163], a[212:215], v[96:99]
  buffer_load_dwordx4 v9, s[16:19], s43 offen offset:1024 sc1 lds
  v_mfma_f32_16x16x32_bf16 v[100:103], a[164:167], a[208:211], v[100:103]
  ds_read_b128 a[148:151], v6 offset:1024
  v_mul_f32 v60, v36, v44
  v_mfma_f32_16x16x32_bf16 v[104:107], a[164:167], a[212:215], v[104:107]
  v_rcp_f32 v53, v53
  v_mfma_f32_16x16x32_bf16 v[108:111], a[168:171], a[208:211], v[108:111]
  ds_read_b128 a[152:155], v6 offset:2048
  v_mul_f32 v61, v37, v45
  v_mfma_f32_16x16x32_bf16 v[112:115], a[168:171], a[212:215], v[112:115]
  buffer_load_dwordx4 v9, s[16:19], s43 offen offset:2048 sc1 lds
  v_mfma_f32_16x16x32_bf16 v[116:119], a[172:175], a[208:211], v[116:119]
  ds_read_b128 a[156:159], v6 offset:3072
  v_add_u32 v228, 1, v228
  v_mfma_f32_16x16x32_bf16 v[120:123], a[172:175], a[212:215], v[120:123]
  s_waitcnt vmcnt(15) lgkmcnt(4)
  v_rcp_f32 v54, v54
  v_mfma_f32_16x16x32_bf16 v[124:127], a[176:179], a[208:211], v[124:127]
  ds_read_b128 a[160:163], v6 offset:4096
  v_mul_f32 v62, v38, v46
  v_mfma_f32_16x16x32_bf16 v[128:131], a[176:179], a[212:215], v[128:131]
  ds_write_b32 v229, v228
  v_mul_f32 v63, v39, v47
  v_mfma_f32_16x16x32_bf16 v[132:135], a[180:183], a[208:211], v[132:135]
  ds_read_b128 a[164:167], v6 offset:5120
  v_mul_f32 v60, v60, v52
  v_mfma_f32_16x16x32_bf16 v[136:139], a[180:183], a[212:215], v[136:139]
  s_add_u32 s43, s43, 36864
  v_rcp_f32 v55, v55
  v_mfma_f32_16x16x32_bf16 v[140:143], a[184:187], a[208:211], v[140:143]
  ds_read_b128 a[168:171], v6 offset:6144
  v_mul_f32 v61, v61, v53
  v_mfma_f32_16x16x32_bf16 v[144:147], a[184:187], a[212:215], v[144:147]
  s_xor_b32 s44, s44, 73728
  v_mul_f32 v62, v62, v54
  v_mul_f32 v63, v63, v55
  v_mfma_f32_16x16x32_bf16 v[148:151], a[188:191], a[208:211], v[148:151]
  ds_read_b128 a[172:175], v6 offset:7168
  v_cvt_pk_bf16_f32 v218, v56, v57
  v_mfma_f32_16x16x32_bf16 v[152:155], a[188:191], a[212:215], v[152:155]
  s_waitcnt vmcnt(63) lgkmcnt(5)
  v_cvt_pk_bf16_f32 v219, v58, v59
  v_cvt_pk_bf16_f32 v222, v60, v61
  buffer_store_dwordx4 v[216:219], v1, s[12:15], s46 offen sc1
  v_cvt_pk_bf16_f32 v223, v62, v63
  buffer_store_dwordx4 v[220:223], v1, s[12:15], s46 offen offset:1024 sc1
  s_add_u32 s46, s46, 2048
  v_mfma_f32_16x16x32_bf16 v[84:87], a[144:147], v[184:187], v[84:87]
  ds_read_b128 a[176:179], v6 offset:8192
  v_mov_b32 v14, 10
  v_mfma_f32_16x16x32_bf16 v[88:91], a[144:147], v[188:191], v[88:91]
  ds_read_b32 v224, v230
  s_mov_b32 s47, 4096
  v_mfma_f32_16x16x32_bf16 v[92:95], a[148:151], v[184:187], v[92:95]
  ds_read_b128 a[180:183], v6 offset:9216
  v_mfma_f32_16x16x32_bf16 v[96:99], a[148:151], v[188:191], v[96:99]
  buffer_load_dwordx4 a[24:27], v83, s[12:15], s47 offen offset:2048 sc1
  v_mfma_f32_16x16x32_bf16 v[100:103], a[152:155], v[184:187], v[100:103]
  ds_read_b128 a[184:187], v6 offset:10240
  v_mfma_f32_16x16x32_bf16 v[104:107], a[152:155], v[188:191], v[104:107]
  v_mfma_f32_16x16x32_bf16 v[108:111], a[156:159], v[184:187], v[108:111]
  ds_read_b128 a[188:191], v6 offset:11264
  v_mfma_f32_16x16x32_bf16 v[112:115], a[156:159], v[188:191], v[112:115]
  s_waitcnt lgkmcnt(3)
  v_cmp_gt_u32 vcc, v228, v224
  v_mfma_f32_16x16x32_bf16 v[116:119], a[160:163], v[184:187], v[116:119]
  ds_read_b128 a[144:147], v6 offset:12288
  v_mfma_f32_16x16x32_bf16 v[120:123], a[160:163], v[188:191], v[120:123]
  buffer_load_dwordx4 a[28:31], v83, s[12:15], s47 offen offset:3072 sc1
  v_mfma_f32_16x16x32_bf16 v[124:127], a[164:167], v[184:187], v[124:127]
  ds_read_b128 a[148:151], v6 offset:13312
  s_cbranch_vccnz fs12_spin
fs12_back:
  v_mfma_f32_16x16x32_bf16 v[128:131], a[164:167], v[188:191], v[128:131]
  buffer_store_dword v14, v15, s[12:15], s41 offen sc1
  v_mfma_f32_16x16x32_bf16 v[132:135], a[168:171], v[184:187], v[132:135]
  ds_read_b128 a[152:155], v6 offset:14336
  s_add_u32 m0, s44, s48
  v_mfma_f32_16x16x32_bf16 v[136:139], a[168:171], v[188:191], v[136:139]
  buffer_load_dwordx4 v7, s[16:19], s43 offen sc1 lds
  v_mfma_f32_16x16x32_bf16 v[140:143], a[172:175], v[184:187], v[140:143]
  ds_read_b128 a[156:159], v6 offset:15360
  s_mov_b32 s47, 8192
  v_mfma_f32_16x16x32_bf16 v[144:147], a[172:175], v[188:191], v[144:147]
  s_waitcnt lgkmcnt(4)
  v_mfma_f32_16x16x32_bf16 v[148:151], a[176:179], v[184:187], v[148:151]
  ds_read_b128 a[160:163], v6 offset:16384
  v_mfma_f32_16x16x32_bf16 v[152:155], a[176:179], v[188:191], v[152:155]
  buffer_load_dwordx4 a[32:35], v81, s[12:15], s47 offen sc1
  v_mfma_f32_16x16x32_bf16 v[84:87], a[180:183], a[216:219], v[84:87]
  ds_read_b128 a[164:167], v6 offset:17408
  v_mfma_f32_16x16x32_bf16 v[88:91], a[180:183], a[220:223], v[88:91]
  v_mfma_f32_16x16x32_bf16 v[92:95], a[184:187], a[216:219], v[92:95]
  ds_read_b128 a[168:171], v6 offset:18432
  v_mfma_f32_16x16x32_bf16 v[96:99], a[184:187], a[220:223], v[96:99]
  buffer_load_dwordx4 v7, s[16:19], s43 offen offset:1024 sc1 lds
  v_mfma_f32_16x16x32_bf16 v[100:103], a[188:191], a[216:219], v[100:103]
  ds_read_b128 a[172:175], v6 offset:19456
  v_mfma_f32_16x16x32_bf16 v[104:107], a[188:191], a[220:223], v[104:107]
  s_waitcnt lgkmcnt(4)
  v_mfma_f32_16x16x32_bf16 v[108:111], a[144:147], a[216:219], v[108:111]
  ds_read_b128 a[176:179], v6 offset:20480
  v_mfma_f32_16x16x32_bf16 v[112:115], a[144:147], a[220:223], v[112:115]
  buffer_load_dwordx4 v7, s[16:19], s43 offen offset:2048 sc1 lds
  v_mfma_f32_16x16x32_bf16 v[116:119], a[148:151], a[216:219], v[116:119]
  ds_read_b128 a[180:183], v6 offset:21504
  s_add_u32 m0, s44, s49
  v_mfma_f32_16x16x32_bf16 v[120:123], a[148:151], a[220:223], v[120:123]
  v_mfma_f32_16x16x32_bf16 v[124:127], a[152:155], a[216:219], v[124:127]
  ds_read_b128 a[184:187], v6 offset:22528
  v_mfma_f32_16x16x32_bf16 v[128:131], a[152:155], a[220:223], v[128:131]
  buffer_load_dwordx4 v8, s[16:19], s43 offen sc1 lds
  v_mfma_f32_16x16x32_bf16 v[132:135], a[156:159], a[216:219], v[132:135]
  ds_read_b128 a[188:191], v6 offset:23552
  v_mfma_f32_16x16x32_bf16 v[136:139], a[156:159], a[220:223], v[136:139]
  s_waitcnt lgkmcnt(4)
  v_mfma_f32_16x16x32_bf16 v[140:143], a[160:163], a[216:219], v[140:143]
  ds_read_b128 a[144:147], v6 offset:24576
  v_mfma_f32_16x16x32_bf16 v[144:147], a[160:163], a[220:223], v[144:147]
  buffer_load_dwordx4 a[36:39], v81, s[12:15], s47 offen offset:1024 sc1
  v_mfma_f32_16x16x32_bf16 v[148:151], a[164:167], a[216:219], v[148:151]
  ds_read_b128 a[148:151], v6 offset:25600
  v_mfma_f32_16x16x32_bf16 v[152:155], a[164:167], a[220:223], v[152:155]
  v_mfma_f32_16x16x32_bf16 v[84:87], a[168:171], a[224:227], v[84:87]
  ds_read_b128 a[152:155], v6 offset:26624
  v_mfma_f32_16x16x32_bf16 v[88:91], a[168:171], a[228:231], v[88:91]
  v_mfma_f32_16x16x32_bf16 v[92:95], a[172:175], a[224:227], v[92:95]
  ds_read_b128 a[156:159], v6 offset:27648
  v_mfma_f32_16x16x32_bf16 v[96:99], a[172:175], a[228:231], v[96:99]
  s_waitcnt lgkmcnt(4)
  v_mfma_f32_16x16x32_bf16 v[100:103], a[176:179], a[224:227], v[100:103]
  ds_read_b128 a[160:163], v6 offset:28672
  v_xor_b32 v5, 73728, v5
  v_mfma_f32_16x16x32_bf16 v[104:107], a[176:179], a[228:231], v[104:107]
  buffer_load_dwordx4 v8, s[16:19], s43 offen offset:1024 sc1 lds
  v_mfma_f32_16x16x32_bf16 v[108:111], a[180:183], a[224:227], v[108:111]
  ds_read_b128 a[164:167], v6 offset:29696
  v_mfma_f32_16x16x32_bf16 v[112:115], a[180:183], a[228:231], v[112:115]
  v_mfma_f32_16x16x32_bf16 v[116:119], a[184:187], a[224:227], v[116:119]
  ds_read_b128 a[168:171], v6 offset:30720
  v_mfma_f32_16x16x32_bf16 v[120:123], a[184:187], a[228:231], v[120:123]
  buffer_load_dwordx4 v8, s[16:19], s43 offen offset:2048 sc1 lds
  v_mfma_f32_16x16x32_bf16 v[124:127], a[188:191], a[224:227], v[124:127]
  ds_read_b128 a[172:175], v6 offset:31744
  s_add_u32 m0, s44, s50
  v_mfma_f32_16x16x32_bf16 v[128:131], a[188:191], a[228:231], v[128:131]
  s_waitcnt lgkmcnt(4)
  v_mfma_f32_16x16x32_bf16 v[132:135], a[144:147], a[224:227], v[132:135]
  ds_read_b128 a[176:179], v6 offset:32768
  v_mfma_f32_16x16x32_bf16 v[136:139], a[144:147], a[228:231], v[136:139]
  v_mfma_f32_16x16x32_bf16 v[140:143], a[148:151], a[224:227], v[140:143]
  ds_read_b128 a[180:183], v6 offset:33792
  v_mfma_f32_16x16x32_bf16 v[144:147], a[148:151], a[228:231], v[144:147]
  buffer_load_dwordx4 v9, s[16:19], s43 offen sc1 lds
  v_mfma_f32_16x16x32_bf16 v[148:151], a[152:155], a[224:227], v[148:151]
  ds_read_b128 a[184:187], v6 offset:34816
  v_mfma_f32_16x16x32_bf16 v[152:155], a[152:155], a[228:231], v[152:155]
  v_mfma_f32_16x16x32_bf16 v[84:87], a[156:159], a[232:235], v[84:87]
  ds_read_b128 a[188:191], v6 offset:35840
  v_mfma_f32_16x16x32_bf16 v[88:91], a[156:159], a[236:239], v[88:91]
  s_waitcnt lgkmcnt(4)
  v_mfma_f32_16x16x32_bf16 v[92:95], a[160:163], a[232:235], v[92:95]
  ds_read_b128 a[144:147], v5 offset:0
  v_mfma_f32_16x16x32_bf16 v[96:99], a[160:163], a[236:239], v[96:99]
  buffer_load_dwordx4 a[40:43], v82, s[12:15], s47 offen sc1
  v_mfma_f32_16x16x32_bf16 v[100:103], a[164:167], a[232:235], v[100:103]
  ds_read_b128 a[148:151], v5 offset:1024
  v_mfma_f32_16x16x32_bf16 v[104:107], a[164:167], a[236:239], v[104:107]
  v_mfma_f32_16x16x32_bf16 v[108:111], a[168:171], a[232:235], v[108:111]
  ds_read_b128 a[152:155], v5 offset:2048
  v_mfma_f32_16x16x32_bf16 v[112:115], a[168:171], a[236:239], v[112:115]
  buffer_load_dwordx4 v9, s[16:19], s43 offen offset:1024 sc1 lds
  v_mfma_f32_16x16x32_bf16 v[116:119], a[172:175], a[232:235], v[116:119]
  ds_read_b128 a[156:159], v5 offset:3072
  v_add_u32 v228, 1, v228
  v_mfma_f32_16x16x32_bf16 v[120:123], a[172:175], a[236:239], v[120:123]
  s_waitcnt vmcnt(16) lgkmcnt(4)
  v_mfma_f32_16x16x32_bf16 v[124:127], a[176:179], a[232:235], v[124:127]
  ds_read_b128 a[160:163], v5 offset:4096
  v_mfma_f32_16x16x32_bf16 v[128:131], a[176:179], a[236:239], v[128:131]
  ds_write_b32 v229, v228
  v_mfma_f32_16x16x32_bf16 v[132:135], a[180:183], a[232:235], v[132:135]
  ds_read_b128 a[164:167], v5 offset:5120
  v_mfma_f32_16x16x32_bf16 v[136:139], a[180:183], a[236:239], v[136:139]
  buffer_load_dwordx4 v9, s[16:19], s43 offen offset:2048 sc1 lds
  v_mfma_f32_16x16x32_bf16 v[140:143], a[184:187], a[232:235], v[140:143]
  ds_read_b128 a[168:171], v5 offset:6144
  s_add_u32 s43, s43, 36864
  v_mfma_f32_16x16x32_bf16 v[144:147], a[184:187], a[236:239], v[144:147]
  v_mfma_f32_16x16x32_bf16 v[148:151], a[188:191], a[232:235], v[148:151]
  ds_read_b128 a[172:175], v5 offset:7168
  v_mfma_f32_16x16x32_bf16 v[152:155], a[188:191], a[236:239], v[152:155]
  s_waitcnt vmcnt(63) lgkmcnt(5)
  v_mfma_f32_16x16x32_bf16 v[84:87], a[144:147], a[240:243], v[84:87]
  ds_read_b128 a[176:179], v5 offset:8192
  s_mov_b32 s47, 8192
  v_mfma_f32_16x16x32_bf16 v[88:91], a[144:147], a[244:247], v[88:91]
  ds_read_b32 v224, v230
  v_mfma_f32_16x16x32_bf16 v[92:95], a[148:151], a[240:243], v[92:95]
  ds_read_b128 a[180:183], v5 offset:9216
  v_mfma_f32_16x16x32_bf16 v[96:99], a[148:151], a[244:247], v[96:99]
  buffer_load_dwordx4 a[44:47], v82, s[12:15], s47 offen offset:1024 sc1
  v_mfma_f32_16x16x32_bf16 v[100:103], a[152:155], a[240:243], v[100:103]
  ds_read_b128 a[184:187], v5 offset:10240
  v_mfma_f32_16x16x32_bf16 v[104:107], a[152:155], a[244:247], v[104:107]
  v_mfma_f32_16x16x32_bf16 v[108:111], a[156:159], a[240:243], v[108:111]
  ds_read_b128 a[188:191], v5 offset:11264
  v_mfma_f32_16x16x32_bf16 v[112:115], a[156:159], a[244:247], v[112:115]
  s_waitcnt lgkmcnt(3)
  v_cmp_gt_u32 vcc, v228, v224
  v_mfma_f32_16x16x32_bf16 v[116:119], a[160:163], a[240:243], v[116:119]
  ds_read_b128 a[144:147], v5 offset:12288
  v_mfma_f32_16x16x32_bf16 v[120:123], a[160:163], a[244:247], v[120:123]
  buffer_load_dwordx4 a[48:51], v83, s[12:15], s47 offen sc1
  v_mfma_f32_16x16x32_bf16 v[124:127], a[164:167], a[240:243], v[124:127]
  ds_read_b128 a[148:151], v5 offset:13312
  s_cbranch_vccnz fs13_spin
fs13_back:
  v_mfma_f32_16x16x32_bf16 v[128:131], a[164:167], a[244:247], v[128:131]
  s_add_u32 m0, s44, s51
  v_mfma_f32_16x16x32_bf16 v[132:135], a[168:171], a[240:243], v[132:135]
  ds_read_b128 a[152:155], v5 offset:14336
  v_mfma_f32_16x16x32_bf16 v[136:139], a[168:171], a[244:247], v[136:139]
  buffer_load_dwordx4 v7, s[16:19], s43 offen sc1 lds
  v_mfma_f32_16x16x32_bf16 v[140:143], a[172:175], a[240:243], v[140:143]
  ds_read_b128 a[156:159], v5 offset:15360
  v_mfma_f32_16x16x32_bf16 v[144:147], a[172:175], a[244:247], v[144:147]
  s_waitcnt lgkmcnt(4)
  v_mfma_f32_16x16x32_bf16 v[148:151], a[176:179], a[240:243], v[148:151]
  ds_read_b128 a[160:163], v5 offset:16384
  v_mfma_f32_16x16x32_bf16 v[152:155], a[176:179], a[244:247], v[152:155]
  buffer_load_dwordx4 a[52:55], v83, s[12:15], s47 offen offset:1024 sc1
  v_mfma_f32_16x16x32_bf16 v[84:87], a[180:183], a[248:251], v[84:87]
  ds_read_b128 a[164:167], v5 offset:17408
  v_mfma_f32_16x16x32_bf16 v[88:91], a[180:183], a[252:255], v[88:91]
  v_mfma_f32_16x16x32_bf16 v[92:95], a[184:187], a[248:251], v[92:95]
  ds_read_b128 a[168:171], v5 offset:18432
  v_mfma_f32_16x16x32_bf16 v[96:99], a[184:187], a[252:255], v[96:99]
  buffer_load_dword v72, v74, s[12:15], s41 offen sc1
  v_mfma_f32_16x16x32_bf16 v[100:103], a[188:191], a[248:251], v[100:103]
  ds_read_b128 a[172:175], v5 offset:19456
  v_mfma_f32_16x16x32_bf16 v[104:107], a[188:191], a[252:255], v[104:107]
  s_waitcnt lgkmcnt(4)
  v_mfma_f32_16x16x32_bf16 v[108:111], a[144:147], a[248:251], v[108:111]
  ds_read_b128 a[176:179], v5 offset:20480
  v_mfma_f32_16x16x32_bf16 v[112:115], a[144:147], a[252:255], v[112:115]
  buffer_load_dwordx4 v7, s[16:19], s43 offen offset:1024 sc1 lds
  v_mfma_f32_16x16x32_bf16 v[116:119], a[148:151], a[248:251], v[116:119]
  ds_read_b128 a[180:183], v5 offset:21504
  v_mfma_f32_16x16x32_bf16 v[120:123], a[148:151], a[252:255], v[120:123]
  v_mfma_f32_16x16x32_bf16 v[124:127], a[152:155], a[248:251], v[124:127]
  ds_read_b128 a[184:187], v5 offset:22528
  v_mfma_f32_16x16x32_bf16 v[128:131], a[152:155], a[252:255], v[128:131]
  buffer_load_dwordx4 v7, s[16:19], s43 offen offset:2048 sc1 lds
  v_mfma_f32_16x16x32_bf16 v[132:135], a[156:159], a[248:251], v[132:135]
  ds_read_b128 a[188:191], v5 offset:23552
  s_add_u32 m0, s44, s52
  v_mfma_f32_16x16x32_bf16 v[136:139], a[156:159], a[252:255], v[136:139]
  s_waitcnt lgkmcnt(4)
  v_mfma_f32_16x16x32_bf16 v[140:143], a[160:163], a[248:251], v[140:143]
  ds_read_b128 a[144:147], v5 offset:24576
  v_mfma_f32_16x16x32_bf16 v[144:147], a[160:163], a[252:255], v[144:147]
  buffer_load_dwordx4 v8, s[16:19], s43 offen sc1 lds
  v_mfma_f32_16x16x32_bf16 v[148:151], a[164:167], a[248:251], v[148:151]
  ds_read_b128 a[148:151], v5 offset:25600
  v_mfma_f32_16x16x32_bf16 v[152:155], a[164:167], a[252:255], v[152:155]
  v_mfma_f32_16x16x32_bf16 v[84:87], a[168:171], v[160:163], v[84:87]
  ds_read_b128 a[152:155], v5 offset:26624
  v_mfma_f32_16x16x32_bf16 v[88:91], a[168:171], v[164:167], v[88:91]
  buffer_load_dwordx4 a[56:59], v81, s[12:15], s47 offen offset:2048 sc1
  v_mfma_f32_16x16x32_bf16 v[92:95], a[172:175], v[160:163], v[92:95]
  ds_read_b128 a[156:159], v5 offset:27648
  v_mfma_f32_16x16x32_bf16 v[96:99], a[172:175], v[164:167], v[96:99]
  s_waitcnt lgkmcnt(4)
  v_mfma_f32_16x16x32_bf16 v[100:103], a[176:179], v[160:163], v[100:103]
  ds_read_b128 a[160:163], v5 offset:28672
  v_xor_b32 v6, 73728, v6
  v_mfma_f32_16x16x32_bf16 v[104:107], a[176:179], v[164:167], v[104:107]
  buffer_load_dwordx4 v8, s[16:19], s43 offen offset:1024 sc1 lds
  v_mfma_f32_16x16x32_bf16 v[108:111], a[180:183], v[160:163], v[108:111]
  ds_read_b128 a[164:167], v5 offset:29696
  v_mfma_f32_16x16x32_bf16 v[112:115], a[180:183], v[164:167], v[112:115]
  v_mfma_f32_16x16x32_bf16 v[116:119], a[184:187], v[160:163], v[116:119]
  ds_read_b128 a[168:171], v5 offset:30720
  v_mfma_f32_16x16x32_bf16 v[120:123], a[184:187], v[164:167], v[120:123]
  buffer_load_dwordx4 v8, s[16:19], s43 offen offset:2048 sc1 lds
  v_mfma_f32_16x16x32_bf16 v[124:127], a[188:191], v[160:163], v[124:127]
  ds_read_b128 a[172:175], v5 offset:31744
  s_add_u32 m0, s44, s53
  v_mfma_f32_16x16x32_bf16 v[128:131], a[188:191], v[164:167], v[128:131]
  s_waitcnt lgkmcnt(4)
  v_mfma_f32_16x16x32_bf16 v[132:135], a[144:147], v[160:163], v[132:135]
  ds_read_b128 a[176:179], v5 offset:32768
  v_mfma_f32_16x16x32_bf16 v[136:139], a[144:147], v[164:167], v[136:139]
  v_mfma_f32_16x16x32_bf16 v[140:143], a[148:151], v[160:163], v[140:143]
  ds_read_b128 a[180:183], v5 offset:33792
  v_mfma_f32_16x16x32_bf16 v[144:147], a[148:151], v[164:167], v[144:147]
  buffer_load_dwordx4 v9, s[16:19], s43 offen sc1 lds
  v_mfma_f32_16x16x32_bf16 v[148:151], a[152:155], v[160:163], v[148:151]
  ds_read_b128 a[184:187], v5 offset:34816
  v_mfma_f32_16x16x32_bf16 v[152:155], a[152:155], v[164:167], v[152:155]
  v_mfma_f32_16x16x32_bf16 v[84:87], a[156:159], v[168:171], v[84:87]
  ds_read_b128 a[188:191], v5 offset:35840
  v_mfma_f32_16x16x32_bf16 v[88:91], a[156:159], v[172:175], v[88:91]
  s_waitcnt lgkmcnt(4)
  v_mfma_f32_16x16x32_bf16 v[92:95], a[160:163], v[168:171], v[92:95]
  ds_read_b128 a[144:147], v6 offset:0
  v_mfma_f32_16x16x32_bf16 v[96:99], a[160:163], v[172:175], v[96:99]
  buffer_load_dwordx4 a[60:63], v81, s[12:15], s47 offen offset:3072 sc1
  v_mfma_f32_16x16x32_bf16 v[100:103], a[164:167], v[168:171], v[100:103]
  ds_read_b128 a[148:151], v6 offset:1024
  v_mfma_f32_16x16x32_bf16 v[104:107], a[164:167], v[172:175], v[104:107]
  v_mfma_f32_16x16x32_bf16 v[108:111], a[168:171], v[168:171], v[108:111]
  ds_read_b128 a[152:155], v6 offset:2048
  v_mfma_f32_16x16x32_bf16 v[112:115], a[168:171], v[172:175], v[112:115]
  buffer_load_dwordx4 v9, s[16:19], s43 offen offset:1024 sc1 lds
  v_mfma_f32_16x16x32_bf16 v[116:119], a[172:175], v[168:171], v[116:119]
  ds_read_b128 a[156:159], v6 offset:3072
  v_add_u32 v228, 1, v228
  v_mfma_f32_16x16x32_bf16 v[120:123], a[172:175], v[172:175], v[120:123]
  s_waitcnt vmcnt(14) lgkmcnt(4)
  v_mfma_f32_16x16x32_bf16 v[124:127], a[176:179], v[168:171], v[124:127]
  ds_read_b128 a[160:163], v6 offset:4096
  v_mfma_f32_16x16x32_bf16 v[128:131], a[176:179], v[172:175], v[128:131]
  ds_write_b32 v229, v228
  v_mfma_f32_16x16x32_bf16 v[132:135], a[180:183], v[168:171], v[132:135]
  ds_read_b128 a[164:167], v6 offset:5120
  v_mfma_f32_16x16x32_bf16 v[136:139], a[180:183], v[172:175], v[136:139]
  buffer_load_dwordx4 v9, s[16:19], s43 offen offset:2048 sc1 lds
  v_mfma_f32_16x16x32_bf16 v[140:143], a[184:187], v[168:171], v[140:143]
  ds_read_b128 a[168:171], v6 offset:6144
  s_add_u32 s43, s43, 36864
  v_mfma_f32_16x16x32_bf16 v[144:147], a[184:187], v[172:175], v[144:147]
  s_xor_b32 s44, s44, 73728
  v_mfma_f32_16x16x32_bf16 v[148:151], a[188:191], v[168:171], v[148:151]
  ds_read_b128 a[172:175], v6 offset:7168
  v_mfma_f32_16x16x32_bf16 v[152:155], a[188:191], v[172:175], v[152:155]
  s_waitcnt vmcnt(10) lgkmcnt(5)
  v_mfma_f32_16x16x32_bf16 v[84:87], a[144:147], a[0:3], v[84:87]
  ds_read_b128 a[176:179], v6 offset:8192
  v_cmp_gt_u32 vcc, 10, v72
  v_mfma_f32_16x16x32_bf16 v[88:91], a[144:147], a[4:7], v[88:91]
  ds_read_b32 v224, v230
  v_mov_b32 v14, 11
  v_mfma_f32_16x16x32_bf16 v[92:95], a[148:151], a[0:3], v[92:95]
  ds_read_b128 a[180:183], v6 offset:9216
  s_cbranch_vccnz f21_spin
f21_back:
  v_mfma_f32_16x16x32_bf16 v[96:99], a[148:151], a[4:7], v[96:99]
  s_mov_b32 s47, 8192
  v_mfma_f32_16x16x32_bf16 v[100:103], a[152:155], a[0:3], v[100:103]
  ds_read_b128 a[184:187], v6 offset:10240
  v_mfma_f32_16x16x32_bf16 v[104:107], a[152:155], a[4:7], v[104:107]
  buffer_load_dwordx4 a[64:67], v82, s[12:15], s47 offen offset:2048 sc1
  v_mfma_f32_16x16x32_bf16 v[108:111], a[156:159], a[0:3], v[108:111]
  ds_read_b128 a[188:191], v6 offset:11264
  v_mfma_f32_16x16x32_bf16 v[112:115], a[156:159], a[4:7], v[112:115]
  s_waitcnt lgkmcnt(3)
  v_cmp_gt_u32 vcc, v228, v224
  v_mfma_f32_16x16x32_bf16 v[116:119], a[160:163], a[0:3], v[116:119]
  ds_read_b128 a[144:147], v6 offset:12288
  v_mfma_f32_16x16x32_bf16 v[120:123], a[160:163], a[4:7], v[120:123]
  buffer_load_dwordx4 a[68:71], v82, s[12:15], s47 offen offset:3072 sc1
  v_mfma_f32_16x16x32_bf16 v[124:127], a[164:167], a[0:3], v[124:127]
  ds_read_b128 a[148:151], v6 offset:13312
  s_cbranch_vccnz fs15_spin
fs15_back:
  v_mfma_f32_16x16x32_bf16 v[128:131], a[164:167], a[4:7], v[128:131]
  buffer_store_dword v14, v15, s[12:15], s41 offen sc1
  v_mfma_f32_16x16x32_bf16 v[132:135], a[168:171], a[0:3], v[132:135]
  ds_read_b128 a[152:155], v6 offset:14336
  s_add_u32 m0, s44, s48
  v_mfma_f32_16x16x32_bf16 v[136:139], a[168:171], a[4:7], v[136:139]
  buffer_load_dwordx4 v7, s[16:19], s43 offen sc1 lds
  v_mfma_f32_16x16x32_bf16 v[140:143], a[172:175], a[0:3], v[140:143]
  ds_read_b128 a[156:159], v6 offset:15360
  v_mfma_f32_16x16x32_bf16 v[144:147], a[172:175], a[4:7], v[144:147]
  s_waitcnt lgkmcnt(4)
  v_mfma_f32_16x16x32_bf16 v[148:151], a[176:179], a[0:3], v[148:151]
  ds_read_b128 a[160:163], v6 offset:16384
  v_mfma_f32_16x16x32_bf16 v[152:155], a[176:179], a[4:7], v[152:155]
  buffer_load_dwordx4 a[72:75], v83, s[12:15], s47 offen offset:2048 sc1
  v_mfma_f32_16x16x32_bf16 v[84:87], a[180:183], a[8:11], v[84:87]
  ds_read_b128 a[164:167], v6 offset:17408
  v_mfma_f32_16x16x32_bf16 v[88:91], a[180:183], a[12:15], v[88:91]
  v_mfma_f32_16x16x32_bf16 v[92:95], a[184:187], a[8:11], v[92:95]
  ds_read_b128 a[168:171], v6 offset:18432
  v_mfma_f32_16x16x32_bf16 v[96:99], a[184:187], a[12:15], v[96:99]
  buffer_load_dwordx4 v7, s[16:19], s43 offen offset:1024 sc1 lds
  v_mfma_f32_16x16x32_bf16 v[100:103], a[188:191], a[8:11], v[100:103]
  ds_read_b128 a[172:175], v6 offset:19456
  v_mfma_f32_16x16x32_bf16 v[104:107], a[188:191], a[12:15], v[104:107]
  s_waitcnt lgkmcnt(4)
  v_mfma_f32_16x16x32_bf16 v[108:111], a[144:147], a[8:11], v[108:111]
  ds_read_b128 a[176:179], v6 offset:20480
  v_mfma_f32_16x16x32_bf16 v[112:115], a[144:147], a[12:15], v[112:115]
  buffer_load_dwordx4 v7, s[16:19], s43 offen offset:2048 sc1 lds
  v_mfma_f32_16x16x32_bf16 v[116:119], a[148:151], a[8:11], v[116:119]
  ds_read_b128 a[180:183], v6 offset:21504
  v_mfma_f32_16x16x32_bf16 v[120:123], a[148:151], a[12:15], v[120:123]
  v_mfma_f32_16x16x32_bf16 v[124:127], a[152:155], a[8:11], v[124:127]
  ds_read_b128 a[184:187], v6 offset:22528
  v_mfma_f32_16x16x32_bf16 v[128:131], a[152:155], a[12:15], v[128:131]
  buffer_load_dwordx4 a[76:79], v83, s[12:15], s47 offen offset:3072 sc1
  v_mfma_f32_16x16x32_bf16 v[132:135], a[156:159], a[8:11], v[132:135]
  ds_read_b128 a[188:191], v6 offset:23552
  s_add_u32 m0, s44, s49
  v_mfma_f32_16x16x32_bf16 v[136:139], a[156:159], a[12:15], v[136:139]
  s_waitcnt lgkmcnt(4)
  v_mfma_f32_16x16x32_bf16 v[140:143], a[160:163], a[8:11], v[140:143]
  ds_read_b128 a[144:147], v6 offset:24576
  v_mfma_f32_16x16x32_bf16 v[144:147], a[160:163], a[12:15], v[144:147]
  buffer_load_dwordx4 v8, s[16:19], s43 offen sc1 lds
  v_mfma_f32_16x16x32_bf16 v[148:151], a[164:167], a[8:11], v[148:151]
  ds_read_b128 a[148:151], v6 offset:25600
  v_mfma_f32_16x16x32_bf16 v[152:155], a[164:167], a[12:15], v[152:155]
  v_mfma_f32_16x16x32_bf16 v[84:87], a[168:171], a[16:19], v[84:87]
  ds_read_b128 a[152:155], v6 offset:26624
  v_mfma_f32_16x16x32_bf16 v[88:91], a[168:171], a[20:23], v[88:91]
  buffer_load_dwordx4 v8, s[16:19], s43 offen offset:1024 sc1 lds
  v_mfma_f32_16x16x32_bf16 v[92:95], a[172:175], a[16:19], v[92:95]
  ds_read_b128 a[156:159], v6 offset:27648
  s_mov_b32 s47, 12288
  v_mfma_f32_16x16x32_bf16 v[96:99], a[172:175], a[20:23], v[96:99]
  s_waitcnt lgkmcnt(4)
  v_mfma_f32_16x16x32_bf16 v[100:103], a[176:179], a[16:19], v[100:103]
  ds_read_b128 a[160:163], v6 offset:28672
  v_xor_b32 v5, 73728, v5
  v_mfma_f32_16x16x32_bf16 v[104:107], a[176:179], a[20:23], v[104:107]
  buffer_load_dwordx4 a[80:83], v81, s[12:15], s47 offen sc1
  v_mfma_f32_16x16x32_bf16 v[108:111], a[180:183], a[16:19], v[108:111]
  ds_read_b128 a[164:167], v6 offset:29696
  v_mfma_f32_16x16x32_bf16 v[112:115], a[180:183], a[20:23], v[112:115]
  v_mfma_f32_16x16x32_bf16 v[116:119], a[184:187], a[16:19], v[116:119]
  ds_read_b128 a[168:171], v6 offset:30720
  v_mfma_f32_16x16x32_bf16 v[120:123], a[184:187], a[20:23], v[120:123]
  buffer_load_dwordx4 v8, s[16:19], s43 offen offset:2048 sc1 lds
  v_mfma_f32_16x16x32_bf16 v[124:127], a[188:191], a[16:19], v[124:127]
  ds_read_b128 a[172:175], v6 offset:31744
  s_add_u32 m0, s44, s50
  v_mfma_f32_16x16x32_bf16 v[128:131], a[188:191], a[20:23], v[128:131]
  s_waitcnt lgkmcnt(4)
  v_mfma_f32_16x16x32_bf16 v[132:135], a[144:147], a[16:19], v[132:135]
  ds_read_b128 a[176:179], v6 offset:32768
  v_mfma_f32_16x16x32_bf16 v[136:139], a[144:147], a[20:23], v[136:139]
  v_mfma_f32_16x16x32_bf16 v[140:143], a[148:151], a[16:19], v[140:143]
  ds_read_b128 a[180:183], v6 offset:33792
  v_mfma_f32_16x16x32_bf16 v[144:147], a[148:151], a[20:23], v[144:147]
  buffer_load_dwordx4 v9, s[16:19], s43 offen sc1 lds
  v_mfma_f32_16x16x32_bf16 v[148:151], a[152:155], a[16:19], v[148:151]
  ds_read_b128 a[184:187], v6 offset:34816
  v_mfma_f32_16x16x32_bf16 v[152:155], a[152:155], a[20:23], v[152:155]
  v_mfma_f32_16x16x32_bf16 v[84:87], a[156:159], a[24:27], v[84:87]
  ds_read_b128 a[188:191], v6 offset:35840
  v_mfma_f32_16x16x32_bf16 v[88:91], a[156:159], a[28:31], v[88:91]
  s_waitcnt lgkmcnt(4)
  v_mfma_f32_16x16x32_bf16 v[92:95], a[160:163], a[24:27], v[92:95]
  ds_read_b128 a[144:147], v5 offset:0
  v_mfma_f32_16x16x32_bf16 v[96:99], a[160:163], a[28:31], v[96:99]
  buffer_load_dwordx4 a[84:87], v81, s[12:15], s47 offen offset:1024 sc1
  v_mfma_f32_16x16x32_bf16 v[100:103], a[164:167], a[24:27], v[100:103]
  ds_read_b128 a[148:151], v5 offset:1024
  v_mfma_f32_16x16x32_bf16 v[104:107], a[164:167], a[28:31], v[104:107]
  v_mfma_f32_16x16x32_bf16 v[108:111], a[168:171], a[24:27], v[108:111]
  ds_read_b128 a[152:155], v5 offset:2048
  v_mfma_f32_16x16x32_bf16 v[112:115], a[168:171], a[28:31], v[112:115]
  buffer_load_dwordx4 v9, s[16:19], s43 offen offset:1024 sc1 lds
  v_mfma_f32_16x16x32_bf16 v[116:119], a[172:175], a[24:27], v[116:119]
  ds_read_b128 a[156:159], v5 offset:3072
  v_add_u32 v228, 1, v228
  v_mfma_f32_16x16x32_bf16 v[120:123], a[172:175], a[28:31], v[120:123]
  s_waitcnt vmcnt(15) lgkmcnt(4)
  v_mfma_f32_16x16x32_bf16 v[124:127], a[176:179], a[24:27], v[124:127]
  ds_read_b128 a[160:163], v5 offset:4096
  v_mfma_f32_16x16x32_bf16 v[128:131], a[176:179], a[28:31], v[128:131]
  ds_write_b32 v229, v228
  v_mfma_f32_16x16x32_bf16 v[132:135], a[180:183], a[24:27], v[132:135]
  ds_read_b128 a[164:167], v5 offset:5120
  v_mfma_f32_16x16x32_bf16 v[136:139], a[180:183], a[28:31], v[136:139]
  buffer_load_dwordx4 v9, s[16:19], s43 offen offset:2048 sc1 lds
  v_mfma_f32_16x16x32_bf16 v[140:143], a[184:187], a[24:27], v[140:143]
  ds_read_b128 a[168:171], v5 offset:6144
  s_add_u32 s43, s43, 36864
  v_mfma_f32_16x16x32_bf16 v[144:147], a[184:187], a[28:31], v[144:147]
  v_mfma_f32_16x16x32_bf16 v[148:151], a[188:191], a[24:27], v[148:151]
  ds_read_b128 a[172:175], v5 offset:7168
  v_mfma_f32_16x16x32_bf16 v[152:155], a[188:191], a[28:31], v[152:155]
  s_waitcnt vmcnt(63) lgkmcnt(5)
  v_mfma_f32_16x16x32_bf16 v[84:87], a[144:147], v[64:67], v[84:87]
  ds_read_b128 a[176:179], v5 offset:8192
  s_mov_b32 s47, 12288
  v_mfma_f32_16x16x32_bf16 v[88:91], a[144:147], v[68:71], v[88:91]
  ds_read_b32 v224, v230
  v_mfma_f32_16x16x32_bf16 v[92:95], a[148:151], v[64:67], v[92:95]
  ds_read_b128 a[180:183], v5 offset:9216
  v_mfma_f32_16x16x32_bf16 v[96:99], a[148:151], v[68:71], v[96:99]
  buffer_load_dwordx4 a[88:91], v82, s[12:15], s47 offen sc1
  v_mfma_f32_16x16x32_bf16 v[100:103], a[152:155], v[64:67], v[100:103]
  ds_read_b128 a[184:187], v5 offset:10240
  v_mfma_f32_16x16x32_bf16 v[104:107], a[152:155], v[68:71], v[104:107]
  v_mfma_f32_16x16x32_bf16 v[108:111], a[156:159], v[64:67], v[108:111]
  ds_read_b128 a[188:191], v5 offset:11264
  v_mfma_f32_16x16x32_bf16 v[112:115], a[156:159], v[68:71], v[112:115]
  s_waitcnt lgkmcnt(3)
  v_cmp_gt_u32 vcc, v228, v224
  v_mfma_f32_16x16x32_bf16 v[116:119], a[160:163], v[64:67], v[116:119]
  ds_read_b128 a[144:147], v5 offset:12288
  v_mfma_f32_16x16x32_bf16 v[120:123], a[160:163], v[68:71], v[120:123]
  buffer_load_dwordx4 a[92:95], v82, s[12:15], s47 offen offset:1024 sc1
  v_mfma_f32_16x16x32_bf16 v[124:127], a[164:167], v[64:67], v[124:127]
  ds_read_b128 a[148:151], v5 offset:13312
  s_cbranch_vccnz fs16_spin
fs16_back:
  v_mfma_f32_16x16x32_bf16 v[128:131], a[164:167], v[68:71], v[128:131]
  s_add_u32 m0, s44, s51
  v_mfma_f32_16x16x32_bf16 v[132:135], a[168:171], v[64:67], v[132:135]
  ds_read_b128 a[152:155], v5 offset:14336
  v_mfma_f32_16x16x32_bf16 v[136:139], a[168:171], v[68:71], v[136:139]
  buffer_load_dwordx4 v7, s[16:19], s43 offen sc1 lds
  v_mfma_f32_16x16x32_bf16 v[140:143], a[172:175], v[64:67], v[140:143]
  ds_read_b128 a[156:159], v5 offset:15360
  v_mfma_f32_16x16x32_bf16 v[144:147], a[172:175], v[68:71], v[144:147]
  s_waitcnt lgkmcnt(4)
  v_mfma_f32_16x16x32_bf16 v[148:151], a[176:179], v[64:67], v[148:151]
  ds_read_b128 a[160:163], v5 offset:16384
  v_mfma_f32_16x16x32_bf16 v[152:155], a[176:179], v[68:71], v[152:155]
  buffer_load_dwordx4 a[96:99], v83, s[12:15], s47 offen sc1
  v_mfma_f32_16x16x32_bf16 v[84:87], a[180:183], a[32:35], v[84:87]
  ds_read_b128 a[164:167], v5 offset:17408
  v_mfma_f32_16x16x32_bf16 v[88:91], a[180:183], a[36:39], v[88:91]
  v_mfma_f32_16x16x32_bf16 v[92:95], a[184:187], a[32:35], v[92:95]
  ds_read_b128 a[168:171], v5 offset:18432
  v_mfma_f32_16x16x32_bf16 v[96:99], a[184:187], a[36:39], v[96:99]
  buffer_load_dword v72, v74, s[12:15], s41 offen sc1
  v_mfma_f32_16x16x32_bf16 v[100:103], a[188:191], a[32:35], v[100:103]
  ds_read_b128 a[172:175], v5 offset:19456
  v_mfma_f32_16x16x32_bf16 v[104:107], a[188:191], a[36:39], v[104:107]
  s_waitcnt lgkmcnt(4)
  v_mfma_f32_16x16x32_bf16 v[108:111], a[144:147], a[32:35], v[108:111]
  ds_read_b128 a[176:179], v5 offset:20480
  v_mfma_f32_16x16x32_bf16 v[112:115], a[144:147], a[36:39], v[112:115]
  buffer_load_dwordx4 v7, s[16:19], s43 offen offset:1024 sc1 lds
  v_mfma_f32_16x16x32_bf16 v[116:119], a[148:151], a[32:35], v[116:119]
  ds_read_b128 a[180:183], v5 offset:21504
  v_mfma_f32_16x16x32_bf16 v[120:123], a[148:151], a[36:39], v[120:123]
  v_mfma_f32_16x16x32_bf16 v[124:127], a[152:155], a[32:35], v[124:127]
  ds_read_b128 a[184:187], v5 offset:22528
  v_mfma_f32_16x16x32_bf16 v[128:131], a[152:155], a[36:39], v[128:131]
  buffer_load_dwordx4 v7, s[16:19], s43 offen offset:2048 sc1 lds
  v_mfma_f32_16x16x32_bf16 v[132:135], a[156:159], a[32:35], v[132:135]
  ds_read_b128 a[188:191], v5 offset:23552
  s_add_u32 m0, s44, s52
  v_mfma_f32_16x16x32_bf16 v[136:139], a[156:159], a[36:39], v[136:139]
  s_waitcnt lgkmcnt(4)
  v_mfma_f32_16x16x32_bf16 v[140:143], a[160:163], a[32:35], v[140:143]
  ds_read_b128 a[144:147], v5 offset:24576
  v_mfma_f32_16x16x32_bf16 v[144:147], a[160:163], a[36:39], v[144:147]
  buffer_load_dwordx4 v8, s[16:19], s43 offen sc1 lds
  v_mfma_f32_16x16x32_bf16 v[148:151], a[164:167], a[32:35], v[148:151]
  ds_read_b128 a[148:151], v5 offset:25600
  v_mfma_f32_16x16x32_bf16 v[152:155], a[164:167], a[36:39], v[152:155]
  v_mfma_f32_16x16x32_bf16 v[84:87], a[168:171], a[40:43], v[84:87]
  ds_read_b128 a[152:155], v5 offset:26624
  v_mfma_f32_16x16x32_bf16 v[88:91], a[168:171], a[44:47], v[88:91]
  buffer_load_dwordx4 a[100:103], v83, s[12:15], s47 offen offset:1024 sc1
  v_mfma_f32_16x16x32_bf16 v[92:95], a[172:175], a[40:43], v[92:95]
  ds_read_b128 a[156:159], v5 offset:27648
  v_mfma_f32_16x16x32_bf16 v[96:99], a[172:175], a[44:47], v[96:99]
  s_waitcnt lgkmcnt(4)
  v_mfma_f32_16x16x32_bf16 v[100:103], a[176:179], a[40:43], v[100:103]
  ds_read_b128 a[160:163], v5 offset:28672
  v_xor_b32 v6, 73728, v6
  v_mfma_f32_16x16x32_bf16 v[104:107], a[176:179], a[44:47], v[104:107]
  buffer_load_dwordx4 v8, s[16:19], s43 offen offset:1024 sc1 lds
  v_mfma_f32_16x16x32_bf16 v[108:111], a[180:183], a[40:43], v[108:111]
  ds_read_b128 a[164:167], v5 offset:29696
  v_mfma_f32_16x16x32_bf16 v[112:115], a[180:183], a[44:47], v[112:115]
  v_mfma_f32_16x16x32_bf16 v[116:119], a[184:187], a[40:43], v[116:119]
  ds_read_b128 a[168:171], v5 offset:30720
  v_mfma_f32_16x16x32_bf16 v[120:123], a[184:187], a[44:47], v[120:123]
  buffer_load_dwordx4 v8, s[16:19], s43 offen offset:2048 sc1 lds
  v_mfma_f32_16x16x32_bf16 v[124:127], a[188:191], a[40:43], v[124:127]
  ds_read_b128 a[172:175], v5 offset:31744
  s_add_u32 m0, s44, s53
  v_mfma_f32_16x16x32_bf16 v[128:131], a[188:191], a[44:47], v[128:131]
  s_waitcnt lgkmcnt(4)
  v_mfma_f32_16x16x32_bf16 v[132:135], a[144:147], a[40:43], v[132:135]
  ds_read_b128 a[176:179], v5 offset:32768
  v_mfma_f32_16x16x32_bf16 v[136:139], a[144:147], a[44:47], v[136:139]
  v_mfma_f32_16x16x32_bf16 v[140:143], a[148:151], a[40:43], v[140:143]
  ds_read_b128 a[180:183], v5 offset:33792
  v_mfma_f32_16x16x32_bf16 v[144:147], a[148:151], a[44:47], v[144:147]
  buffer_load_dwordx4 v9, s[16:19], s43 offen sc1 lds
  v_mfma_f32_16x16x32_bf16 v[148:151], a[152:155], a[40:43], v[148:151]
  ds_read_b128 a[184:187], v5 offset:34816
  v_mfma_f32_16x16x32_bf16 v[152:155], a[152:155], a[44:47], v[152:155]
  v_mfma_f32_16x16x32_bf16 v[84:87], a[156:159], a[48:51], v[84:87]
  ds_read_b128 a[188:191], v5 offset:35840
  v_mfma_f32_16x16x32_bf16 v[88:91], a[156:159], a[52:55], v[88:91]
  s_waitcnt lgkmcnt(4)
  v_mfma_f32_16x16x32_bf16 v[92:95], a[160:163], a[48:51], v[92:95]
  ds_read_b128 a[144:147], v6 offset:0
  v_mfma_f32_16x16x32_bf16 v[96:99], a[160:163], a[52:55], v[96:99]
  buffer_load_dwordx4 a[104:107], v81, s[12:15], s47 offen offset:2048 sc1
  v_mfma_f32_16x16x32_bf16 v[100:103], a[164:167], a[48:51], v[100:103]
  ds_read_b128 a[148:151], v6 offset:1024
  v_mfma_f32_16x16x32_bf16 v[104:107], a[164:167], a[52:55], v[104:107]
  v_mfma_f32_16x16x32_bf16 v[108:111], a[168:171], a[48:51], v[108:111]
  ds_read_b128 a[152:155], v6 offset:2048
  v_mfma_f32_16x16x32_bf16 v[112:115], a[168:171], a[52:55], v[112:115]
  buffer_load_dwordx4 v9, s[16:19], s43 offen offset:1024 sc1 lds
  v_mfma_f32_16x16x32_bf16 v[116:119], a[172:175], a[48:51], v[116:119]
  ds_read_b128 a[156:159], v6 offset:3072
  v_add_u32 v228, 1, v228
  v_mfma_f32_16x16x32_bf16 v[120:123], a[172:175], a[52:55], v[120:123]
  s_waitcnt vmcnt(14) lgkmcnt(4)
  v_mfma_f32_16x16x32_bf16 v[124:127], a[176:179], a[48:51], v[124:127]
  ds_read_b128 a[160:163], v6 offset:4096
  v_mfma_f32_16x16x32_bf16 v[128:131], a[176:179], a[52:55], v[128:131]
  ds_write_b32 v229, v228
  v_mfma_f32_16x16x32_bf16 v[132:135], a[180:183], a[48:51], v[132:135]
  ds_read_b128 a[164:167], v6 offset:5120
  v_mfma_f32_16x16x32_bf16 v[136:139], a[180:183], a[52:55], v[136:139]
  buffer_load_dwordx4 v9, s[16:19], s43 offen offset:2048 sc1 lds
  v_mfma_f32_16x16x32_bf16 v[140:143], a[184:187], a[48:51], v[140:143]
  ds_read_b128 a[168:171], v6 offset:6144
  s_add_u32 s43, s43, 36864
  v_mfma_f32_16x16x32_bf16 v[144:147], a[184:187], a[52:55], v[144:147]
  s_xor_b32 s44, s44, 73728
  v_mfma_f32_16x16x32_bf16 v[148:151], a[188:191], a[48:51], v[148:151]
  ds_read_b128 a[172:175], v6 offset:7168
  v_mfma_f32_16x16x32_bf16 v[152:155], a[188:191], a[52:55], v[152:155]
  s_waitcnt vmcnt(10) lgkmcnt(5)
  v_mfma_f32_16x16x32_bf16 v[84:87], a[144:147], v[192:195], v[84:87]
  ds_read_b128 a[176:179], v6 offset:8192
  v_cmp_gt_u32 vcc, 11, v72
  v_mfma_f32_16x16x32_bf16 v[88:91], a[144:147], v[196:199], v[88:91]
  ds_read_b32 v224, v230
  s_mov_b32 s47, 12288
  v_mfma_f32_16x16x32_bf16 v[92:95], a[148:151], v[192:195], v[92:95]
  ds_read_b128 a[180:183], v6 offset:9216
  s_cbranch_vccnz f23_spin
f23_back:
  v_mfma_f32_16x16x32_bf16 v[96:99], a[148:151], v[196:199], v[96:99]
  buffer_load_dwordx4 a[108:111], v81, s[12:15], s47 offen offset:3072 sc1
  v_mfma_f32_16x16x32_bf16 v[100:103], a[152:155], v[192:195], v[100:103]
  ds_read_b128 a[184:187], v6 offset:10240
  v_mfma_f32_16x16x32_bf16 v[104:107], a[152:155], v[196:199], v[104:107]
  v_mfma_f32_16x16x32_bf16 v[108:111], a[156:159], v[192:195], v[108:111]
  ds_read_b128 a[188:191], v6 offset:11264
  v_mfma_f32_16x16x32_bf16 v[112:115], a[156:159], v[196:199], v[112:115]
  s_waitcnt lgkmcnt(3)
  v_cmp_gt_u32 vcc, v228, v224
  v_mfma_f32_16x16x32_bf16 v[116:119], a[160:163], v[192:195], v[116:119]
  ds_read_b128 a[144:147], v6 offset:12288
  v_mfma_f32_16x16x32_bf16 v[120:123], a[160:163], v[196:199], v[120:123]
  buffer_load_dwordx4 a[112:115], v82, s[12:15], s47 offen offset:2048 sc1
  v_mfma_f32_16x16x32_bf16 v[124:127], a[164:167], v[192:195], v[124:127]
  ds_read_b128 a[148:151], v6 offset:13312
  s_cbranch_vccnz fs18_spin
fs18_back:
  v_mfma_f32_16x16x32_bf16 v[128:131], a[164:167], v[196:199], v[128:131]
  s_add_u32 m0, s44, s48
  v_mfma_f32_16x16x32_bf16 v[132:135], a[168:171], v[192:195], v[132:135]
  ds_read_b128 a[152:155], v6 offset:14336
  v_mfma_f32_16x16x32_bf16 v[136:139], a[168:171], v[196:199], v[136:139]
  buffer_load_dwordx4 v7, s[16:19], s43 offen sc1 lds
  v_mfma_f32_16x16x32_bf16 v[140:143], a[172:175], v[192:195], v[140:143]
  ds_read_b128 a[156:159], v6 offset:15360
  v_mfma_f32_16x16x32_bf16 v[144:147], a[172:175], v[196:199], v[144:147]
  s_waitcnt lgkmcnt(4)
  v_mfma_f32_16x16x32_bf16 v[148:151], a[176:179], v[192:195], v[148:151]
  ds_read_b128 a[160:163], v6 offset:16384
  v_mfma_f32_16x16x32_bf16 v[152:155], a[176:179], v[196:199], v[152:155]
  buffer_load_dwordx4 a[116:119], v82, s[12:15], s47 offen offset:3072 sc1
  v_mfma_f32_16x16x32_bf16 v[84:87], a[180:183], a[56:59], v[84:87]
  ds_read_b128 a[164:167], v6 offset:17408
  v_mfma_f32_16x16x32_bf16 v[88:91], a[180:183], a[60:63], v[88:91]
  v_mfma_f32_16x16x32_bf16 v[92:95], a[184:187], a[56:59], v[92:95]
  ds_read_b128 a[168:171], v6 offset:18432
  v_mfma_f32_16x16x32_bf16 v[96:99], a[184:187], a[60:63], v[96:99]
  buffer_load_dwordx4 v7, s[16:19], s43 offen offset:1024 sc1 lds
  v_mfma_f32_16x16x32_bf16 v[100:103], a[188:191], a[56:59], v[100:103]
  ds_read_b128 a[172:175], v6 offset:19456
  v_mfma_f32_16x16x32_bf16 v[104:107], a[188:191], a[60:63], v[104:107]
  s_waitcnt lgkmcnt(4)
  v_mfma_f32_16x16x32_bf16 v[108:111], a[144:147], a[56:59], v[108:111]
  ds_read_b128 a[176:179], v6 offset:20480
  v_mfma_f32_16x16x32_bf16 v[112:115], a[144:147], a[60:63], v[112:115]
  buffer_load_dwordx4 v7, s[16:19], s43 offen offset:2048 sc1 lds
  v_mfma_f32_16x16x32_bf16 v[116:119], a[148:151], a[56:59], v[116:119]
  ds_read_b128 a[180:183], v6 offset:21504
  s_add_u32 m0, s44, s49
  v_mfma_f32_16x16x32_bf16 v[120:123], a[148:151], a[60:63], v[120:123]
  v_mfma_f32_16x16x32_bf16 v[124:127], a[152:155], a[56:59], v[124:127]
  ds_read_b128 a[184:187], v6 offset:22528
  v_mfma_f32_16x16x32_bf16 v[128:131], a[152:155], a[60:63], v[128:131]
  buffer_load_dwordx4 v8, s[16:19], s43 offen sc1 lds
  v_mfma_f32_16x16x32_bf16 v[132:135], a[156:159], a[56:59], v[132:135]
  ds_read_b128 a[188:191], v6 offset:23552
  v_mfma_f32_16x16x32_bf16 v[136:139], a[156:159], a[60:63], v[136:139]
  s_waitcnt lgkmcnt(4)
  v_mfma_f32_16x16x32_bf16 v[140:143], a[160:163], a[56:59], v[140:143]
  ds_read_b128 a[144:147], v6 offset:24576
  v_mfma_f32_16x16x32_bf16 v[144:147], a[160:163], a[60:63], v[144:147]
  buffer_load_dwordx4 a[120:123], v83, s[12:15], s47 offen offset:2048 sc1
  v_mfma_f32_16x16x32_bf16 v[148:151], a[164:167], a[56:59], v[148:151]
  ds_read_b128 a[148:151], v6 offset:25600
  v_mfma_f32_16x16x32_bf16 v[152:155], a[164:167], a[60:63], v[152:155]
  v_mfma_f32_16x16x32_bf16 v[84:87], a[168:171], a[64:67], v[84:87]
  ds_read_b128 a[152:155], v6 offset:26624
  v_mfma_f32_16x16x32_bf16 v[88:91], a[168:171], a[68:71], v[88:91]
  v_mfma_f32_16x16x32_bf16 v[92:95], a[172:175], a[64:67], v[92:95]
  ds_read_b128 a[156:159], v6 offset:27648
  v_mfma_f32_16x16x32_bf16 v[96:99], a[172:175], a[68:71], v[96:99]
  s_waitcnt lgkmcnt(4)
  v_mfma_f32_16x16x32_bf16 v[100:103], a[176:179], a[64:67], v[100:103]
  ds_read_b128 a[160:163], v6 offset:28672
  v_xor_b32 v5, 73728, v5
  v_mfma_f32_16x16x32_bf16 v[104:107], a[176:179], a[68:71], v[104:107]
  buffer_load_dwordx4 v8, s[16:19], s43 offen offset:1024 sc1 lds
  v_mfma_f32_16x16x32_bf16 v[108:111], a[180:183], a[64:67], v[108:111]
  ds_read_b128 a[164:167], v6 offset:29696
  v_mfma_f32_16x16x32_bf16 v[112:115], a[180:183], a[68:71], v[112:115]
  v_mfma_f32_16x16x32_bf16 v[116:119], a[184:187], a[64:67], v[116:119]
  ds_read_b128 a[168:171], v6 offset:30720
  v_mfma_f32_16x16x32_bf16 v[120:123], a[184:187], a[68:71], v[120:123]
  buffer_load_dwordx4 v8, s[16:19], s43 offen offset:2048 sc1 lds
  v_mfma_f32_16x16x32_bf16 v[124:127], a[188:191], a[64:67], v[124:127]
  ds_read_b128 a[172:175], v6 offset:31744
  s_add_u32 m0, s44, s50
  v_mfma_f32_16x16x32_bf16 v[128:131], a[188:191], a[68:71], v[128:131]
  s_waitcnt lgkmcnt(4)
  v_mfma_f32_16x16x32_bf16 v[132:135], a[144:147], a[64:67], v[132:135]
  ds_read_b128 a[176:179], v6 offset:32768
  v_mfma_f32_16x16x32_bf16 v[136:139], a[144:147], a[68:71], v[136:139]
  v_mfma_f32_16x16x32_bf16 v[140:143], a[148:151], a[64:67], v[140:143]
  ds_read_b128 a[180:183], v6 offset:33792
  v_mfma_f32_16x16x32_bf16 v[144:147], a[148:151], a[68:71], v[144:147]
  buffer_load_dwordx4 v9, s[16:19], s43 offen sc1 lds
  v_mfma_f32_16x16x32_bf16 v[148:151], a[152:155], a[64:67], v[148:151]
  ds_read_b128 a[184:187], v6 offset:34816
  v_mfma_f32_16x16x32_bf16 v[152:155], a[152:155], a[68:71], v[152:155]
  v_mfma_f32_16x16x32_bf16 v[84:87], a[156:159], a[72:75], v[84:87]
  ds_read_b128 a[188:191], v6 offset:35840
  v_mfma_f32_16x16x32_bf16 v[88:91], a[156:159], a[76:79], v[88:91]
  s_waitcnt lgkmcnt(4)
  v_mfma_f32_16x16x32_bf16 v[92:95], a[160:163], a[72:75], v[92:95]
  ds_read_b128 a[144:147], v5 offset:0
  v_mfma_f32_16x16x32_bf16 v[96:99], a[160:163], a[76:79], v[96:99]
  buffer_load_dwordx4 a[124:127], v83, s[12:15], s47 offen offset:3072 sc1
  v_mfma_f32_16x16x32_bf16 v[100:103], a[164:167], a[72:75], v[100:103]
  ds_read_b128 a[148:151], v5 offset:1024
  v_mfma_f32_16x16x32_bf16 v[104:107], a[164:167], a[76:79], v[104:107]
  v_mfma_f32_16x16x32_bf16 v[108:111], a[168:171], a[72:75], v[108:111]
  ds_read_b128 a[152:155], v5 offset:2048
  v_mfma_f32_16x16x32_bf16 v[112:115], a[168:171], a[76:79], v[112:115]
  buffer_load_dwordx4 v9, s[16:19], s43 offen offset:1024 sc1 lds
  v_mfma_f32_16x16x32_bf16 v[116:119], a[172:175], a[72:75], v[116:119]
  ds_read_b128 a[156:159], v5 offset:3072
  v_add_u32 v228, 1, v228
  v_mfma_f32_16x16x32_bf16 v[120:123], a[172:175], a[76:79], v[120:123]
  s_waitcnt vmcnt(13) lgkmcnt(4)
  v_mfma_f32_16x16x32_bf16 v[124:127], a[176:179], a[72:75], v[124:127]
  ds_read_b128 a[160:163], v5 offset:4096
  v_mfma_f32_16x16x32_bf16 v[128:131], a[176:179], a[76:79], v[128:131]
  ds_write_b32 v229, v228
  v_mfma_f32_16x16x32_bf16 v[132:135], a[180:183], a[72:75], v[132:135]
  ds_read_b128 a[164:167], v5 offset:5120
  v_mfma_f32_16x16x32_bf16 v[136:139], a[180:183], a[76:79], v[136:139]
  buffer_load_dwordx4 v9, s[16:19], s43 offen offset:2048 sc1 lds
  v_mfma_f32_16x16x32_bf16 v[140:143], a[184:187], a[72:75], v[140:143]
  ds_read_b128 a[168:171], v5 offset:6144
  s_add_u32 s43, s43, 147456
  v_mfma_f32_16x16x32_bf16 v[144:147], a[184:187], a[76:79], v[144:147]
  v_mfma_f32_16x16x32_bf16 v[148:151], a[188:191], a[72:75], v[148:151]
  ds_read_b128 a[172:175], v5 offset:7168
  v_mfma_f32_16x16x32_bf16 v[152:155], a[188:191], a[76:79], v[152:155]
  s_waitcnt vmcnt(63) lgkmcnt(5)
  v_mfma_f32_16x16x32_bf16 v[84:87], a[144:147], v[200:203], v[84:87]
  ds_read_b128 a[176:179], v5 offset:8192
  s_mov_b32 s47, 16384
  v_mfma_f32_16x16x32_bf16 v[88:91], a[144:147], v[204:207], v[88:91]
  ds_read_b32 v224, v230
  v_mfma_f32_16x16x32_bf16 v[92:95], a[148:151], v[200:203], v[92:95]
  ds_read_b128 a[180:183], v5 offset:9216
  v_mfma_f32_16x16x32_bf16 v[96:99], a[148:151], v[204:207], v[96:99]
  buffer_load_dwordx4 a[192:195], v81, s[12:15], s47 offen sc1
  v_mfma_f32_16x16x32_bf16 v[100:103], a[152:155], v[200:203], v[100:103]
  ds_read_b128 a[184:187], v5 offset:10240
  v_mfma_f32_16x16x32_bf16 v[104:107], a[152:155], v[204:207], v[104:107]
  v_mfma_f32_16x16x32_bf16 v[108:111], a[156:159], v[200:203], v[108:111]
  ds_read_b128 a[188:191], v5 offset:11264
  v_mfma_f32_16x16x32_bf16 v[112:115], a[156:159], v[204:207], v[112:115]
  s_waitcnt lgkmcnt(3)
  v_cmp_gt_u32 vcc, v228, v224
  v_mfma_f32_16x16x32_bf16 v[116:119], a[160:163], v[200:203], v[116:119]
  ds_read_b128 a[144:147], v5 offset:12288
  v_mfma_f32_16x16x32_bf16 v[120:123], a[160:163], v[204:207], v[120:123]
  s_cbranch_vccnz fs19_spin
fs19_back:
  v_mfma_f32_16x16x32_bf16 v[124:127], a[164:167], v[200:203], v[124:127]
  ds_read_b128 a[148:151], v5 offset:13312
  v_mfma_f32_16x16x32_bf16 v[128:131], a[164:167], v[204:207], v[128:131]
  v_mfma_f32_16x16x32_bf16 v[132:135], a[168:171], v[200:203], v[132:135]
  ds_read_b128 a[152:155], v5 offset:14336
  v_mfma_f32_16x16x32_bf16 v[136:139], a[168:171], v[204:207], v[136:139]
  v_mfma_f32_16x16x32_bf16 v[140:143], a[172:175], v[200:203], v[140:143]
  ds_read_b128 a[156:159], v5 offset:15360
  v_mfma_f32_16x16x32_bf16 v[144:147], a[172:175], v[204:207], v[144:147]
  s_waitcnt lgkmcnt(4)
  v_mfma_f32_16x16x32_bf16 v[148:151], a[176:179], v[200:203], v[148:151]
  ds_read_b128 a[160:163], v5 offset:16384
  v_mfma_f32_16x16x32_bf16 v[152:155], a[176:179], v[204:207], v[152:155]
  buffer_load_dwordx4 a[196:199], v81, s[12:15], s47 offen offset:1024 sc1
  v_mfma_f32_16x16x32_bf16 v[84:87], a[180:183], a[80:83], v[84:87]
  ds_read_b128 a[164:167], v5 offset:17408
  v_mfma_f32_16x16x32_bf16 v[88:91], a[180:183], a[84:87], v[88:91]
  v_mfma_f32_16x16x32_bf16 v[92:95], a[184:187], a[80:83], v[92:95]
  ds_read_b128 a[168:171], v5 offset:18432
  v_mfma_f32_16x16x32_bf16 v[96:99], a[184:187], a[84:87], v[96:99]
  v_mfma_f32_16x16x32_bf16 v[100:103], a[188:191], a[80:83], v[100:103]
  ds_read_b128 a[172:175], v5 offset:19456
  v_mfma_f32_16x16x32_bf16 v[104:107], a[188:191], a[84:87], v[104:107]
  s_waitcnt lgkmcnt(4)
  v_mfma_f32_16x16x32_bf16 v[108:111], a[144:147], a[80:83], v[108:111]
  ds_read_b128 a[176:179], v5 offset:20480
  v_mfma_f32_16x16x32_bf16 v[112:115], a[144:147], a[84:87], v[112:115]
  v_mfma_f32_16x16x32_bf16 v[116:119], a[148:151], a[80:83], v[116:119]
  ds_read_b128 a[180:183], v5 offset:21504
  v_mfma_f32_16x16x32_bf16 v[120:123], a[148:151], a[84:87], v[120:123]
  v_mfma_f32_16x16x32_bf16 v[124:127], a[152:155], a[80:83], v[124:127]
  ds_read_b128 a[184:187], v5 offset:22528
  v_mfma_f32_16x16x32_bf16 v[128:131], a[152:155], a[84:87], v[128:131]
  buffer_load_dwordx4 a[200:203], v82, s[12:15], s47 offen sc1
  v_mfma_f32_16x16x32_bf16 v[132:135], a[156:159], a[80:83], v[132:135]
  ds_read_b128 a[188:191], v5 offset:23552
  v_mfma_f32_16x16x32_bf16 v[136:139], a[156:159], a[84:87], v[136:139]
  s_waitcnt lgkmcnt(4)
  v_mfma_f32_16x16x32_bf16 v[140:143], a[160:163], a[80:83], v[140:143]
  ds_read_b128 a[144:147], v5 offset:24576
  v_mfma_f32_16x16x32_bf16 v[144:147], a[160:163], a[84:87], v[144:147]
  v_mfma_f32_16x16x32_bf16 v[148:151], a[164:167], a[80:83], v[148:151]
  ds_read_b128 a[148:151], v5 offset:25600
  v_mfma_f32_16x16x32_bf16 v[152:155], a[164:167], a[84:87], v[152:155]
  v_mfma_f32_16x16x32_bf16 v[84:87], a[168:171], a[88:91], v[84:87]
  ds_read_b128 a[152:155], v5 offset:26624
  v_mfma_f32_16x16x32_bf16 v[88:91], a[168:171], a[92:95], v[88:91]
  v_mfma_f32_16x16x32_bf16 v[92:95], a[172:175], a[88:91], v[92:95]
  ds_read_b128 a[156:159], v5 offset:27648
  v_mfma_f32_16x16x32_bf16 v[96:99], a[172:175], a[92:95], v[96:99]
  s_waitcnt lgkmcnt(4)
  v_mfma_f32_16x16x32_bf16 v[100:103], a[176:179], a[88:91], v[100:103]
  ds_read_b128 a[160:163], v5 offset:28672
  v_xor_b32 v6, 73728, v6
  v_mfma_f32_16x16x32_bf16 v[104:107], a[176:179], a[92:95], v[104:107]
  buffer_load_dwordx4 a[204:207], v82, s[12:15], s47 offen offset:1024 sc1
  v_mfma_f32_16x16x32_bf16 v[108:111], a[180:183], a[88:91], v[108:111]
  ds_read_b128 a[164:167], v5 offset:29696
  v_mfma_f32_16x16x32_bf16 v[112:115], a[180:183], a[92:95], v[112:115]
  v_mfma_f32_16x16x32_bf16 v[116:119], a[184:187], a[88:91], v[116:119]
  ds_read_b128 a[168:171], v5 offset:30720
  v_mfma_f32_16x16x32_bf16 v[120:123], a[184:187], a[92:95], v[120:123]
  v_mfma_f32_16x16x32_bf16 v[124:127], a[188:191], a[88:91], v[124:127]
  ds_read_b128 a[172:175], v5 offset:31744
  v_mfma_f32_16x16x32_bf16 v[128:131], a[188:191], a[92:95], v[128:131]
  s_waitcnt lgkmcnt(4)
  v_mfma_f32_16x16x32_bf16 v[132:135], a[144:147], a[88:91], v[132:135]
  ds_read_b128 a[176:179], v5 offset:32768
  v_mfma_f32_16x16x32_bf16 v[136:139], a[144:147], a[92:95], v[136:139]
  v_mfma_f32_16x16x32_bf16 v[140:143], a[148:151], a[88:91], v[140:143]
  ds_read_b128 a[180:183], v5 offset:33792
  v_mfma_f32_16x16x32_bf16 v[144:147], a[148:151], a[92:95], v[144:147]
  v_mfma_f32_16x16x32_bf16 v[148:151], a[152:155], a[88:91], v[148:151]
  ds_read_b128 a[184:187], v5 offset:34816
  v_mfma_f32_16x16x32_bf16 v[152:155], a[152:155], a[92:95], v[152:155]
  buffer_load_dwordx4 a[208:211], v83, s[12:15], s47 offen sc1
  v_mfma_f32_16x16x32_bf16 v[84:87], a[156:159], a[96:99], v[84:87]
  ds_read_b128 a[188:191], v5 offset:35840
  v_mfma_f32_16x16x32_bf16 v[88:91], a[156:159], a[100:103], v[88:91]
  s_waitcnt lgkmcnt(4)
  v_mfma_f32_16x16x32_bf16 v[92:95], a[160:163], a[96:99], v[92:95]
  ds_read_b128 a[144:147], v6 offset:0
  v_mfma_f32_16x16x32_bf16 v[96:99], a[160:163], a[100:103], v[96:99]
  v_mfma_f32_16x16x32_bf16 v[100:103], a[164:167], a[96:99], v[100:103]
  ds_read_b128 a[148:151], v6 offset:1024
  v_mfma_f32_16x16x32_bf16 v[104:107], a[164:167], a[100:103], v[104:107]
  v_mfma_f32_16x16x32_bf16 v[108:111], a[168:171], a[96:99], v[108:111]
  ds_read_b128 a[152:155], v6 offset:2048
  v_mfma_f32_16x16x32_bf16 v[112:115], a[168:171], a[100:103], v[112:115]
  v_mfma_f32_16x16x32_bf16 v[116:119], a[172:175], a[96:99], v[116:119]
  ds_read_b128 a[156:159], v6 offset:3072
  v_add_u32 v228, 1, v228
  v_mfma_f32_16x16x32_bf16 v[120:123], a[172:175], a[100:103], v[120:123]
  s_waitcnt vmcnt(5) lgkmcnt(4)
  v_mfma_f32_16x16x32_bf16 v[124:127], a[176:179], a[96:99], v[124:127]
  ds_read_b128 a[160:163], v6 offset:4096
  v_mfma_f32_16x16x32_bf16 v[128:131], a[176:179], a[100:103], v[128:131]
  ds_write_b32 v229, v228
  v_mfma_f32_16x16x32_bf16 v[132:135], a[180:183], a[96:99], v[132:135]
  ds_read_b128 a[164:167], v6 offset:5120
  v_mfma_f32_16x16x32_bf16 v[136:139], a[180:183], a[100:103], v[136:139]
  buffer_load_dwordx4 a[212:215], v83, s[12:15], s47 offen offset:1024 sc1
  v_mfma_f32_16x16x32_bf16 v[140:143], a[184:187], a[96:99], v[140:143]
  ds_read_b128 a[168:171], v6 offset:6144
  v_mfma_f32_16x16x32_bf16 v[144:147], a[184:187], a[100:103], v[144:147]
  v_mfma_f32_16x16x32_bf16 v[148:151], a[188:191], a[96:99], v[148:151]
  ds_read_b128 a[172:175], v6 offset:7168
  v_mfma_f32_16x16x32_bf16 v[152:155], a[188:191], a[100:103], v[152:155]
  s_waitcnt vmcnt(63) lgkmcnt(5)
  v_mfma_f32_16x16x32_bf16 v[84:87], a[144:147], v[208:211], v[84:87]
  ds_read_b128 a[176:179], v6 offset:8192
  v_mfma_f32_16x16x32_bf16 v[88:91], a[144:147], v[212:215], v[88:91]
  ds_read_b32 v224, v230
  v_mfma_f32_16x16x32_bf16 v[92:95], a[148:151], v[208:211], v[92:95]
  ds_read_b128 a[180:183], v6 offset:9216
  v_mfma_f32_16x16x32_bf16 v[96:99], a[148:151], v[212:215], v[96:99]
  v_mfma_f32_16x16x32_bf16 v[100:103], a[152:155], v[208:211], v[100:103]
  ds_read_b128 a[184:187], v6 offset:10240
  v_mfma_f32_16x16x32_bf16 v[104:107], a[152:155], v[212:215], v[104:107]
  v_mfma_f32_16x16x32_bf16 v[108:111], a[156:159], v[208:211], v[108:111]
  ds_read_b128 a[188:191], v6 offset:11264
  v_mfma_f32_16x16x32_bf16 v[112:115], a[156:159], v[212:215], v[112:115]
  s_waitcnt lgkmcnt(3)
  v_cmp_gt_u32 vcc, v228, v224
  v_mfma_f32_16x16x32_bf16 v[116:119], a[160:163], v[208:211], v[116:119]
  ds_read_b128 a[144:147], v6 offset:12288
  v_mfma_f32_16x16x32_bf16 v[120:123], a[160:163], v[212:215], v[120:123]
  s_cbranch_vccnz fs20_spin
fs20_back:
  v_mfma_f32_16x16x32_bf16 v[124:127], a[164:167], v[208:211], v[124:127]
  ds_read_b128 a[148:151], v6 offset:13312
  v_mfma_f32_16x16x32_bf16 v[128:131], a[164:167], v[212:215], v[128:131]
  v_mfma_f32_16x16x32_bf16 v[132:135], a[168:171], v[208:211], v[132:135]
  ds_read_b128 a[152:155], v6 offset:14336
  v_mfma_f32_16x16x32_bf16 v[136:139], a[168:171], v[212:215], v[136:139]
  v_mfma_f32_16x16x32_bf16 v[140:143], a[172:175], v[208:211], v[140:143]
  ds_read_b128 a[156:159], v6 offset:15360
  v_mfma_f32_16x16x32_bf16 v[144:147], a[172:175], v[212:215], v[144:147]
  s_waitcnt lgkmcnt(4)
  v_mfma_f32_16x16x32_bf16 v[148:151], a[176:179], v[208:211], v[148:151]
  ds_read_b128 a[160:163], v6 offset:16384
  v_mfma_f32_16x16x32_bf16 v[152:155], a[176:179], v[212:215], v[152:155]
  v_mfma_f32_16x16x32_bf16 v[84:87], a[180:183], a[104:107], v[84:87]
  ds_read_b128 a[164:167], v6 offset:17408
  v_mfma_f32_16x16x32_bf16 v[88:91], a[180:183], a[108:111], v[88:91]
  v_mfma_f32_16x16x32_bf16 v[92:95], a[184:187], a[104:107], v[92:95]
  ds_read_b128 a[168:171], v6 offset:18432
  v_mfma_f32_16x16x32_bf16 v[96:99], a[184:187], a[108:111], v[96:99]
  v_mfma_f32_16x16x32_bf16 v[100:103], a[188:191], a[104:107], v[100:103]
  ds_read_b128 a[172:175], v6 offset:19456
  v_mfma_f32_16x16x32_bf16 v[104:107], a[188:191], a[108:111], v[104:107]
  s_waitcnt lgkmcnt(4)
  v_mfma_f32_16x16x32_bf16 v[108:111], a[144:147], a[104:107], v[108:111]
  ds_read_b128 a[176:179], v6 offset:20480
  v_mfma_f32_16x16x32_bf16 v[112:115], a[144:147], a[108:111], v[112:115]
  v_mfma_f32_16x16x32_bf16 v[116:119], a[148:151], a[104:107], v[116:119]
  ds_read_b128 a[180:183], v6 offset:21504
  v_mfma_f32_16x16x32_bf16 v[120:123], a[148:151], a[108:111], v[120:123]
  v_mfma_f32_16x16x32_bf16 v[124:127], a[152:155], a[104:107], v[124:127]
  ds_read_b128 a[184:187], v6 offset:22528
  v_mfma_f32_16x16x32_bf16 v[128:131], a[152:155], a[108:111], v[128:131]
  v_mfma_f32_16x16x32_bf16 v[132:135], a[156:159], a[104:107], v[132:135]
  ds_read_b128 a[188:191], v6 offset:23552
  v_mfma_f32_16x16x32_bf16 v[136:139], a[156:159], a[108:111], v[136:139]
  s_waitcnt lgkmcnt(4)
  v_mfma_f32_16x16x32_bf16 v[140:143], a[160:163], a[104:107], v[140:143]
  ds_read_b128 a[144:147], v6 offset:24576
  v_mfma_f32_16x16x32_bf16 v[144:147], a[160:163], a[108:111], v[144:147]
  v_mfma_f32_16x16x32_bf16 v[148:151], a[164:167], a[104:107], v[148:151]
  ds_read_b128 a[148:151], v6 offset:25600
  v_mfma_f32_16x16x32_bf16 v[152:155], a[164:167], a[108:111], v[152:155]
  v_mfma_f32_16x16x32_bf16 v[84:87], a[168:171], a[112:115], v[84:87]
  ds_read_b128 a[152:155], v6 offset:26624
  v_mfma_f32_16x16x32_bf16 v[88:91], a[168:171], a[116:119], v[88:91]
  v_mfma_f32_16x16x32_bf16 v[92:95], a[172:175], a[112:115], v[92:95]
  ds_read_b128 a[156:159], v6 offset:27648
  v_mfma_f32_16x16x32_bf16 v[96:99], a[172:175], a[116:119], v[96:99]
  s_waitcnt lgkmcnt(4)
  v_mfma_f32_16x16x32_bf16 v[100:103], a[176:179], a[112:115], v[100:103]
  ds_read_b128 a[160:163], v6 offset:28672
  v_xor_b32 v5, 73728, v5
  v_mfma_f32_16x16x32_bf16 v[104:107], a[176:179], a[116:119], v[104:107]
  v_mfma_f32_16x16x32_bf16 v[108:111], a[180:183], a[112:115], v[108:111]
  ds_read_b128 a[164:167], v6 offset:29696
  v_mfma_f32_16x16x32_bf16 v[112:115], a[180:183], a[116:119], v[112:115]
  v_mfma_f32_16x16x32_bf16 v[116:119], a[184:187], a[112:115], v[116:119]
  ds_read_b128 a[168:171], v6 offset:30720
  v_mfma_f32_16x16x32_bf16 v[120:123], a[184:187], a[116:119], v[120:123]
  v_mfma_f32_16x16x32_bf16 v[124:127], a[188:191], a[112:115], v[124:127]
  ds_read_b128 a[172:175], v6 offset:31744
  v_mfma_f32_16x16x32_bf16 v[128:131], a[188:191], a[116:119], v[128:131]
  s_waitcnt lgkmcnt(4)
  v_mfma_f32_16x16x32_bf16 v[132:135], a[144:147], a[112:115], v[132:135]
  ds_read_b128 a[176:179], v6 offset:32768
  v_mfma_f32_16x16x32_bf16 v[136:139], a[144:147], a[116:119], v[136:139]
  v_mfma_f32_16x16x32_bf16 v[140:143], a[148:151], a[112:115], v[140:143]
  ds_read_b128 a[180:183], v6 offset:33792
  v_mfma_f32_16x16x32_bf16 v[144:147], a[148:151], a[116:119], v[144:147]
  v_mfma_f32_16x16x32_bf16 v[148:151], a[152:155], a[112:115], v[148:151]
  ds_read_b128 a[184:187], v6 offset:34816
  v_mfma_f32_16x16x32_bf16 v[152:155], a[152:155], a[116:119], v[152:155]
  v_mfma_f32_16x16x32_bf16 v[84:87], a[156:159], a[120:123], v[84:87]
  ds_read_b128 a[188:191], v6 offset:35840
  v_mfma_f32_16x16x32_bf16 v[88:91], a[156:159], a[124:127], v[88:91]
  s_waitcnt lgkmcnt(4)
  v_mfma_f32_16x16x32_bf16 v[92:95], a[160:163], a[120:123], v[92:95]
  ds_read_b128 a[144:147], v5 offset:0
  v_mfma_f32_16x16x32_bf16 v[96:99], a[160:163], a[124:127], v[96:99]
  v_mfma_f32_16x16x32_bf16 v[100:103], a[164:167], a[120:123], v[100:103]
  ds_read_b128 a[148:151], v5 offset:9216
  v_mfma_f32_16x16x32_bf16 v[104:107], a[164:167], a[124:127], v[104:107]
  v_mfma_f32_16x16x32_bf16 v[108:111], a[168:171], a[120:123], v[108:111]
  ds_read_b128 a[152:155], v5 offset:18432
  v_mfma_f32_16x16x32_bf16 v[112:115], a[168:171], a[124:127], v[112:115]
  v_mfma_f32_16x16x32_bf16 v[116:119], a[172:175], a[120:123], v[116:119]
  ds_read_b128 a[156:159], v5 offset:27648
  v_mfma_f32_16x16x32_bf16 v[120:123], a[172:175], a[124:127], v[120:123]
  s_waitcnt lgkmcnt(4)
  v_mfma_f32_16x16x32_bf16 v[124:127], a[176:179], a[120:123], v[124:127]
  ds_read_b128 a[160:163], v5 offset:3072
  v_mfma_f32_16x16x32_bf16 v[128:131], a[176:179], a[124:127], v[128:131]
  v_mfma_f32_16x16x32_bf16 v[132:135], a[180:183], a[120:123], v[132:135]
  ds_read_b128 a[164:167], v5 offset:12288
  v_mfma_f32_16x16x32_bf16 v[136:139], a[180:183], a[124:127], v[136:139]
  v_mfma_f32_16x16x32_bf16 v[140:143], a[184:187], a[120:123], v[140:143]
  ds_read_b128 a[168:171], v5 offset:21504
  v_mfma_f32_16x16x32_bf16 v[144:147], a[184:187], a[124:127], v[144:147]
  v_mfma_f32_16x16x32_bf16 v[148:151], a[188:191], a[120:123], v[148:151]
  ds_read_b128 a[172:175], v5 offset:30720
  v_mfma_f32_16x16x32_bf16 v[152:155], a[188:191], a[124:127], v[152:155]
  s_waitcnt vmcnt(0) lgkmcnt(4)
  v_mfma_f32_16x16x32_bf16 v[84:87], a[144:147], v[216:219], v[84:87]
  ds_read_b128 a[176:179], v5 offset:6144
  v_mfma_f32_16x16x32_bf16 v[88:91], a[144:147], v[220:223], v[88:91]
  v_mfma_f32_16x16x32_bf16 v[84:87], a[148:151], a[192:195], v[84:87]
  ds_read_b128 a[180:183], v5 offset:15360
  v_mfma_f32_16x16x32_bf16 v[88:91], a[148:151], a[196:199], v[88:91]
  v_mfma_f32_16x16x32_bf16 v[84:87], a[152:155], a[200:203], v[84:87]
  ds_read_b128 a[184:187], v5 offset:24576
  v_mfma_f32_16x16x32_bf16 v[88:91], a[152:155], a[204:207], v[88:91]
  v_mfma_f32_16x16x32_bf16 v[84:87], a[156:159], a[208:211], v[84:87]
  ds_read_b128 a[188:191], v5 offset:33792
  v_mfma_f32_16x16x32_bf16 v[88:91], a[156:159], a[212:215], v[88:91]
  s_waitcnt lgkmcnt(4)
  v_mfma_f32_16x16x32_bf16 v[108:111], a[160:163], v[216:219], v[108:111]
  ds_read_b128 a[144:147], v5 offset:1024
  v_mfma_f32_16x16x32_bf16 v[112:115], a[160:163], v[220:223], v[112:115]
  v_mfma_f32_16x16x32_bf16 v[108:111], a[164:167], a[192:195], v[108:111]
  ds_read_b128 a[148:151], v5 offset:10240
  v_mfma_f32_16x16x32_bf16 v[112:115], a[164:167], a[196:199], v[112:115]
  v_mfma_f32_16x16x32_bf16 v[108:111], a[168:171], a[200:203], v[108:111]
  ds_read_b128 a[152:155], v5 offset:19456
  v_cvt_pk_bf16_f32 v16, v84, v85
  v_mfma_f32_16x16x32_bf16 v[112:115], a[168:171], a[204:207], v[112:115]
  v_cvt_pk_bf16_f32 v17, v86, v87
  v_cvt_pk_bf16_f32 v18, v88, v89
  v_mfma_f32_16x16x32_bf16 v[108:111], a[172:175], a[208:211], v[108:111]
  ds_read_b128 a[156:159], v5 offset:28672
  v_cvt_pk_bf16_f32 v19, v90, v91
  v_mfma_f32_16x16x32_bf16 v[112:115], a[172:175], a[212:215], v[112:115]
  s_waitcnt lgkmcnt(4)
  v_permlane16_swap_b32 v16, v18
  v_permlane16_swap_b32 v17, v19
  v_mfma_f32_16x16x32_bf16 v[132:135], a[176:179], v[216:219], v[132:135]
  ds_read_b128 a[160:163], v5 offset:4096
  v_mfma_f32_16x16x32_bf16 v[136:139], a[176:179], v[220:223], v[136:139]
  buffer_store_dwordx4 v[16:19], v156, s[12:15], s34 offen offset:0 sc1
  v_mfma_f32_16x16x32_bf16 v[132:135], a[180:183], a[192:195], v[132:135]
  ds_read_b128 a[164:167], v5 offset:13312
  v_mfma_f32_16x16x32_bf16 v[136:139], a[180:183], a[196:199], v[136:139]
  v_mfma_f32_16x16x32_bf16 v[132:135], a[184:187], a[200:203], v[132:135]
  ds_read_b128 a[168:171], v5 offset:22528
  v_cvt_pk_bf16_f32 v28, v108, v109
  v_mfma_f32_16x16x32_bf16 v[136:139], a[184:187], a[204:207], v[136:139]
  v_cvt_pk_bf16_f32 v29, v110, v111
  v_cvt_pk_bf16_f32 v30, v112, v113
  v_mfma_f32_16x16x32_bf16 v[132:135], a[188:191], a[208:211], v[132:135]
  ds_read_b128 a[172:175], v5 offset:31744
  v_cvt_pk_bf16_f32 v31, v114, v115
  v_mfma_f32_16x16x32_bf16 v[136:139], a[188:191], a[212:215], v[136:139]
  s_waitcnt lgkmcnt(4)
  v_permlane16_swap_b32 v28, v30
  v_permlane16_swap_b32 v29, v31
  v_mfma_f32_16x16x32_bf16 v[92:95], a[144:147], v[216:219], v[92:95]
  ds_read_b128 a[176:179], v5 offset:7168
  v_mfma_f32_16x16x32_bf16 v[96:99], a[144:147], v[220:223], v[96:99]
  buffer_store_dwordx4 v[28:31], v156, s[12:15], s34 offen offset:1536 sc1
  v_mfma_f32_16x16x32_bf16 v[92:95], a[148:151], a[192:195], v[92:95]
  ds_read_b128 a[180:183], v5 offset:16384
  v_mfma_f32_16x16x32_bf16 v[96:99], a[148:151], a[196:199], v[96:99]
  v_mfma_f32_16x16x32_bf16 v[92:95], a[152:155], a[200:203], v[92:95]
  ds_read_b128 a[184:187], v5 offset:25600
  v_cvt_pk_bf16_f32 v40, v132, v133
  v_mfma_f32_16x16x32_bf16 v[96:99], a[152:155], a[204:207], v[96:99]
  v_cvt_pk_bf16_f32 v41, v134, v135
  v_cvt_pk_bf16_f32 v42, v136, v137
  v_mfma_f32_16x16x32_bf16 v[92:95], a[156:159], a[208:211], v[92:95]
  ds_read_b128 a[188:191], v5 offset:34816
  v_cvt_pk_bf16_f32 v43, v138, v139
  v_mfma_f32_16x16x32_bf16 v[96:99], a[156:159], a[212:215], v[96:99]
  s_waitcnt lgkmcnt(4)
  v_permlane16_swap_b32 v40, v42
  v_permlane16_swap_b32 v41, v43
  v_mfma_f32_16x16x32_bf16 v[116:119], a[160:163], v[216:219], v[116:119]
  ds_read_b128 a[144:147], v5 offset:2048
  v_mfma_f32_16x16x32_bf16 v[120:123], a[160:163], v[220:223], v[120:123]
  buffer_store_dwordx4 v[40:43], v156, s[12:15], s34 offen offset:3072 sc1
  v_mfma_f32_16x16x32_bf16 v[116:119], a[164:167], a[192:195], v[116:119]
  ds_read_b128 a[148:151], v5 offset:11264
  v_mfma_f32_16x16x32_bf16 v[120:123], a[164:167], a[196:199], v[120:123]
  v_mfma_f32_16x16x32_bf16 v[116:119], a[168:171], a[200:203], v[116:119]
  ds_read_b128 a[152:155], v5 offset:20480
  v_cvt_pk_bf16_f32 v20, v92, v93
  v_mfma_f32_16x16x32_bf16 v[120:123], a[168:171], a[204:207], v[120:123]
  v_cvt_pk_bf16_f32 v21, v94, v95
  v_cvt_pk_bf16_f32 v22, v96, v97
  v_mfma_f32_16x16x32_bf16 v[116:119], a[172:175], a[208:211], v[116:119]
  ds_read_b128 a[156:159], v5 offset:29696
  v_cvt_pk_bf16_f32 v23, v98, v99
  v_mfma_f32_16x16x32_bf16 v[120:123], a[172:175], a[212:215], v[120:123]
  s_waitcnt lgkmcnt(4)
  v_permlane16_swap_b32 v20, v22
  v_permlane16_swap_b32 v21, v23
  v_mfma_f32_16x16x32_bf16 v[140:143], a[176:179], v[216:219], v[140:143]
  ds_read_b128 a[160:163], v5 offset:5120
  v_mfma_f32_16x16x32_bf16 v[144:147], a[176:179], v[220:223], v[144:147]
  buffer_store_dwordx4 v[20:23], v156, s[12:15], s34 offen offset:512 sc1
  v_mfma_f32_16x16x32_bf16 v[140:143], a[180:183], a[192:195], v[140:143]
  ds_read_b128 a[164:167], v5 offset:14336
  v_mfma_f32_16x16x32_bf16 v[144:147], a[180:183], a[196:199], v[144:147]
  v_mfma_f32_16x16x32_bf16 v[140:143], a[184:187], a[200:203], v[140:143]
  ds_read_b128 a[168:171], v5 offset:23552
  v_cvt_pk_bf16_f32 v32, v116, v117
  v_mfma_f32_16x16x32_bf16 v[144:147], a[184:187], a[204:207], v[144:147]
  v_cvt_pk_bf16_f32 v33, v118, v119
  v_cvt_pk_bf16_f32 v34, v120, v121
  v_mfma_f32_16x16x32_bf16 v[140:143], a[188:191], a[208:211], v[140:143]
  ds_read_b128 a[172:175], v5 offset:32768
  v_cvt_pk_bf16_f32 v35, v122, v123
  v_mfma_f32_16x16x32_bf16 v[144:147], a[188:191], a[212:215], v[144:147]
  s_waitcnt lgkmcnt(4)
  v_permlane16_swap_b32 v32, v34
  v_permlane16_swap_b32 v33, v35
  v_mfma_f32_16x16x32_bf16 v[100:103], a[144:147], v[216:219], v[100:103]
  ds_read_b128 a[176:179], v5 offset:8192
  v_mfma_f32_16x16x32_bf16 v[104:107], a[144:147], v[220:223], v[104:107]
  buffer_store_dwordx4 v[32:35], v156, s[12:15], s34 offen offset:2048 sc1
  v_mfma_f32_16x16x32_bf16 v[100:103], a[148:151], a[192:195], v[100:103]
  ds_read_b128 a[180:183], v5 offset:17408
  v_mfma_f32_16x16x32_bf16 v[104:107], a[148:151], a[196:199], v[104:107]
  v_mfma_f32_16x16x32_bf16 v[100:103], a[152:155], a[200:203], v[100:103]
  ds_read_b128 a[184:187], v5 offset:26624
  v_cvt_pk_bf16_f32 v44, v140, v141
  v_mfma_f32_16x16x32_bf16 v[104:107], a[152:155], a[204:207], v[104:107]
  v_cvt_pk_bf16_f32 v45, v142, v143
  v_cvt_pk_bf16_f32 v46, v144, v145
  v_mfma_f32_16x16x32_bf16 v[100:103], a[156:159], a[208:211], v[100:103]
  ds_read_b128 a[188:191], v5 offset:35840
  v_cvt_pk_bf16_f32 v47, v146, v147
  v_mfma_f32_16x16x32_bf16 v[104:107], a[156:159], a[212:215], v[104:107]
  s_waitcnt lgkmcnt(4)
  v_permlane16_swap_b32 v44, v46
  v_permlane16_swap_b32 v45, v47
  v_mfma_f32_16x16x32_bf16 v[124:127], a[160:163], v[216:219], v[124:127]
  v_mfma_f32_16x16x32_bf16 v[128:131], a[160:163], v[220:223], v[128:131]
  buffer_store_dwordx4 v[44:47], v156, s[12:15], s34 offen offset:3584 sc1
  v_mfma_f32_16x16x32_bf16 v[124:127], a[164:167], a[192:195], v[124:127]
  v_mfma_f32_16x16x32_bf16 v[128:131], a[164:167], a[196:199], v[128:131]
  v_mfma_f32_16x16x32_bf16 v[124:127], a[168:171], a[200:203], v[124:127]
  v_cvt_pk_bf16_f32 v24, v100, v101
  v_cvt_pk_bf16_f32 v25, v102, v103
  v_mfma_f32_16x16x32_bf16 v[128:131], a[168:171], a[204:207], v[128:131]
  v_cvt_pk_bf16_f32 v26, v104, v105
  v_cvt_pk_bf16_f32 v27, v106, v107
  v_mfma_f32_16x16x32_bf16 v[124:127], a[172:175], a[208:211], v[124:127]
  v_permlane16_swap_b32 v24, v26
  v_permlane16_swap_b32 v25, v27
  v_mfma_f32_16x16x32_bf16 v[128:131], a[172:175], a[212:215], v[128:131]
  s_waitcnt lgkmcnt(0)
  v_mfma_f32_16x16x32_bf16 v[148:151], a[176:179], v[216:219], v[148:151]
  v_mfma_f32_16x16x32_bf16 v[152:155], a[176:179], v[220:223], v[152:155]
  v_mfma_f32_16x16x32_bf16 v[148:151], a[180:183], a[192:195], v[148:151]
  buffer_store_dwordx4 v[24:27], v156, s[12:15], s34 offen offset:1024 sc1
  v_mfma_f32_16x16x32_bf16 v[152:155], a[180:183], a[196:199], v[152:155]
  v_mfma_f32_16x16x32_bf16 v[148:151], a[184:187], a[200:203], v[148:151]
  v_mfma_f32_16x16x32_bf16 v[152:155], a[184:187], a[204:207], v[152:155]
  v_mfma_f32_16x16x32_bf16 v[148:151], a[188:191], a[208:211], v[148:151]
  v_mfma_f32_16x16x32_bf16 v[152:155], a[188:191], a[212:215], v[152:155]
  v_cvt_pk_bf16_f32 v36, v124, v125
  v_cvt_pk_bf16_f32 v37, v126, v127
  v_cvt_pk_bf16_f32 v38, v128, v129
  v_cvt_pk_bf16_f32 v39, v130, v131
  s_nop 0
  v_permlane16_swap_b32 v36, v38
  v_permlane16_swap_b32 v37, v39
  buffer_store_dwordx4 v[36:39], v156, s[12:15], s34 offen offset:2560 sc1
  v_cvt_pk_bf16_f32 v48, v148, v149
  v_cvt_pk_bf16_f32 v49, v150, v151
  v_cvt_pk_bf16_f32 v50, v152, v153
  v_cvt_pk_bf16_f32 v51, v154, v155
  s_nop 0
  v_permlane16_swap_b32 v48, v50
  v_permlane16_swap_b32 v49, v51
  buffer_store_dwordx4 v[48:51], v156, s[12:15], s35 offen offset:0 sc1
  s_cmp_lg_u32 s36, s33
  s_cbranch_scc1 f_nokeep
  ds_write_b128 v157, v[16:19] offset:0
  ds_write_b128 v157, v[20:23] offset:1024
  ds_write_b128 v157, v[24:27] offset:2048
  ds_write_b128 v157, v[28:31] offset:3072
  ds_write_b128 v157, v[32:35] offset:4096
  ds_write_b128 v157, v[36:39] offset:5120
  ds_write_b128 v157, v[40:43] offset:6144
  ds_write_b128 v157, v[44:47] offset:7168
  ds_write_b128 v157, v[48:51] offset:8192
f_nokeep:
  s_mul_i32 s35, s33, 3072
  s_add_u32 s35, s35, 147456
  v_add_u32 v6, s35, v1
  s_waitcnt lgkmcnt(0)
  s_barrier
  ds_read_b128 v[96:99], v6 offset:0
  ds_read_b128 v[100:103], v6 offset:1024
  ds_read_b128 v[104:107], v6 offset:2048
  v_and_b32 v13, 15, v0
  v_lshlrev_b32 v13, 4, v13
  v_bfe_u32 v14, v0, 4, 1
  v_lshl_add_u32 v13, v14, 3, v13
  v_bfe_u32 v14, v0, 5, 1
  v_lshl_add_u32 v13, v14, 2, v13
  s_and_b32 s59, s25, 3
  s_mul_i32 s59, s59, 3
  s_add_u32 s59, s59, s33
  s_lshl_b32 s59, s59, 8
  s_mul_i32 s38, s29, 3072
  s_add_u32 s59, s59, s38
  s_and_b32 s34, s25, 3
  s_mul_i32 s34, s34, 3
  s_add_u32 s34, s34, s33
  s_mul_i32 s34, s34, 1536
  s_mul_i32 s35, s29, 36864
  s_add_u32 s34, s34, s35
  s_add_u32 s35, s34, s26
  s_add_u32 s35, s35, 7077888
  s_add_u32 s38, s36, 1
  s_and_b32 s38, s38, 3
  s_mul_i32 s38, s38, 2359296
  s_add_u32 s40, s38, s35
  s_add_u32 s38, s36, 2
  s_and_b32 s38, s38, 3
  s_mul_i32 s38, s38, 2359296
  s_add_u32 s41, s38, s35
  s_add_u32 s38, s36, 3
  s_and_b32 s38, s38, 3
  s_mul_i32 s38, s38, 2359296
  s_add_u32 s42, s38, s35
  s_waitcnt vmcnt(3)
  s_mov_b64 exec, 1
  buffer_atomic_add v3, v2, s[12:15], s37 offen offset:0 sc1
  s_mov_b64 exec, -1
  s_mov_b32 s20, s12
  s_mov_b32 s21, s13
  s_mov_b32 s22, 2359296
  s_mov_b32 s23, 0x20000
  v_mov_b32 v10, v156
  s_cmp_eq_u32 s26, 0
  s_cbranch_scc1 r_mid
  v_and_b32 v10, 31, v0
  v_mul_u32_u24 v10, 1152, v10
  v_bfe_u32 v11, v0, 5, 1
  v_lshl_add_u32 v10, v11, 4, v10
  s_and_b32 s34, s25, 3
  s_mul_i32 s34, s34, 3
  s_add_u32 s34, s34, s33
  s_mul_i32 s34, s34, 96
  s_mul_i32 s35, s29, 36864
  s_add_u32 s34, s34, s35
  s_mov_b32 s20, s6
  s_mov_b32 s21, s7
r_mid:
  s_lshl_b32 s39, s24, 4
  s_add_u32 s39, s39, s25
  s_lshl_b32 s39, s39, 2
  s_add_u32 s45, s39, 1
  s_lshl_b32 s60, s39, 7
  s_add_u32 s60, s60, s27
  s_add_u32 s60, s60, 65536
  s_mov_b32 s61, 0x40000
  v_and_b32 v12, 1, v0
  v_lshlrev_b32 v12, 7, v12
  v_mov_b32 v8, 0
  v_mov_b32 v9, 0
  v_mov_b32 v14, 0
  v_mov_b32 v15, 0
  s_waitcnt lgkmcnt(0)
  v_dot2_f32_bf16 v232, v96, s30, v232
  v_dot2_f32_bf16 v233, v96, s31, v233
  v_dot2_f32_bf16 v234, v97, s30, v234
  v_dot2_f32_bf16 v235, v97, s31, v235
  v_dot2_f32_bf16 v236, v98, s30, v236
  v_dot2_f32_bf16 v237, v98, s31, v237
  v_dot2_f32_bf16 v238, v99, s30, v238
  v_dot2_f32_bf16 v239, v99, s31, v239
  v_dot2_f32_bf16 v240, v100, s30, v240
  v_dot2_f32_bf16 v241, v100, s31, v241
  v_dot2_f32_bf16 v242, v101, s30, v242
  v_dot2_f32_bf16 v243, v101, s31, v243
  v_dot2_f32_bf16 v244, v102, s30, v244
  v_dot2_f32_bf16 v245, v102, s31, v245
  v_dot2_f32_bf16 v246, v103, s30, v246
  v_dot2_f32_bf16 v247, v103, s31, v247
  v_dot2_f32_bf16 v248, v104, s30, v248
  v_dot2_f32_bf16 v249, v104, s31, v249
  v_dot2_f32_bf16 v250, v105, s30, v250
  v_dot2_f32_bf16 v251, v105, s31, v251
  v_dot2_f32_bf16 v252, v106, s30, v252
  v_dot2_f32_bf16 v253, v106, s31, v253
  v_dot2_f32_bf16 v254, v107, s30, v254
  v_dot2_f32_bf16 v255, v107, s31, v255
  s_waitcnt vmcnt(1)
  s_mov_b64 exec, 1
  buffer_atomic_add v3, v2, s[12:15], s37 offen offset:128 sc1
  s_mov_b64 exec, -1
  s_cmp_eq_u32 s33, 3
  s_cbranch_scc1 r_wq
r_poll:
  buffer_load_dword v4, v12, s[12:15], s60 offen sc1
  s_sub_u32 s61, s61, 1
  s_waitcnt vmcnt(0)
  v_cmp_gt_u32 vcc, 3, v4
  s_cbranch_scc1 r_ok
  s_bitcmp1_b32 vcc_lo, 0
  s_cbranch_scc1 r_poll
r_ok:
  buffer_load_dwordx4 v[108:111], v156, s[12:15], s40 offen offset:0 sc1
  buffer_load_dwordx4 v[120:123], v156, s[12:15], s41 offen offset:0 sc1
  buffer_load_dwordx4 v[132:135], v156, s[12:15], s42 offen offset:0 sc1
  buffer_load_dwordx4 v[112:115], v156, s[12:15], s40 offen offset:512 sc1
  buffer_load_dwordx4 v[124:127], v156, s[12:15], s41 offen offset:512 sc1
  buffer_load_dwordx4 v[136:139], v156, s[12:15], s42 offen offset:512 sc1
  s_cbranch_vccz r2_ok
  s_lshl_b32 s60, s45, 7
  s_add_u32 s60, s60, s27
  s_add_u32 s60, s60, 65536
  s_mov_b32 s61, 0x40000
r2_poll:
  buffer_load_dword v4, v2, s[12:15], s60 offen sc1
  s_sub_u32 s61, s61, 1
  s_waitcnt vmcnt(0)
  v_cmp_gt_u32 vcc, 3, v4
  s_cbranch_scc1 r2_ok
  s_cbranch_vccnz r2_poll
r2_ok:
  buffer_load_dwordx4 v[116:119], v156, s[12:15], s40 offen offset:1024 sc1
  buffer_load_dwordx4 v[128:131], v156, s[12:15], s41 offen offset:1024 sc1
  buffer_load_dwordx4 v[140:143], v156, s[12:15], s42 offen offset:1024 sc1
  s_add_u32 s38, s59, 40566784
  s_cmp_lg_u32 s26, 0
  s_waitcnt vmcnt(8)
  v_dot2_f32_bf16 v232, v108, s30, v232
  v_dot2_f32_bf16 v233, v108, s31, v233
  v_dot2_f32_bf16 v234, v109, s30, v234
  v_dot2_f32_bf16 v235, v109, s31, v235
  v_dot2_f32_bf16 v236, v110, s30, v236
  v_dot2_f32_bf16 v237, v110, s31, v237
  v_dot2_f32_bf16 v238, v111, s30, v238
  v_dot2_f32_bf16 v239, v111, s31, v239
  s_waitcnt vmcnt(7)
  v_dot2_f32_bf16 v232, v120, s30, v232
  v_dot2_f32_bf16 v233, v120, s31, v233
  v_dot2_f32_bf16 v234, v121, s30, v234
  v_dot2_f32_bf16 v235, v121, s31, v235
  v_dot2_f32_bf16 v236, v122, s30, v236
  v_dot2_f32_bf16 v237, v122, s31, v237
  v_dot2_f32_bf16 v238, v123, s30, v238
  v_dot2_f32_bf16 v239, v123, s31, v239
  s_waitcnt vmcnt(6)
  v_dot2_f32_bf16 v232, v132, s30, v232
  v_dot2_f32_bf16 v233, v132, s31, v233
  v_dot2_f32_bf16 v234, v133, s30, v234
  v_dot2_f32_bf16 v235, v133, s31, v235
  v_dot2_f32_bf16 v236, v134, s30, v236
  v_dot2_f32_bf16 v237, v134, s31, v237
  v_dot2_f32_bf16 v238, v135, s30, v238
  v_dot2_f32_bf16 v239, v135, s31, v239
  v_cvt_pk_bf16_f32 v80, v232, v233
  v_cvt_pk_bf16_f32 v81, v234, v235
  v_cvt_pk_bf16_f32 v82, v236, v237
  v_cvt_pk_bf16_f32 v83, v238, v239
  s_cbranch_scc1 r_out0
  buffer_store_dwordx4 v[80:83], v10, s[20:23], s34 offen offset:0 sc1
  v_pk_add_f32 v[8:9], v[8:9], v[232:233]
  v_pk_fma_f32 v[14:15], v[232:233], v[232:233], v[14:15]
  v_pk_add_f32 v[8:9], v[8:9], v[234:235]
  v_pk_fma_f32 v[14:15], v[234:235], v[234:235], v[14:15]
  v_pk_add_f32 v[8:9], v[8:9], v[236:237]
  v_pk_fma_f32 v[14:15], v[236:237], v[236:237], v[14:15]
  v_pk_add_f32 v[8:9], v[8:9], v[238:239]
  v_pk_fma_f32 v[14:15], v[238:239], v[238:239], v[14:15]
r_back0:
  s_waitcnt vmcnt(6)
  v_dot2_f32_bf16 v240, v112, s30, v240
  v_dot2_f32_bf16 v241, v112, s31, v241
  v_dot2_f32_bf16 v242, v113, s30, v242
  v_dot2_f32_bf16 v243, v113, s31, v243
  v_dot2_f32_bf16 v244, v114, s30, v244
  v_dot2_f32_bf16 v245, v114, s31, v245
  v_dot2_f32_bf16 v246, v115, s30, v246
  v_dot2_f32_bf16 v247, v115, s31, v247
  s_waitcnt vmcnt(5)
  v_dot2_f32_bf16 v240, v124, s30, v240
  v_dot2_f32_bf16 v241, v124, s31, v241
  v_dot2_f32_bf16 v242, v125, s30, v242
  v_dot2_f32_bf16 v243, v125, s31, v243
  v_dot2_f32_bf16 v244, v126, s30, v244
  v_dot2_f32_bf16 v245, v126, s31, v245
  v_dot2_f32_bf16 v246, v127, s30, v246
  v_dot2_f32_bf16 v247, v127, s31, v247
  s_waitcnt vmcnt(4)
  v_dot2_f32_bf16 v240, v136, s30, v240
  v_dot2_f32_bf16 v241, v136, s31, v241
  v_dot2_f32_bf16 v242, v137, s30, v242
  v_dot2_f32_bf16 v243, v137, s31, v243
  v_dot2_f32_bf16 v244, v138, s30, v244
  v_dot2_f32_bf16 v245, v138, s31, v245
  v_dot2_f32_bf16 v246, v139, s30, v246
  v_dot2_f32_bf16 v247, v139, s31, v247
  v_cvt_pk_bf16_f32 v84, v240, v241
  v_cvt_pk_bf16_f32 v85, v242, v243
  v_cvt_pk_bf16_f32 v86, v244, v245
  v_cvt_pk_bf16_f32 v87, v246, v247
  s_cbranch_scc1 r_out1
  buffer_store_dwordx4 v[84:87], v10, s[20:23], s34 offen offset:512 sc1
  v_pk_add_f32 v[8:9], v[8:9], v[240:241]
  v_pk_fma_f32 v[14:15], v[240:241], v[240:241], v[14:15]
  v_pk_add_f32 v[8:9], v[8:9], v[242:243]
  v_pk_fma_f32 v[14:15], v[242:243], v[242:243], v[14:15]
  v_pk_add_f32 v[8:9], v[8:9], v[244:245]
  v_pk_fma_f32 v[14:15], v[244:245], v[244:245], v[14:15]
  v_pk_add_f32 v[8:9], v[8:9], v[246:247]
  v_pk_fma_f32 v[14:15], v[246:247], v[246:247], v[14:15]
r_back1:
  s_waitcnt vmcnt(4)
  v_dot2_f32_bf16 v248, v116, s30, v248
  v_dot2_f32_bf16 v249, v116, s31, v249
  v_dot2_f32_bf16 v250, v117, s30, v250
  v_dot2_f32_bf16 v251, v117, s31, v251
  v_dot2_f32_bf16 v252, v118, s30, v252
  v_dot2_f32_bf16 v253, v118, s31, v253
  v_dot2_f32_bf16 v254, v119, s30, v254
  v_dot2_f32_bf16 v255, v119, s31, v255
  s_waitcnt vmcnt(3)
  v_dot2_f32_bf16 v248, v128, s30, v248
  v_dot2_f32_bf16 v249, v128, s31, v249
  v_dot2_f32_bf16 v250, v129, s30, v250
  v_dot2_f32_bf16 v251, v129, s31, v251
  v_dot2_f32_bf16 v252, v130, s30, v252
  v_dot2_f32_bf16 v253, v130, s31, v253
  v_dot2_f32_bf16 v254, v131, s30, v254
  v_dot2_f32_bf16 v255, v131, s31, v255
  s_waitcnt vmcnt(2)
  v_dot2_f32_bf16 v248, v140, s30, v248
  v_dot2_f32_bf16 v249, v140, s31, v249
  v_dot2_f32_bf16 v250, v141, s30, v250
  v_dot2_f32_bf16 v251, v141, s31, v251
  v_dot2_f32_bf16 v252, v142, s30, v252
  v_dot2_f32_bf16 v253, v142, s31, v253
  v_dot2_f32_bf16 v254, v143, s30, v254
  v_dot2_f32_bf16 v255, v143, s31, v255
  v_cvt_pk_bf16_f32 v88, v248, v249
  v_cvt_pk_bf16_f32 v89, v250, v251
  v_cvt_pk_bf16_f32 v90, v252, v253
  v_cvt_pk_bf16_f32 v91, v254, v255
  s_cbranch_scc1 r_out2
  buffer_store_dwordx4 v[88:91], v10, s[20:23], s34 offen offset:1024 sc1
  v_pk_add_f32 v[8:9], v[8:9], v[248:249]
  v_pk_fma_f32 v[14:15], v[248:249], v[248:249], v[14:15]
  v_pk_add_f32 v[8:9], v[8:9], v[250:251]
  v_pk_fma_f32 v[14:15], v[250:251], v[250:251], v[14:15]
  v_pk_add_f32 v[8:9], v[8:9], v[252:253]
  v_pk_fma_f32 v[14:15], v[252:253], v[252:253], v[14:15]
  v_pk_add_f32 v[8:9], v[8:9], v[254:255]
  v_pk_fma_f32 v[14:15], v[254:255], v[254:255], v[14:15]
r_back2:
  s_cbranch_scc1 r_exit
  v_add_f32 v8, v8, v9
  v_add_f32 v9, v14, v15
  s_nop 1
  v_permlane32_swap_b32 v8, v9
  s_nop 0
  v_add_f32 v8, v8, v9
  buffer_store_dword v8, v13, s[12:15], s38 offen sc1
  s_lshl_b32 s60, s29, 11
  s_add_u32 s60, s60, s27
  s_add_u32 s60, s60, 66944
  s_waitcnt vmcnt(0) lgkmcnt(0)
r_bar:
  s_barrier
  s_cmp_lg_u32 s33, 2
  s_cbranch_scc1 r_sig
  s_mov_b64 exec, 1
  buffer_atomic_add v3, v2, s[12:15], s60 offen sc1
  s_mov_b64 exec, -1
r_sig:
  s_lshl_b32 s10, s33, 10
  s_add_u32 s10, s10, 98304
  s_mul_i32 s44, s33, 16384
  s_add_u32 m0, s44, 65536
  s_add_u32 s43, s44, 1060864
  buffer_load_dwordx4 v1, s[16:19], s43 offen sc1 lds
  buffer_load_dwordx4 v1, s[16:19], s43 offen offset:1024 sc1 lds
  buffer_load_dwordx4 v1, s[16:19], s43 offen offset:2048 sc1 lds
  buffer_load_dwordx4 v1, s[16:19], s43 offen offset:3072 sc1 lds
  s_add_u32 m0, m0, 4096
  s_add_u32 s43, s43, 4096
  buffer_load_dwordx4 v1, s[16:19], s43 offen sc1 lds
  buffer_load_dwordx4 v1, s[16:19], s43 offen offset:1024 sc1 lds
  buffer_load_dwordx4 v1, s[16:19], s43 offen offset:2048 sc1 lds
  buffer_load_dwordx4 v1, s[16:19], s43 offen offset:3072 sc1 lds
  s_add_u32 m0, m0, 4096
  s_add_u32 s43, s43, 4096
  buffer_load_dwordx4 v1, s[16:19], s43 offen sc1 lds
  buffer_load_dwordx4 v1, s[16:19], s43 offen offset:1024 sc1 lds
  buffer_load_dwordx4 v1, s[16:19], s43 offen offset:2048 sc1 lds
  buffer_load_dwordx4 v1, s[16:19], s43 offen offset:3072 sc1 lds
  s_add_u32 m0, m0, 4096
  s_add_u32 s43, s43, 4096
  buffer_load_dwordx4 v1, s[16:19], s43 offen sc1 lds
  buffer_load_dwordx4 v1, s[16:19], s43 offen offset:1024 sc1 lds
  buffer_load_dwordx4 v1, s[16:19], s43 offen offset:2048 sc1 lds
  buffer_load_dwordx4 v1, s[16:19], s43 offen offset:3072 sc1 lds
  s_mov_b32 s26, 40763392
  s_add_u32 s27, s27, 196608
  s_branch layer
r_exit:
interleave_layers__mha_block__glu_gated_swiglu__prompt_kernel_end:
  s_endpgm
q_fill:
  buffer_atomic_add v3, v152, s[12:15], s44 offen sc1
  v_mfma_f32_16x16x32_bf16 v[48:51], a[16:19], a[64:67], 0
  ds_read_b128 a[36:39], v1 offset:9216
  v_mfma_f32_16x16x32_bf16 v[52:55], a[16:19], a[68:71], 0
  buffer_load_dwordx4 a[104:107], v1, s[12:15], s36 offen offset:1024 sc1
  v_mfma_f32_16x16x32_bf16 v[16:19], a[0:3], a[64:67], 0
  ds_read_b128 a[20:23], v1 offset:5120
  v_mfma_f32_16x16x32_bf16 v[20:23], a[0:3], a[68:71], 0
  buffer_load_dwordx4 v1, s[16:19], s10 offen sc1 lds
  v_mfma_f32_16x16x32_bf16 v[24:27], a[4:7], a[64:67], 0
  ds_read_b128 a[24:27], v1 offset:6144
  s_add_u32 m0, m0, 4096
  s_add_u32 s10, s10, 4096
  v_mfma_f32_16x16x32_bf16 v[28:31], a[4:7], a[68:71], 0
  ds_read_b128 a[28:31], v1 offset:7168
  v_mfma_f32_16x16x32_bf16 v[32:35], a[64:67], a[8:11], 0
  buffer_load_dwordx4 a[108:111], v1, s[12:15], s37 offen offset:1024 sc1
  v_mfma_f32_16x16x32_bf16 v[36:39], a[68:71], a[8:11], 0
  ds_read_b128 a[32:35], v1 offset:8192
  v_mfma_f32_16x16x32_bf16 v[40:43], a[64:67], a[12:15], 0
  buffer_load_dwordx4 v1, s[16:19], s10 offen sc1 lds
  v_mfma_f32_16x16x32_bf16 v[44:47], a[68:71], a[12:15], 0
  s_waitcnt vmcnt(11) lgkmcnt(3)
  s_add_u32 m0, m0, 4096
  s_add_u32 s10, s10, 4096
  v_mfma_f32_16x16x32_bf16 v[48:51], a[36:39], a[72:75], v[48:51]
  ds_read_b128 a[16:19], v1 offset:14336
  v_mfma_f32_16x16x32_bf16 v[52:55], a[36:39], a[76:79], v[52:55]
  buffer_load_dwordx4 a[112:115], v1, s[12:15], s36 offen offset:2048 sc1
  v_mfma_f32_16x16x32_bf16 v[16:19], a[20:23], a[72:75], v[16:19]
  ds_read_b128 a[0:3], v1 offset:10240
  v_mfma_f32_16x16x32_bf16 v[20:23], a[20:23], a[76:79], v[20:23]
  s_waitcnt lgkmcnt(2)
  buffer_load_dwordx4 v1, s[16:19], s10 offen sc1 lds
  v_mfma_f32_16x16x32_bf16 v[24:27], a[24:27], a[72:75], v[24:27]
  ds_read_b128 a[4:7], v1 offset:11264
  s_add_u32 m0, m0, 4096
  s_add_u32 s10, s10, 4096
  v_mfma_f32_16x16x32_bf16 v[28:31], a[24:27], a[76:79], v[28:31]
  ds_read_b128 a[8:11], v1 offset:12288
  v_mfma_f32_16x16x32_bf16 v[32:35], a[72:75], a[28:31], v[32:35]
  buffer_load_dwordx4 a[116:119], v1, s[12:15], s37 offen offset:2048 sc1
  v_mfma_f32_16x16x32_bf16 v[36:39], a[76:79], a[28:31], v[36:39]
  ds_read_b128 a[12:15], v1 offset:13312
  v_mfma_f32_16x16x32_bf16 v[40:43], a[72:75], a[32:35], v[40:43]
  buffer_load_dwordx4 v1, s[16:19], s10 offen sc1 lds
  v_mfma_f32_16x16x32_bf16 v[44:47], a[76:79], a[32:35], v[44:47]
  s_waitcnt vmcnt(13) lgkmcnt(3)
  s_add_u32 m0, m0, 4096
  s_add_u32 s10, s10, 4096
  v_mfma_f32_16x16x32_bf16 v[48:51], a[16:19], a[80:83], v[48:51]
  ds_read_b128 a[36:39], v1 offset:19456
  v_mfma_f32_16x16x32_bf16 v[52:55], a[16:19], a[84:87], v[52:55]
  buffer_load_dwordx4 a[120:123], v1, s[12:15], s36 offen offset:3072 sc1
  v_mfma_f32_16x16x32_bf16 v[16:19], a[0:3], a[80:83], v[16:19]
  ds_read_b128 a[20:23], v1 offset:15360
  s_add_u32 s36, s36, 4096
  v_mfma_f32_16x16x32_bf16 v[20:23], a[0:3], a[84:87], v[20:23]
  s_waitcnt lgkmcnt(2)
  buffer_load_dwordx4 v1, s[16:19], s10 offen sc1 lds
  v_mfma_f32_16x16x32_bf16 v[24:27], a[4:7], a[80:83], v[24:27]
  ds_read_b128 a[24:27], v1 offset:16384
  s_add_u32 m0, m0, 4096
  s_add_u32 s10, s10, 4096
  v_mfma_f32_16x16x32_bf16 v[28:31], a[4:7], a[84:87], v[28:31]
  ds_read_b128 a[28:31], v1 offset:17408
  v_mfma_f32_16x16x32_bf16 v[32:35], a[80:83], a[8:11], v[32:35]
  buffer_load_dwordx4 a[124:127], v1, s[12:15], s37 offen offset:3072 sc1
  v_mfma_f32_16x16x32_bf16 v[36:39], a[84:87], a[8:11], v[36:39]
  ds_read_b128 a[32:35], v1 offset:18432
  s_add_u32 s37, s37, 4096
  v_mfma_f32_16x16x32_bf16 v[40:43], a[80:83], a[12:15], v[40:43]
  buffer_load_dwordx4 v1, s[16:19], s10 offen sc1 lds
  v_mfma_f32_16x16x32_bf16 v[44:47], a[84:87], a[12:15], v[44:47]
  s_waitcnt vmcnt(15) lgkmcnt(3)
  s_add_u32 m0, m0, 4096
  s_add_u32 s10, s10, 4096
  v_mfma_f32_16x16x32_bf16 v[48:51], a[36:39], a[88:91], v[48:51]
  ds_read_b128 a[16:19], v1 offset:24576
  v_mfma_f32_16x16x32_bf16 v[52:55], a[36:39], a[92:95], v[52:55]
  buffer_load_dwordx4 a[128:131], v1, s[12:15], s36 offen sc1
  v_mfma_f32_16x16x32_bf16 v[16:19], a[20:23], a[88:91], v[16:19]
  ds_read_b128 a[0:3], v1 offset:20480
  v_mfma_f32_16x16x32_bf16 v[20:23], a[20:23], a[92:95], v[20:23]
  s_waitcnt lgkmcnt(2)
  buffer_load_dwordx4 v1, s[16:19], s10 offen sc1 lds
  v_mfma_f32_16x16x32_bf16 v[24:27], a[24:27], a[88:91], v[24:27]
  ds_read_b128 a[4:7], v1 offset:21504
  s_add_u32 m0, m0, 4096
  s_add_u32 s10, s10, 4096
  v_mfma_f32_16x16x32_bf16 v[28:31], a[24:27], a[92:95], v[28:31]
  ds_read_b128 a[8:11], v1 offset:22528
  v_mfma_f32_16x16x32_bf16 v[32:35], a[88:91], a[28:31], v[32:35]
  buffer_load_dwordx4 a[132:135], v1, s[12:15], s37 offen sc1
  v_mfma_f32_16x16x32_bf16 v[36:39], a[92:95], a[28:31], v[36:39]
  ds_read_b128 a[12:15], v1 offset:23552
  v_mfma_f32_16x16x32_bf16 v[40:43], a[88:91], a[32:35], v[40:43]
  buffer_load_dwordx4 v1, s[16:19], s10 offen sc1 lds
  v_mfma_f32_16x16x32_bf16 v[44:47], a[92:95], a[32:35], v[44:47]
  s_waitcnt vmcnt(17) lgkmcnt(3)
  s_add_u32 m0, m0, 4096
  s_add_u32 s10, s10, 4096
  v_mfma_f32_16x16x32_bf16 v[48:51], a[16:19], a[96:99], v[48:51]
  ds_read_b128 a[36:39], v1 offset:29696
  v_mfma_f32_16x16x32_bf16 v[52:55], a[16:19], a[100:103], v[52:55]
  buffer_load_dwordx4 a[136:139], v1, s[12:15], s36 offen offset:1024 sc1
  v_mfma_f32_16x16x32_bf16 v[16:19], a[0:3], a[96:99], v[16:19]
  ds_read_b128 a[20:23], v1 offset:25600
  v_mfma_f32_16x16x32_bf16 v[20:23], a[0:3], a[100:103], v[20:23]
  s_waitcnt lgkmcnt(2)
  buffer_load_dwordx4 v1, s[16:19], s10 offen sc1 lds
  v_mfma_f32_16x16x32_bf16 v[24:27], a[4:7], a[96:99], v[24:27]
  ds_read_b128 a[24:27], v1 offset:26624
  s_add_u32 m0, m0, 4096
  s_add_u32 s10, s10, 4096
  v_mfma_f32_16x16x32_bf16 v[28:31], a[4:7], a[100:103], v[28:31]
  ds_read_b128 a[28:31], v1 offset:27648
  v_mfma_f32_16x16x32_bf16 v[32:35], a[96:99], a[8:11], v[32:35]
  buffer_load_dwordx4 a[140:143], v1, s[12:15], s37 offen offset:1024 sc1
  v_mfma_f32_16x16x32_bf16 v[36:39], a[100:103], a[8:11], v[36:39]
  ds_read_b128 a[32:35], v1 offset:28672
  v_mfma_f32_16x16x32_bf16 v[40:43], a[96:99], a[12:15], v[40:43]
  buffer_load_dwordx4 v1, s[16:19], s10 offen sc1 lds
  v_mfma_f32_16x16x32_bf16 v[44:47], a[100:103], a[12:15], v[44:47]
  s_waitcnt vmcnt(17) lgkmcnt(3)
  s_add_u32 m0, m0, 4096
  s_add_u32 s10, s10, 4096
  v_mfma_f32_16x16x32_bf16 v[48:51], a[36:39], a[104:107], v[48:51]
  s_waitcnt vmcnt(8)
  s_barrier
  ds_read_b128 a[16:19], v1 offset:34816
  v_mfma_f32_16x16x32_bf16 v[52:55], a[36:39], a[108:111], v[52:55]
  buffer_load_dwordx4 a[144:147], v1, s[12:15], s36 offen offset:2048 sc1
  v_mfma_f32_16x16x32_bf16 v[16:19], a[20:23], a[104:107], v[16:19]
  ds_read_b128 a[0:3], v1 offset:30720
  v_mfma_f32_16x16x32_bf16 v[20:23], a[20:23], a[108:111], v[20:23]
  s_waitcnt lgkmcnt(2)
  buffer_load_dwordx4 v1, s[16:19], s10 offen sc1 lds
  v_mfma_f32_16x16x32_bf16 v[24:27], a[24:27], a[104:107], v[24:27]
  ds_read_b128 a[4:7], v1 offset:31744
  s_add_u32 m0, m0, 4096
  s_add_u32 s10, s10, 4096
  v_mfma_f32_16x16x32_bf16 v[28:31], a[24:27], a[108:111], v[28:31]
  ds_read_b128 a[8:11], v1 offset:32768
  v_mfma_f32_16x16x32_bf16 v[32:35], a[104:107], a[28:31], v[32:35]
  buffer_load_dwordx4 a[148:151], v1, s[12:15], s37 offen offset:2048 sc1
  v_mfma_f32_16x16x32_bf16 v[36:39], a[108:111], a[28:31], v[36:39]
  ds_read_b128 a[12:15], v1 offset:33792
  v_mfma_f32_16x16x32_bf16 v[40:43], a[104:107], a[32:35], v[40:43]
  buffer_load_dwordx4 v1, s[16:19], s10 offen sc1 lds
  v_mfma_f32_16x16x32_bf16 v[44:47], a[108:111], a[32:35], v[44:47]
  s_waitcnt vmcnt(63) lgkmcnt(3)
  s_add_u32 m0, m0, 4096
  s_add_u32 s10, s10, 4096
  v_mfma_f32_16x16x32_bf16 v[48:51], a[16:19], a[112:115], v[48:51]
  ds_read_b128 a[36:39], v1 offset:39936
  v_mfma_f32_16x16x32_bf16 v[52:55], a[16:19], a[116:119], v[52:55]
  buffer_load_dwordx4 a[152:155], v1, s[12:15], s36 offen offset:3072 sc1
  v_mfma_f32_16x16x32_bf16 v[16:19], a[0:3], a[112:115], v[16:19]
  ds_read_b128 a[20:23], v1 offset:35840
  s_add_u32 s36, s36, 4096
  v_mfma_f32_16x16x32_bf16 v[20:23], a[0:3], a[116:119], v[20:23]
  s_waitcnt lgkmcnt(2)
  buffer_load_dwordx4 v1, s[16:19], s10 offen sc1 lds
  v_mfma_f32_16x16x32_bf16 v[24:27], a[4:7], a[112:115], v[24:27]
  ds_read_b128 a[24:27], v1 offset:36864
  s_add_u32 m0, m0, 4096
  s_add_u32 s10, s10, 4096
  v_mfma_f32_16x16x32_bf16 v[28:31], a[4:7], a[116:119], v[28:31]
  ds_read_b128 a[28:31], v1 offset:37888
  v_mfma_f32_16x16x32_bf16 v[32:35], a[112:115], a[8:11], v[32:35]
  buffer_load_dwordx4 a[156:159], v1, s[12:15], s37 offen offset:3072 sc1
  v_mfma_f32_16x16x32_bf16 v[36:39], a[116:119], a[8:11], v[36:39]
  ds_read_b128 a[32:35], v1 offset:38912
  s_add_u32 s37, s37, 4096
  v_mfma_f32_16x16x32_bf16 v[40:43], a[112:115], a[12:15], v[40:43]
  buffer_load_dwordx4 v1, s[16:19], s10 offen sc1 lds
  v_mfma_f32_16x16x32_bf16 v[44:47], a[116:119], a[12:15], v[44:47]
  s_waitcnt vmcnt(63) lgkmcnt(3)
  s_add_u32 m0, m0, 4096
  s_add_u32 s10, s10, 4096
  v_mfma_f32_16x16x32_bf16 v[48:51], a[36:39], a[120:123], v[48:51]
  ds_read_b128 a[16:19], v1 offset:45056
  v_mfma_f32_16x16x32_bf16 v[52:55], a[36:39], a[124:127], v[52:55]
  buffer_load_dwordx4 a[160:163], v1, s[12:15], s36 offen sc1
  v_mfma_f32_16x16x32_bf16 v[16:19], a[20:23], a[120:123], v[16:19]
  ds_read_b128 a[0:3], v1 offset:40960
  v_mfma_f32_16x16x32_bf16 v[20:23], a[20:23], a[124:127], v[20:23]
  s_waitcnt lgkmcnt(2)
  buffer_load_dwordx4 v1, s[16:19], s10 offen sc1 lds
  v_mfma_f32_16x16x32_bf16 v[24:27], a[24:27], a[120:123], v[24:27]
  ds_read_b128 a[4:7], v1 offset:41984
  s_add_u32 m0, m0, 4096
  s_add_u32 s10, s10, 4096
  v_mfma_f32_16x16x32_bf16 v[28:31], a[24:27], a[124:127], v[28:31]
  ds_read_b128 a[8:11], v1 offset:43008
  v_mfma_f32_16x16x32_bf16 v[32:35], a[120:123], a[28:31], v[32:35]
  buffer_load_dwordx4 a[164:167], v1, s[12:15], s37 offen sc1
  v_mfma_f32_16x16x32_bf16 v[36:39], a[124:127], a[28:31], v[36:39]
  ds_read_b128 a[12:15], v1 offset:44032
  v_mfma_f32_16x16x32_bf16 v[40:43], a[120:123], a[32:35], v[40:43]
  buffer_load_dwordx4 v1, s[16:19], s10 offen sc1 lds
  v_mfma_f32_16x16x32_bf16 v[44:47], a[124:127], a[32:35], v[44:47]
  s_waitcnt vmcnt(17) lgkmcnt(3)
  s_add_u32 m0, m0, 4096
  s_add_u32 s10, s10, 4096
  v_mfma_f32_16x16x32_bf16 v[48:51], a[16:19], a[128:131], v[48:51]
  ds_read_b128 a[36:39], v1 offset:50176
  v_mov_b32 v8, 1.0
  v_mfma_f32_16x16x32_bf16 v[52:55], a[16:19], a[132:135], v[52:55]
  buffer_load_dwordx4 a[168:171], v1, s[12:15], s36 offen offset:1024 sc1
  v_mfma_f32_16x16x32_bf16 v[16:19], a[0:3], a[128:131], v[16:19]
  ds_read_b128 a[20:23], v1 offset:46080
  v_mov_b32 v9, 1.0
  v_mfma_f32_16x16x32_bf16 v[20:23], a[0:3], a[132:135], v[20:23]
  s_waitcnt lgkmcnt(2)
  v_mov_b32 v80, 0
  v_mov_b32 v81, 0
  v_mfma_f32_16x16x32_bf16 v[24:27], a[4:7], a[128:131], v[24:27]
  ds_read_b128 a[24:27], v1 offset:47104
  v_mov_b32 v82, 0
  v_mfma_f32_16x16x32_bf16 v[28:31], a[4:7], a[132:135], v[28:31]
  ds_read_b128 a[28:31], v1 offset:48128
  v_mov_b32 v83, 0
  v_mfma_f32_16x16x32_bf16 v[32:35], a[128:131], a[8:11], v[32:35]
  buffer_load_dwordx4 a[172:175], v1, s[12:15], s37 offen offset:1024 sc1
  v_mfma_f32_16x16x32_bf16 v[36:39], a[132:135], a[8:11], v[36:39]
  ds_read_b128 a[32:35], v1 offset:49152
  v_mov_b32 v84, 0
  v_mfma_f32_16x16x32_bf16 v[40:43], a[128:131], a[12:15], v[40:43]
  v_mov_b32 v85, 0
  v_mov_b32 v86, 0
  v_mfma_f32_16x16x32_bf16 v[44:47], a[132:135], a[12:15], v[44:47]
  s_waitcnt vmcnt(15) lgkmcnt(3)
  v_mov_b32 v87, 0
  v_mov_b32 v88, 0
  v_mfma_f32_16x16x32_bf16 v[48:51], a[36:39], a[136:139], v[48:51]
  ds_read_b128 a[16:19], v1 offset:55296
  v_mov_b32 v89, 0
  v_mfma_f32_16x16x32_bf16 v[52:55], a[36:39], a[140:143], v[52:55]
  buffer_load_dwordx4 a[176:179], v1, s[12:15], s36 offen offset:2048 sc1
  v_mfma_f32_16x16x32_bf16 v[16:19], a[20:23], a[136:139], v[16:19]
  ds_read_b128 a[0:3], v1 offset:51200
  v_mov_b32 v90, 0
  v_mfma_f32_16x16x32_bf16 v[20:23], a[20:23], a[140:143], v[20:23]
  s_waitcnt lgkmcnt(2)
  v_mov_b32 v91, 0
  v_mov_b32 v92, 0
  v_mfma_f32_16x16x32_bf16 v[24:27], a[24:27], a[136:139], v[24:27]
  ds_read_b128 a[4:7], v1 offset:52224
  v_mov_b32 v93, 0
  v_mfma_f32_16x16x32_bf16 v[28:31], a[24:27], a[140:143], v[28:31]
  ds_read_b128 a[8:11], v1 offset:53248
  v_mov_b32 v94, 0
  v_mfma_f32_16x16x32_bf16 v[32:35], a[136:139], a[28:31], v[32:35]
  buffer_load_dwordx4 a[180:183], v1, s[12:15], s37 offen offset:2048 sc1
  v_mfma_f32_16x16x32_bf16 v[36:39], a[140:143], a[28:31], v[36:39]
  ds_read_b128 a[12:15], v1 offset:54272
  v_mov_b32 v95, 0
  v_mfma_f32_16x16x32_bf16 v[40:43], a[136:139], a[32:35], v[40:43]
  v_mul_f32 v12, 0x3eae1a93, v8
  v_mul_f32 v13, 0x3eae1a93, v9
  v_mfma_f32_16x16x32_bf16 v[44:47], a[140:143], a[32:35], v[44:47]
  s_waitcnt vmcnt(13) lgkmcnt(3)
  v_cndmask_b32 v14, v8, v12, s[48:49]
  v_cndmask_b32 v15, v9, v13, s[48:49]
  v_mfma_f32_16x16x32_bf16 v[48:51], a[16:19], a[144:147], v[48:51]
  s_waitcnt vmcnt(4)
  s_barrier
  ds_read_b128 a[36:39], v1 offset:60416
  v_mfma_f32_16x16x32_bf16 v[52:55], a[16:19], a[148:151], v[52:55]
  buffer_load_dwordx4 a[184:187], v1, s[12:15], s36 offen offset:3072 sc1
  v_mfma_f32_16x16x32_bf16 v[16:19], a[0:3], a[144:147], v[16:19]
  ds_read_b128 a[20:23], v1 offset:56320
  s_add_u32 s36, s36, 4096
  v_mfma_f32_16x16x32_bf16 v[20:23], a[0:3], a[148:151], v[20:23]
  s_waitcnt lgkmcnt(2)
  v_mfma_f32_16x16x32_bf16 v[24:27], a[4:7], a[144:147], v[24:27]
  ds_read_b128 a[24:27], v1 offset:57344
  v_mfma_f32_16x16x32_bf16 v[28:31], a[4:7], a[148:151], v[28:31]
  ds_read_b128 a[28:31], v1 offset:58368
  v_mfma_f32_16x16x32_bf16 v[32:35], a[144:147], a[8:11], v[32:35]
  buffer_load_dwordx4 a[188:191], v1, s[12:15], s37 offen offset:3072 sc1
  v_mfma_f32_16x16x32_bf16 v[36:39], a[148:151], a[8:11], v[36:39]
  ds_read_b128 a[32:35], v1 offset:59392
  s_add_u32 s37, s37, 4096
  v_mfma_f32_16x16x32_bf16 v[40:43], a[144:147], a[12:15], v[40:43]
  v_mfma_f32_16x16x32_bf16 v[44:47], a[148:151], a[12:15], v[44:47]
  s_waitcnt vmcnt(63) lgkmcnt(3)
  v_mfma_f32_16x16x32_bf16 v[48:51], a[36:39], a[152:155], v[48:51]
  ds_read_b128 a[16:19], v5 offset:0
  v_mfma_f32_16x16x32_bf16 v[52:55], a[36:39], a[156:159], v[52:55]
  buffer_load_dwordx4 a[192:195], v1, s[12:15], s36 offen sc1
  v_mfma_f32_16x16x32_bf16 v[16:19], a[20:23], a[152:155], v[16:19]
  ds_read_b128 a[0:3], v1 offset:61440
  v_mfma_f32_16x16x32_bf16 v[20:23], a[20:23], a[156:159], v[20:23]
  s_waitcnt lgkmcnt(2)
  v_mfma_f32_16x16x32_bf16 v[24:27], a[24:27], a[152:155], v[24:27]
  ds_read_b128 a[4:7], v1 offset:62464
  v_mfma_f32_16x16x32_bf16 v[28:31], a[24:27], a[156:159], v[28:31]
  ds_read_b128 a[8:11], v1 offset:63488
  v_mfma_f32_16x16x32_bf16 v[32:35], a[152:155], a[28:31], v[32:35]
  buffer_load_dwordx4 a[196:199], v1, s[12:15], s37 offen sc1
  v_mfma_f32_16x16x32_bf16 v[36:39], a[156:159], a[28:31], v[36:39]
  ds_read_b128 a[12:15], v1 offset:64512
  v_mfma_f32_16x16x32_bf16 v[40:43], a[152:155], a[32:35], v[40:43]
  v_mfma_f32_16x16x32_bf16 v[44:47], a[156:159], a[32:35], v[44:47]
  s_waitcnt vmcnt(63) lgkmcnt(3)
  v_mfma_f32_16x16x32_bf16 v[48:51], a[16:19], a[160:163], v[48:51]
  ds_read_b128 a[36:39], v5 offset:5120
  v_mfma_f32_16x16x32_bf16 v[52:55], a[16:19], a[164:167], v[52:55]
  buffer_load_dwordx4 a[200:203], v1, s[12:15], s36 offen offset:1024 sc1
  v_mfma_f32_16x16x32_bf16 v[16:19], a[0:3], a[160:163], v[16:19]
  ds_read_b128 a[20:23], v5 offset:1024
  v_mfma_f32_16x16x32_bf16 v[20:23], a[0:3], a[164:167], v[20:23]
  s_waitcnt lgkmcnt(2)
  v_mfma_f32_16x16x32_bf16 v[24:27], a[4:7], a[160:163], v[24:27]
  ds_read_b128 a[24:27], v5 offset:2048
  v_mfma_f32_16x16x32_bf16 v[28:31], a[4:7], a[164:167], v[28:31]
  ds_read_b128 a[28:31], v5 offset:3072
  v_mfma_f32_16x16x32_bf16 v[32:35], a[160:163], a[8:11], v[32:35]
  buffer_load_dwordx4 a[204:207], v1, s[12:15], s37 offen offset:1024 sc1
  v_mfma_f32_16x16x32_bf16 v[36:39], a[164:167], a[8:11], v[36:39]
  ds_read_b128 a[32:35], v5 offset:4096
  v_mfma_f32_16x16x32_bf16 v[40:43], a[160:163], a[12:15], v[40:43]
  buffer_load_dword v154, v153, s[12:15], s45 offen sc1
  v_mfma_f32_16x16x32_bf16 v[44:47], a[164:167], a[12:15], v[44:47]
  s_waitcnt vmcnt(9) lgkmcnt(3)
  v_mfma_f32_16x16x32_bf16 v[48:51], a[36:39], a[168:171], v[48:51]
  ds_read_b128 a[16:19], v5 offset:10240
  v_mfma_f32_16x16x32_bf16 v[52:55], a[36:39], a[172:175], v[52:55]
  buffer_load_dwordx4 v1, s[16:19], s10 offen sc1 lds
  v_mfma_f32_16x16x32_bf16 v[16:19], a[20:23], a[168:171], v[16:19]
  ds_read_b128 a[0:3], v5 offset:6144
  s_add_u32 m0, m0, 4096
  s_add_u32 s10, s10, 4096
  v_mfma_f32_16x16x32_bf16 v[20:23], a[20:23], a[172:175], v[20:23]
  s_waitcnt lgkmcnt(2)
  v_mfma_f32_16x16x32_bf16 v[24:27], a[24:27], a[168:171], v[24:27]
  ds_read_b128 a[4:7], v5 offset:7168
  v_mfma_f32_16x16x32_bf16 v[28:31], a[24:27], a[172:175], v[28:31]
  ds_read_b128 a[8:11], v5 offset:8192
  v_mfma_f32_16x16x32_bf16 v[32:35], a[168:171], a[28:31], v[32:35]
  buffer_load_dwordx4 v1, s[16:19], s10 offen sc1 lds
  v_mfma_f32_16x16x32_bf16 v[36:39], a[172:175], a[28:31], v[36:39]
  ds_read_b128 a[12:15], v5 offset:9216
  s_add_u32 m0, m0, 4096
  s_add_u32 s10, s10, 4096
  v_mfma_f32_16x16x32_bf16 v[40:43], a[168:171], a[32:35], v[40:43]
  v_mfma_f32_16x16x32_bf16 v[44:47], a[172:175], a[32:35], v[44:47]
  s_waitcnt vmcnt(9) lgkmcnt(3)
  v_mfma_f32_16x16x32_bf16 v[48:51], a[16:19], a[176:179], v[48:51]
  ds_read_b128 a[36:39], v5 offset:15360
  v_mfma_f32_16x16x32_bf16 v[52:55], a[16:19], a[180:183], v[52:55]
  buffer_load_dwordx4 v1, s[16:19], s10 offen sc1 lds
  v_mfma_f32_16x16x32_bf16 v[16:19], a[0:3], a[176:179], v[16:19]
  ds_read_b128 a[20:23], v5 offset:11264
  s_add_u32 m0, m0, 4096
  s_add_u32 s10, s10, 4096
  v_mfma_f32_16x16x32_bf16 v[20:23], a[0:3], a[180:183], v[20:23]
  s_waitcnt lgkmcnt(2)
  v_mfma_f32_16x16x32_bf16 v[24:27], a[4:7], a[176:179], v[24:27]
  ds_read_b128 a[24:27], v5 offset:12288
  v_mfma_f32_16x16x32_bf16 v[28:31], a[4:7], a[180:183], v[28:31]
  ds_read_b128 a[28:31], v5 offset:13312
  v_mfma_f32_16x16x32_bf16 v[32:35], a[176:179], a[8:11], v[32:35]
  buffer_load_dwordx4 v1, s[16:19], s10 offen sc1 lds
  v_mfma_f32_16x16x32_bf16 v[36:39], a[180:183], a[8:11], v[36:39]
  ds_read_b128 a[32:35], v5 offset:14336
  s_add_u32 m0, m0, 4096
  s_add_u32 s10, s10, 4096
  v_mfma_f32_16x16x32_bf16 v[40:43], a[176:179], a[12:15], v[40:43]
  v_mfma_f32_16x16x32_bf16 v[44:47], a[180:183], a[12:15], v[44:47]
  s_waitcnt vmcnt(9) lgkmcnt(3)
  v_mfma_f32_16x16x32_bf16 v[48:51], a[36:39], a[184:187], v[48:51]
  ds_read_b128 a[16:19], v5 offset:20480
  v_mfma_f32_16x16x32_bf16 v[52:55], a[36:39], a[188:191], v[52:55]
  buffer_load_dwordx4 v1, s[16:19], s10 offen sc1 lds
  v_mfma_f32_16x16x32_bf16 v[16:19], a[20:23], a[184:187], v[16:19]
  ds_read_b128 a[0:3], v5 offset:16384
  s_add_u32 m0, m0, 4096
  s_add_u32 s10, s10, 4096
  v_mfma_f32_16x16x32_bf16 v[20:23], a[20:23], a[188:191], v[20:23]
  s_waitcnt lgkmcnt(2)
  v_mfma_f32_16x16x32_bf16 v[24:27], a[24:27], a[184:187], v[24:27]
  ds_read_b128 a[4:7], v5 offset:17408
  v_mfma_f32_16x16x32_bf16 v[28:31], a[24:27], a[188:191], v[28:31]
  ds_read_b128 a[8:11], v5 offset:18432
  v_mfma_f32_16x16x32_bf16 v[32:35], a[184:187], a[28:31], v[32:35]
  buffer_load_dwordx4 v1, s[16:19], s10 offen sc1 lds
  v_mfma_f32_16x16x32_bf16 v[36:39], a[188:191], a[28:31], v[36:39]
  ds_read_b128 a[12:15], v5 offset:19456
  s_add_u32 m0, m0, 4096
  s_add_u32 s10, s10, 4096
  v_mfma_f32_16x16x32_bf16 v[40:43], a[184:187], a[32:35], v[40:43]
  v_mfma_f32_16x16x32_bf16 v[44:47], a[188:191], a[32:35], v[44:47]
  s_waitcnt vmcnt(9) lgkmcnt(3)
  v_mfma_f32_16x16x32_bf16 v[48:51], a[16:19], a[192:195], v[48:51]
  ds_read_b128 a[36:39], v5 offset:25600
  v_mfma_f32_16x16x32_bf16 v[52:55], a[16:19], a[196:199], v[52:55]
  buffer_load_dwordx4 v1, s[16:19], s10 offen sc1 lds
  v_mfma_f32_16x16x32_bf16 v[16:19], a[0:3], a[192:195], v[16:19]
  ds_read_b128 a[20:23], v5 offset:21504
  s_add_u32 m0, m0, 4096
  s_add_u32 s10, s10, 4096
  v_mfma_f32_16x16x32_bf16 v[20:23], a[0:3], a[196:199], v[20:23]
  s_waitcnt lgkmcnt(2)
  v_mfma_f32_16x16x32_bf16 v[24:27], a[4:7], a[192:195], v[24:27]
  ds_read_b128 a[24:27], v5 offset:22528
  v_mfma_f32_16x16x32_bf16 v[28:31], a[4:7], a[196:199], v[28:31]
  ds_read_b128 a[28:31], v5 offset:23552
  v_mfma_f32_16x16x32_bf16 v[32:35], a[192:195], a[8:11], v[32:35]
  buffer_load_dwordx4 v1, s[16:19], s10 offen sc1 lds
  v_mfma_f32_16x16x32_bf16 v[36:39], a[196:199], a[8:11], v[36:39]
  ds_read_b128 a[32:35], v5 offset:24576
  s_add_u32 m0, m0, 4096
  s_add_u32 s10, s10, 4096
  v_mfma_f32_16x16x32_bf16 v[40:43], a[192:195], a[12:15], v[40:43]
  v_mfma_f32_16x16x32_bf16 v[44:47], a[196:199], a[12:15], v[44:47]
  s_waitcnt vmcnt(9) lgkmcnt(3)
  v_mfma_f32_16x16x32_bf16 v[48:51], a[36:39], a[200:203], v[48:51]
  ds_bpermute_b32 v96, v6, v8 offset:0
  v_mfma_f32_16x16x32_bf16 v[52:55], a[36:39], a[204:207], v[52:55]
  ds_bpermute_b32 v97, v6, v8 offset:4
  v_mfma_f32_16x16x32_bf16 v[16:19], a[20:23], a[200:203], v[16:19]
  ds_bpermute_b32 v98, v6, v8 offset:8
  v_mfma_f32_16x16x32_bf16 v[20:23], a[20:23], a[204:207], v[20:23]
  s_waitcnt lgkmcnt(3)
  v_mfma_f32_16x16x32_bf16 v[24:27], a[24:27], a[200:203], v[24:27]
  ds_bpermute_b32 v99, v6, v8 offset:12
  v_mfma_f32_16x16x32_bf16 v[28:31], a[24:27], a[204:207], v[28:31]
  ds_bpermute_b32 v100, v6, v9 offset:0
  v_mfma_f32_16x16x32_bf16 v[32:35], a[200:203], a[28:31], v[32:35]
  ds_bpermute_b32 v101, v6, v9 offset:4
  v_mfma_f32_16x16x32_bf16 v[36:39], a[204:207], a[28:31], v[36:39]
  ds_bpermute_b32 v102, v6, v9 offset:8
  v_mfma_f32_16x16x32_bf16 v[40:43], a[200:203], a[32:35], v[40:43]
  ds_bpermute_b32 v103, v6, v9 offset:12
  v_mfma_f32_16x16x32_bf16 v[44:47], a[204:207], a[32:35], v[44:47]
  s_waitcnt vmcnt(8)
  v_cmp_gt_u32 vcc, s46, v154
  s_mov_b32 s61, 0x40000
  s_cbranch_vccz q_kv
q_wo:
  buffer_load_dword v154, v153, s[12:15], s45 offen sc1
  s_sub_u32 s61, s61, 1
  s_waitcnt vmcnt(0)
  v_cmp_gt_u32 vcc, s46, v154
  s_cbranch_scc1 q_kv
  s_cbranch_vccnz q_wo
  s_branch q_kv
a_jobs:
  s_waitcnt lgkmcnt(0)
  s_mov_b32 s20, s100
  s_mov_b32 s21, s101
  s_mov_b32 s22, 2359296
  s_mov_b32 s23, 0x20000
  v_and_b32 v8, 31, v0
  v_mul_u32_u24 v8, 1152, v8
  v_bfe_u32 v9, v0, 5, 1
  v_lshl_add_u32 v8, v9, 4, v8
  s_and_b32 s38, s25, 3
  s_mul_i32 s38, s38, 3
  s_add_u32 s38, s38, s33
  s_mul_i32 s38, s38, 96
  s_mul_i32 s39, s29, 36864
  s_add_u32 s38, s38, s39
  v_mov_b32 v80, 0x3f803f80
  v_mov_b32 v81, 0x3f803f80
  v_mov_b32 v82, 0x3f803f80
  v_mov_b32 v83, 0x3f803f80
  buffer_load_dwordx4 v[244:247], v8, s[20:23], s38 offen offset:0
  buffer_load_dwordx4 v[248:251], v8, s[20:23], s38 offen offset:32
  buffer_load_dwordx4 v[252:255], v8, s[20:23], s38 offen offset:64
  s_mov_b32 s20, s54
  s_mov_b32 s21, s55
  s_mov_b32 s22, s11
  s_mov_b32 s23, 0x20000
  s_mov_b32 s32, 0
  s_mov_b32 s41, s52
  s_branch a_init
a_break:
  s_and_b32 s38, s25, 3
  s_mul_i32 s38, s38, 167936
  s_add_u32 s38, s38, 81563648
  s_lshl_b32 s56, s33, 13
  s_add_u32 s56, s56, 98304
  s_add_u32 s20, s4, s38
  s_addc_u32 s21, s5, 0
  s_mov_b32 s22, 129024
  s_mov_b32 s23, 0x20000
  s_mov_b32 s36, 1073741824
  s_mov_b32 s37, 1073741824
  s_mov_b32 s38, 1073741824
  s_mov_b32 s39, 1073741824
  s_mov_b32 s44, 1073741824
  s_mov_b32 s45, 1073741824
a_wide:
  s_mov_b32 m0, s56
  s_add_u32 s32, s32, 1
  v_mfma_f32_32x32x8_bf16 v[128:143], v[40:41], v[36:37], 0
  v_exp_f32 v96, v96
  v_exp_f32 v97, v97
  v_exp_f32 v98, v98
  v_exp_f32 v99, v99
  v_mfma_f32_32x32x16_bf16 v[128:143], a[64:67], v[24:27], v[128:143]
  s_add_u32 s46, s46, 4864
  v_exp_f32 v100, v100
  v_exp_f32 v101, v101
  v_exp_f32 v102, v102
  v_exp_f32 v103, v103
  v_smfmac_f32_32x32x32_bf16 v[208:223], a[104:107], v[144:151], v228
  buffer_load_dwordx4 a[76:79], v79, s[16:19], s46 offen sc1
  v_exp_f32 v104, v104
  v_exp_f32 v105, v105
  v_exp_f32 v106, v106
  v_exp_f32 v107, v107
  v_smfmac_f32_32x32x32_bf16 v[208:223], a[108:111], v[152:159], v228
  v_exp_f32 v108, v108
  v_exp_f32 v109, v109
  v_exp_f32 v110, v110
  v_exp_f32 v111, v111
  v_mfma_f32_32x32x8_bf16 v[144:159], v[40:41], v[38:39], 0
  v_exp_f32 v112, v112
  v_exp_f32 v113, v113
  v_exp_f32 v114, v114
  v_exp_f32 v115, v115
  v_mfma_f32_32x32x16_bf16 v[144:159], a[64:67], v[28:31], v[144:159]
  s_waitcnt vmcnt(9)
  v_exp_f32 v116, v116
  v_exp_f32 v117, v117
  v_exp_f32 v118, v118
  v_exp_f32 v119, v119
  v_smfmac_f32_32x32x32_bf16 v[160:175], a[80:83], v[96:103], v228
  buffer_load_dword v46, v231, s[16:19], s46 offen offset:2176 sc1
  v_exp_f32 v120, v120
  v_exp_f32 v121, v121
  v_exp_f32 v122, v122
  v_exp_f32 v123, v123
  v_smfmac_f32_32x32x32_bf16 v[160:175], a[84:87], v[104:111], v228
  v_exp_f32 v124, v124
  v_exp_f32 v125, v125
  v_exp_f32 v126, v126
  v_exp_f32 v127, v127
  v_mfma_f32_32x32x8_bf16 v[96:111], v[42:43], v[32:33], 0
  v_exp_f32 v128, v128
  v_exp_f32 v129, v129
  v_exp_f32 v130, v130
  v_exp_f32 v131, v131
  v_mfma_f32_32x32x16_bf16 v[96:111], a[68:71], v[16:19], v[96:111]
  v_exp_f32 v132, v132
  v_exp_f32 v133, v133
  v_exp_f32 v134, v134
  v_exp_f32 v135, v135
  v_smfmac_f32_32x32x32_bf16 v[176:191], a[80:83], v[112:119], v228
  buffer_load_dwordx4 a[104:107], v229, s[16:19], s46 offen sc1
  v_exp_f32 v136, v136
  v_exp_f32 v137, v137
  v_exp_f32 v138, v138
  v_exp_f32 v139, v139
  v_smfmac_f32_32x32x32_bf16 v[176:191], a[84:87], v[120:127], v228
  buffer_load_dwordx4 v1, s[20:23], s56 offen sc1 lds
  v_exp_f32 v140, v140
  v_exp_f32 v141, v141
  v_exp_f32 v142, v142
  v_exp_f32 v143, v143
  v_mfma_f32_32x32x8_bf16 v[112:127], v[42:43], v[34:35], 0
  v_exp_f32 v144, v144
  v_exp_f32 v145, v145
  v_exp_f32 v146, v146
  v_exp_f32 v147, v147
  v_mfma_f32_32x32x16_bf16 v[112:127], a[68:71], v[20:23], v[112:127]
  v_exp_f32 v148, v148
  v_exp_f32 v149, v149
  v_exp_f32 v150, v150
  v_exp_f32 v151, v151
  v_smfmac_f32_32x32x32_bf16 v[192:207], a[80:83], v[128:135], v228
  buffer_load_dwordx4 a[108:111], v230, s[16:19], s46 offen sc1
  v_exp_f32 v152, v152
  v_exp_f32 v153, v153
  v_exp_f32 v154, v154
  v_exp_f32 v155, v155
  v_smfmac_f32_32x32x32_bf16 v[192:207], a[84:87], v[136:143], v228
  buffer_load_dwordx4 v1, s[20:23], s56 offen offset:1024 sc1 lds
  v_exp_f32 v156, v156
  v_exp_f32 v157, v157
  v_exp_f32 v158, v158
  v_exp_f32 v159, v159
  v_mfma_f32_32x32x8_bf16 v[128:143], v[42:43], v[36:37], 0
  v_exp_f32 v96, v96
  v_exp_f32 v97, v97
  v_exp_f32 v98, v98
  v_exp_f32 v99, v99
  v_mfma_f32_32x32x16_bf16 v[128:143], a[68:71], v[24:27], v[128:143]
  s_add_u32 s46, s46, 4864
  v_exp_f32 v100, v100
  v_exp_f32 v101, v101
  v_exp_f32 v102, v102
  v_exp_f32 v103, v103
  v_smfmac_f32_32x32x32_bf16 v[208:223], a[80:83], v[144:151], v228
  buffer_load_dwordx4 a[64:67], v79, s[16:19], s46 offen sc1
  v_exp_f32 v104, v104
  v_exp_f32 v105, v105
  v_exp_f32 v106, v106
  v_exp_f32 v107, v107
  v_smfmac_f32_32x32x32_bf16 v[208:223], a[84:87], v[152:159], v228
  buffer_store_dwordx4 v[48:51], v1, s[12:15], s36 offen sc1
  v_exp_f32 v108, v108
  v_exp_f32 v109, v109
  v_exp_f32 v110, v110
  v_exp_f32 v111, v111
  v_mfma_f32_32x32x8_bf16 v[144:159], v[42:43], v[38:39], 0
  v_exp_f32 v112, v112
  v_exp_f32 v113, v113
  v_exp_f32 v114, v114
  v_exp_f32 v115, v115
  v_mfma_f32_32x32x16_bf16 v[144:159], a[68:71], v[28:31], v[144:159]
  s_waitcnt vmcnt(11)
  v_exp_f32 v116, v116
  v_exp_f32 v117, v117
  v_exp_f32 v118, v118
  v_exp_f32 v119, v119
  v_smfmac_f32_32x32x32_bf16 v[160:175], a[88:91], v[96:103], v228
  buffer_load_dword v40, v231, s[16:19], s46 offen offset:2176 sc1
  v_exp_f32 v120, v120
  v_exp_f32 v121, v121
  v_exp_f32 v122, v122
  v_exp_f32 v123, v123
  v_smfmac_f32_32x32x32_bf16 v[160:175], a[92:95], v[104:111], v228
  buffer_store_dwordx4 v[52:55], v1, s[12:15], s37 offen sc1
  v_exp_f32 v124, v124
  v_exp_f32 v125, v125
  v_exp_f32 v126, v126
  v_exp_f32 v127, v127
  v_mfma_f32_32x32x8_bf16 v[96:111], v[44:45], v[32:33], 0
  v_exp_f32 v128, v128
  v_exp_f32 v129, v129
  v_exp_f32 v130, v130
  v_exp_f32 v131, v131
  v_mfma_f32_32x32x16_bf16 v[96:111], a[72:75], v[16:19], v[96:111]
  v_exp_f32 v132, v132
  v_exp_f32 v133, v133
  v_exp_f32 v134, v134
  v_exp_f32 v135, v135
  v_smfmac_f32_32x32x32_bf16 v[176:191], a[88:91], v[112:119], v228
  buffer_load_dwordx4 a[80:83], v229, s[16:19], s46 offen sc1
  v_exp_f32 v136, v136
  v_exp_f32 v137, v137
  v_exp_f32 v138, v138
  v_exp_f32 v139, v139
  v_smfmac_f32_32x32x32_bf16 v[176:191], a[92:95], v[120:127], v228
  buffer_load_dwordx4 v1, s[20:23], s56 offen offset:2048 sc1 lds
  v_exp_f32 v140, v140
  v_exp_f32 v141, v141
  v_exp_f32 v142, v142
  v_exp_f32 v143, v143
  v_mfma_f32_32x32x8_bf16 v[112:127], v[44:45], v[34:35], 0
  v_exp_f32 v144, v144
  v_exp_f32 v145, v145
  v_exp_f32 v146, v146
  v_exp_f32 v147, v147
  v_mfma_f32_32x32x16_bf16 v[112:127], a[72:75], v[20:23], v[112:127]
  v_exp_f32 v148, v148
  v_exp_f32 v149, v149
  v_exp_f32 v150, v150
  v_exp_f32 v151, v151
  v_smfmac_f32_32x32x32_bf16 v[192:207], a[88:91], v[128:135], v228
  buffer_load_dwordx4 a[84:87], v230, s[16:19], s46 offen sc1
  v_exp_f32 v152, v152
  v_exp_f32 v153, v153
  v_exp_f32 v154, v154
  v_exp_f32 v155, v155
  v_smfmac_f32_32x32x32_bf16 v[192:207], a[92:95], v[136:143], v228
  buffer_load_dwordx4 v1, s[20:23], s56 offen offset:3072 sc1 lds
  v_exp_f32 v156, v156
  v_exp_f32 v157, v157
  v_exp_f32 v158, v158
  v_exp_f32 v159, v159
  v_mfma_f32_32x32x8_bf16 v[128:143], v[44:45], v[36:37], 0
  v_exp_f32 v96, v96
  v_exp_f32 v97, v97
  v_exp_f32 v98, v98
  v_exp_f32 v99, v99
  v_mfma_f32_32x32x16_bf16 v[128:143], a[72:75], v[24:27], v[128:143]
  s_add_u32 s46, s46, 4864
  v_exp_f32 v100, v100
  v_exp_f32 v101, v101
  v_exp_f32 v102, v102
  v_exp_f32 v103, v103
  v_smfmac_f32_32x32x32_bf16 v[208:223], a[88:91], v[144:151], v228
  buffer_load_dwordx4 a[68:71], v79, s[16:19], s46 offen sc1
  v_exp_f32 v104, v104
  v_exp_f32 v105, v105
  v_exp_f32 v106, v106
  v_exp_f32 v107, v107
  v_smfmac_f32_32x32x32_bf16 v[208:223], a[92:95], v[152:159], v228
  buffer_store_dwordx4 v[56:59], v1, s[12:15], s38 offen sc1
  v_exp_f32 v108, v108
  v_exp_f32 v109, v109
  v_exp_f32 v110, v110
  v_exp_f32 v111, v111
  v_mfma_f32_32x32x8_bf16 v[144:159], v[44:45], v[38:39], 0
  v_exp_f32 v112, v112
  v_exp_f32 v113, v113
  v_exp_f32 v114, v114
  v_exp_f32 v115, v115
  v_mfma_f32_32x32x16_bf16 v[144:159], a[72:75], v[28:31], v[144:159]
  s_waitcnt vmcnt(14)
  v_exp_f32 v116, v116
  v_exp_f32 v117, v117
  v_exp_f32 v118, v118
  v_exp_f32 v119, v119
  v_smfmac_f32_32x32x32_bf16 v[160:175], a[96:99], v[96:103], v228
  buffer_load_dword v42, v231, s[16:19], s46 offen offset:2176 sc1
  v_exp_f32 v120, v120
  v_exp_f32 v121, v121
  v_exp_f32 v122, v122
  v_exp_f32 v123, v123
  v_smfmac_f32_32x32x32_bf16 v[160:175], a[100:103], v[104:111], v228
  buffer_store_dwordx4 v[60:63], v1, s[12:15], s39 offen sc1
  v_exp_f32 v124, v124
  v_exp_f32 v125, v125
  v_exp_f32 v126, v126
  v_exp_f32 v127, v127
  v_mfma_f32_32x32x8_bf16 v[96:111], v[46:47], v[32:33], 0
  v_exp_f32 v128, v128
  v_exp_f32 v129, v129
  v_exp_f32 v130, v130
  v_exp_f32 v131, v131
  v_mfma_f32_32x32x16_bf16 v[96:111], a[76:79], v[16:19], v[96:111]
  s_add_u32 s56, s56, 4096
  s_add_u32 m0, m0, 4096
  v_exp_f32 v132, v132
  v_exp_f32 v133, v133
  v_exp_f32 v134, v134
  v_exp_f32 v135, v135
  v_smfmac_f32_32x32x32_bf16 v[176:191], a[96:99], v[112:119], v228
  buffer_load_dwordx4 a[88:91], v229, s[16:19], s46 offen sc1
  v_exp_f32 v136, v136
  v_exp_f32 v137, v137
  v_exp_f32 v138, v138
  v_exp_f32 v139, v139
  v_smfmac_f32_32x32x32_bf16 v[176:191], a[100:103], v[120:127], v228
  buffer_load_dwordx4 v1, s[20:23], s56 offen sc1 lds
  v_exp_f32 v140, v140
  v_exp_f32 v141, v141
  v_exp_f32 v142, v142
  v_exp_f32 v143, v143
  v_mfma_f32_32x32x8_bf16 v[112:127], v[46:47], v[34:35], 0
  v_exp_f32 v144, v144
  v_exp_f32 v145, v145
  v_exp_f32 v146, v146
  v_exp_f32 v147, v147
  v_mfma_f32_32x32x16_bf16 v[112:127], a[76:79], v[20:23], v[112:127]
  v_exp_f32 v148, v148
  v_exp_f32 v149, v149
  v_exp_f32 v150, v150
  v_exp_f32 v151, v151
  v_smfmac_f32_32x32x32_bf16 v[192:207], a[96:99], v[128:135], v228
  buffer_load_dwordx4 a[92:95], v230, s[16:19], s46 offen sc1
  v_exp_f32 v152, v152
  v_exp_f32 v153, v153
  v_exp_f32 v154, v154
  v_exp_f32 v155, v155
  v_smfmac_f32_32x32x32_bf16 v[192:207], a[100:103], v[136:143], v228
  buffer_load_dwordx4 v1, s[20:23], s56 offen offset:1024 sc1 lds
  v_exp_f32 v156, v156
  v_exp_f32 v157, v157
  v_exp_f32 v158, v158
  v_exp_f32 v159, v159
  v_mfma_f32_32x32x8_bf16 v[128:143], v[46:47], v[36:37], 0
  v_exp_f32 v96, v96
  v_exp_f32 v97, v97
  v_exp_f32 v98, v98
  v_exp_f32 v99, v99
  v_mfma_f32_32x32x16_bf16 v[128:143], a[76:79], v[24:27], v[128:143]
  s_add_u32 s46, s46, 4864
  v_exp_f32 v100, v100
  v_exp_f32 v101, v101
  v_exp_f32 v102, v102
  v_exp_f32 v103, v103
  v_smfmac_f32_32x32x32_bf16 v[208:223], a[96:99], v[144:151], v228
  buffer_load_dwordx4 a[72:75], v79, s[16:19], s46 offen sc1
  v_exp_f32 v104, v104
  v_exp_f32 v105, v105
  v_exp_f32 v106, v106
  v_exp_f32 v107, v107
  v_smfmac_f32_32x32x32_bf16 v[208:223], a[100:103], v[152:159], v228
  buffer_store_dwordx4 v[64:67], v1, s[12:15], s44 offen sc1
  v_exp_f32 v108, v108
  v_exp_f32 v109, v109
  v_exp_f32 v110, v110
  v_exp_f32 v111, v111
  v_mfma_f32_32x32x8_bf16 v[144:159], v[46:47], v[38:39], 0
  v_exp_f32 v112, v112
  v_exp_f32 v113, v113
  v_exp_f32 v114, v114
  v_exp_f32 v115, v115
  v_mfma_f32_32x32x16_bf16 v[144:159], a[76:79], v[28:31], v[144:159]
  s_waitcnt vmcnt(15)
  v_exp_f32 v116, v116
  v_exp_f32 v117, v117
  v_exp_f32 v118, v118
  v_exp_f32 v119, v119
  v_smfmac_f32_32x32x32_bf16 v[160:175], a[104:107], v[96:103], v228
  buffer_load_dword v44, v231, s[16:19], s46 offen offset:2176 sc1
  v_exp_f32 v120, v120
  v_exp_f32 v121, v121
  v_exp_f32 v122, v122
  v_exp_f32 v123, v123
  v_smfmac_f32_32x32x32_bf16 v[160:175], a[108:111], v[104:111], v228
  buffer_store_dwordx4 v[68:71], v1, s[12:15], s45 offen sc1
  v_exp_f32 v124, v124
  v_exp_f32 v125, v125
  v_exp_f32 v126, v126
  v_exp_f32 v127, v127
  v_mfma_f32_32x32x8_bf16 v[96:111], v[40:41], v[32:33], 0
  v_exp_f32 v128, v128
  v_exp_f32 v129, v129
  v_exp_f32 v130, v130
  v_exp_f32 v131, v131
  v_mfma_f32_32x32x16_bf16 v[96:111], a[64:67], v[16:19], v[96:111]
  v_exp_f32 v132, v132
  v_exp_f32 v133, v133
  v_exp_f32 v134, v134
  v_exp_f32 v135, v135
  v_smfmac_f32_32x32x32_bf16 v[176:191], a[104:107], v[112:119], v228
  buffer_load_dwordx4 a[96:99], v229, s[16:19], s46 offen sc1
  v_exp_f32 v136, v136
  v_exp_f32 v137, v137
  v_exp_f32 v138, v138
  v_exp_f32 v139, v139
  v_smfmac_f32_32x32x32_bf16 v[176:191], a[108:111], v[120:127], v228
  buffer_load_dwordx4 v1, s[20:23], s56 offen offset:2048 sc1 lds
  v_exp_f32 v140, v140
  v_exp_f32 v141, v141
  v_exp_f32 v142, v142
  v_exp_f32 v143, v143
  v_mfma_f32_32x32x8_bf16 v[112:127], v[40:41], v[34:35], 0
  v_exp_f32 v144, v144
  v_exp_f32 v145, v145
  v_exp_f32 v146, v146
  v_exp_f32 v147, v147
  v_mfma_f32_32x32x16_bf16 v[112:127], a[64:67], v[20:23], v[112:127]
  v_exp_f32 v148, v148
  v_exp_f32 v149, v149
  v_exp_f32 v150, v150
  v_exp_f32 v151, v151
  v_smfmac_f32_32x32x32_bf16 v[192:207], a[104:107], v[128:135], v228
  buffer_load_dwordx4 a[100:103], v230, s[16:19], s46 offen sc1
  v_exp_f32 v152, v152
  v_exp_f32 v153, v153
  v_exp_f32 v154, v154
  v_exp_f32 v155, v155
  v_smfmac_f32_32x32x32_bf16 v[192:207], a[108:111], v[136:143], v228
  buffer_load_dwordx4 v1, s[20:23], s56 offen offset:3072 sc1 lds
  v_exp_f32 v156, v156
  v_exp_f32 v157, v157
  v_exp_f32 v158, v158
  v_exp_f32 v159, v159
  s_sub_u32 s56, s56, 36864
  s_cmp_eq_u32 s32, 4
  s_cbranch_scc1 a_done
  s_cmp_eq_u32 s32, 2
  s_cbranch_scc1 a_pc1
  s_cmp_eq_u32 s32, 3
  s_cbranch_scc1 a_pc2
  s_barrier
  ds_read_b64_tr_b16 a[112:113], v76 offset:0
  ds_read_b64_tr_b16 a[114:115], v77 offset:0
  ds_read_b64_tr_b16 a[116:117], v76 offset:4096
  ds_read_b64_tr_b16 a[118:119], v77 offset:4096
  ds_read_b64_tr_b16 a[120:121], v76 offset:8192
  ds_read_b64_tr_b16 a[122:123], v77 offset:8192
  ds_read_b64_tr_b16 a[124:125], v76 offset:12288
  ds_read_b64_tr_b16 a[126:127], v77 offset:12288
  ds_read_b64_tr_b16 a[128:129], v76 offset:16384
  ds_read_b64_tr_b16 a[130:131], v77 offset:16384
  ds_read_b64_tr_b16 a[132:133], v76 offset:20480
  ds_read_b64_tr_b16 a[134:135], v77 offset:20480
  ds_read_b64_tr_b16 a[136:137], v76 offset:24576
  ds_read_b64_tr_b16 a[138:139], v77 offset:24576
  s_waitcnt lgkmcnt(12)
  v_mfma_f32_16x16x32_bf16 v[84:87], v[80:83], a[112:115], 0
  ds_read_b64_tr_b16 a[140:141], v76 offset:28672
  ds_read_b64_tr_b16 a[142:143], v77 offset:28672
  s_waitcnt lgkmcnt(12)
  v_mfma_f32_16x16x32_bf16 v[84:87], v[80:83], a[116:119], v[84:87]
  ds_read_b64_tr_b16 a[144:145], v76 offset:32768
  ds_read_b64_tr_b16 a[146:147], v77 offset:32768
  v_add_u32 v76, 36864, v76
  v_add_u32 v77, 36864, v77
  s_waitcnt lgkmcnt(12)
  v_mfma_f32_16x16x32_bf16 v[84:87], v[80:83], a[120:123], v[84:87]
  ds_read_b64_tr_b16 a[148:149], v76 offset:0
  ds_read_b64_tr_b16 a[150:151], v77 offset:0
  s_waitcnt lgkmcnt(12)
  v_mfma_f32_16x16x32_bf16 v[84:87], v[80:83], a[124:127], v[84:87]
  ds_read_b64_tr_b16 a[152:153], v76 offset:4096
  ds_read_b64_tr_b16 a[154:155], v77 offset:4096
  s_waitcnt lgkmcnt(12)
  v_mfma_f32_16x16x32_bf16 v[84:87], v[80:83], a[128:131], v[84:87]
  ds_read_b64_tr_b16 a[156:157], v76 offset:8192
  ds_read_b64_tr_b16 a[158:159], v77 offset:8192
  s_waitcnt lgkmcnt(12)
  v_mfma_f32_16x16x32_bf16 v[84:87], v[80:83], a[132:135], v[84:87]
  ds_read_b64_tr_b16 a[160:161], v76 offset:12288
  ds_read_b64_tr_b16 a[162:163], v77 offset:12288
  s_waitcnt lgkmcnt(12)
  v_mfma_f32_16x16x32_bf16 v[84:87], v[80:83], a[136:139], v[84:87]
  ds_read_b64_tr_b16 a[164:165], v76 offset:16384
  ds_read_b64_tr_b16 a[166:167], v77 offset:16384
  s_waitcnt lgkmcnt(12)
  v_mfma_f32_16x16x32_bf16 v[84:87], v[80:83], a[140:143], v[84:87]
  ds_read_b64_tr_b16 a[168:169], v76 offset:20480
  ds_read_b64_tr_b16 a[170:171], v77 offset:20480
  s_waitcnt lgkmcnt(12)
  v_mfma_f32_16x16x32_bf16 v[84:87], v[80:83], a[144:147], v[84:87]
  ds_read_b64_tr_b16 a[172:173], v76 offset:24576
  ds_read_b64_tr_b16 a[174:175], v77 offset:24576
  s_waitcnt lgkmcnt(12)
  v_mfma_f32_16x16x32_bf16 v[84:87], v[80:83], a[148:151], v[84:87]
  ds_read_b64_tr_b16 a[176:177], v76 offset:28672
  ds_read_b64_tr_b16 a[178:179], v77 offset:28672
  s_waitcnt lgkmcnt(12)
  v_mfma_f32_16x16x32_bf16 v[84:87], v[80:83], a[152:155], v[84:87]
  ds_read_b64_tr_b16 a[180:181], v76 offset:32768
  ds_read_b64_tr_b16 a[182:183], v77 offset:32768
  s_waitcnt lgkmcnt(12)
  v_mfma_f32_16x16x32_bf16 v[84:87], v[80:83], a[156:159], v[84:87]
  s_waitcnt lgkmcnt(10)
  v_mfma_f32_16x16x32_bf16 v[84:87], v[80:83], a[160:163], v[84:87]
  s_waitcnt lgkmcnt(8)
  v_mfma_f32_16x16x32_bf16 v[84:87], v[80:83], a[164:167], v[84:87]
  s_waitcnt lgkmcnt(6)
  v_mfma_f32_16x16x32_bf16 v[84:87], v[80:83], a[168:171], v[84:87]
  s_waitcnt lgkmcnt(4)
  v_mfma_f32_16x16x32_bf16 v[84:87], v[80:83], a[172:175], v[84:87]
  s_waitcnt lgkmcnt(2)
  v_mfma_f32_16x16x32_bf16 v[84:87], v[80:83], a[176:179], v[84:87]
  s_waitcnt lgkmcnt(0)
  v_mfma_f32_16x16x32_bf16 v[84:87], v[80:83], a[180:183], v[84:87]
  s_barrier
a_pc0:
  v_accvgpr_read_b32 v48, a112
  v_accvgpr_read_b32 v49, a113
  v_accvgpr_read_b32 v50, a114
  v_accvgpr_read_b32 v51, a115
  v_accvgpr_read_b32 v52, a116
  v_accvgpr_read_b32 v53, a117
  v_accvgpr_read_b32 v54, a118
  v_accvgpr_read_b32 v55, a119
  v_accvgpr_read_b32 v56, a120
  v_accvgpr_read_b32 v57, a121
  v_accvgpr_read_b32 v58, a122
  v_accvgpr_read_b32 v59, a123
  v_accvgpr_read_b32 v60, a124
  v_accvgpr_read_b32 v61, a125
  v_accvgpr_read_b32 v62, a126
  v_accvgpr_read_b32 v63, a127
  v_accvgpr_read_b32 v64, a128
  v_accvgpr_read_b32 v65, a129
  v_accvgpr_read_b32 v66, a130
  v_accvgpr_read_b32 v67, a131
  v_accvgpr_read_b32 v68, a132
  v_accvgpr_read_b32 v69, a133
  v_accvgpr_read_b32 v70, a134
  v_accvgpr_read_b32 v71, a135
  v_and_b32 v88, 0xffff0000, v84
  v_sub_f32 v84, v84, v88
  v_perm_b32 v84, v84, v88, s49
  s_mov_b64 exec, 0xffff
  buffer_store_dword v84, v78, s[12:15], s8 offen sc1
  s_mov_b64 exec, -1
  s_branch a_piece
a_pc1:
  v_accvgpr_read_b32 v48, a136
  v_accvgpr_read_b32 v49, a137
  v_accvgpr_read_b32 v50, a138
  v_accvgpr_read_b32 v51, a139
  v_accvgpr_read_b32 v52, a140
  v_accvgpr_read_b32 v53, a141
  v_accvgpr_read_b32 v54, a142
  v_accvgpr_read_b32 v55, a143
  v_accvgpr_read_b32 v56, a144
  v_accvgpr_read_b32 v57, a145
  v_accvgpr_read_b32 v58, a146
  v_accvgpr_read_b32 v59, a147
  v_accvgpr_read_b32 v60, a148
  v_accvgpr_read_b32 v61, a149
  v_accvgpr_read_b32 v62, a150
  v_accvgpr_read_b32 v63, a151
  v_accvgpr_read_b32 v64, a152
  v_accvgpr_read_b32 v65, a153
  v_accvgpr_read_b32 v66, a154
  v_accvgpr_read_b32 v67, a155
  v_accvgpr_read_b32 v68, a156
  v_accvgpr_read_b32 v69, a157
  v_accvgpr_read_b32 v70, a158
  v_accvgpr_read_b32 v71, a159
  s_branch a_piece
a_pc2:
  v_accvgpr_read_b32 v48, a160
  v_accvgpr_read_b32 v49, a161
  v_accvgpr_read_b32 v50, a162
  v_accvgpr_read_b32 v51, a163
  v_accvgpr_read_b32 v52, a164
  v_accvgpr_read_b32 v53, a165
  v_accvgpr_read_b32 v54, a166
  v_accvgpr_read_b32 v55, a167
  v_accvgpr_read_b32 v56, a168
  v_accvgpr_read_b32 v57, a169
  v_accvgpr_read_b32 v58, a170
  v_accvgpr_read_b32 v59, a171
  v_accvgpr_read_b32 v60, a172
  v_accvgpr_read_b32 v61, a173
  v_accvgpr_read_b32 v62, a174
  v_accvgpr_read_b32 v63, a175
  v_accvgpr_read_b32 v64, a176
  v_accvgpr_read_b32 v65, a177
  v_accvgpr_read_b32 v66, a178
  v_accvgpr_read_b32 v67, a179
  v_accvgpr_read_b32 v68, a180
  v_accvgpr_read_b32 v69, a181
  v_accvgpr_read_b32 v70, a182
  v_accvgpr_read_b32 v71, a183
a_piece:
  s_cmp_eq_u32 s32, 2
  s_cselect_b32 s47, s9, 0
  s_mov_b32 s36, s58
  s_add_u32 s37, s36, s59
  s_add_u32 s38, s37, s59
  s_add_u32 s39, s38, s59
  s_add_u32 s39, s39, s47
  s_add_u32 s44, s39, s59
  s_add_u32 s45, s44, s59
  s_add_u32 s58, s45, s59
  s_branch a_wide
a_redo:
  s_mov_b32 s3, 1
  s_mov_b32 s47, 32
  s_mov_b32 s56, 1073741824
  s_mov_b32 s57, 0
  s_mov_b32 s40, 0
  s_mov_b32 m0, 196608
  s_waitcnt vmcnt(0)
  v_mov_b32 v160, 0
  v_mov_b32 v161, 0
  v_mov_b32 v162, 0
  v_mov_b32 v163, 0
  v_mov_b32 v164, 0
  v_mov_b32 v165, 0
  v_mov_b32 v166, 0
  v_mov_b32 v167, 0
  v_mov_b32 v168, 0
  v_mov_b32 v169, 0
  v_mov_b32 v170, 0
  v_mov_b32 v171, 0
  v_mov_b32 v172, 0
  v_mov_b32 v173, 0
  v_mov_b32 v174, 0
  v_mov_b32 v175, 0
  v_mov_b32 v176, 0
  v_mov_b32 v177, 0
  v_mov_b32 v178, 0
  v_mov_b32 v179, 0
  v_mov_b32 v180, 0
  v_mov_b32 v181, 0
  v_mov_b32 v182, 0
  v_mov_b32 v183, 0
  v_mov_b32 v184, 0
  v_mov_b32 v185, 0
  v_mov_b32 v186, 0
  v_mov_b32 v187, 0
  v_mov_b32 v188, 0
  v_mov_b32 v189, 0
  v_mov_b32 v190, 0
  v_mov_b32 v191, 0
  v_mov_b32 v192, 0
  v_mov_b32 v193, 0
  v_mov_b32 v194, 0
  v_mov_b32 v195, 0
  v_mov_b32 v196, 0
  v_mov_b32 v197, 0
  v_mov_b32 v198, 0
  v_mov_b32 v199, 0
  v_mov_b32 v200, 0
  v_mov_b32 v201, 0
  v_mov_b32 v202, 0
  v_mov_b32 v203, 0
  v_mov_b32 v204, 0
  v_mov_b32 v205, 0
  v_mov_b32 v206, 0
  v_mov_b32 v207, 0
  v_mov_b32 v208, 0
  v_mov_b32 v209, 0
  v_mov_b32 v210, 0
  v_mov_b32 v211, 0
  v_mov_b32 v212, 0
  v_mov_b32 v213, 0
  v_mov_b32 v214, 0
  v_mov_b32 v215, 0
  v_mov_b32 v216, 0
  v_mov_b32 v217, 0
  v_mov_b32 v218, 0
  v_mov_b32 v219, 0
  v_mov_b32 v220, 0
  v_mov_b32 v221, 0
  v_mov_b32 v222, 0
  v_mov_b32 v223, 0
  s_branch a_max
o_first:
  v_lshlrev_b32 v232, 16, v244
  v_and_b32 v233, 0xffff0000, v244
  v_lshlrev_b32 v234, 16, v245
  v_and_b32 v235, 0xffff0000, v245
  v_lshlrev_b32 v236, 16, v246
  v_and_b32 v237, 0xffff0000, v246
  v_lshlrev_b32 v238, 16, v247
  v_and_b32 v239, 0xffff0000, v247
  v_lshlrev_b32 v240, 16, v248
  v_and_b32 v241, 0xffff0000, v248
  v_lshlrev_b32 v242, 16, v249
  v_and_b32 v243, 0xffff0000, v249
  v_lshlrev_b32 v244, 16, v250
  v_and_b32 v245, 0xffff0000, v250
  v_lshlrev_b32 v246, 16, v251
  v_and_b32 v247, 0xffff0000, v251
  v_lshlrev_b32 v248, 16, v252
  v_and_b32 v249, 0xffff0000, v252
  v_lshlrev_b32 v250, 16, v253
  v_and_b32 v251, 0xffff0000, v253
  v_lshlrev_b32 v252, 16, v254
  v_and_b32 v253, 0xffff0000, v254
  v_lshlrev_b32 v254, 16, v255
  v_and_b32 v255, 0xffff0000, v255
  s_branch o_rest
o_ring:
  s_and_b32 s43, s24, 7
  s_mul_i32 s43, s43, 27
  s_lshr_b32 s43, s43, 3
  s_lshl_b32 s43, s43, 12
  s_mov_b32 m0, s43
  v_cmp_gt_u32 vcc, s41, v4
  s_mov_b32 s42, 27
  s_cbranch_vccnz o_late
  buffer_load_dwordx4 v1, s[16:19], s43 offen sc1 lds
  buffer_load_dwordx4 v1, s[16:19], s43 offen offset:1024 sc1 lds
  buffer_load_dwordx4 v1, s[16:19], s43 offen offset:2048 sc1 lds
  buffer_load_dwordx4 v1, s[16:19], s43 offen offset:3072 sc1 lds
  s_add_u32 s43, s43, 4096
  s_cmp_eq_u32 s43, 110592
  s_cselect_b32 s43, 0, s43
  s_mov_b32 m0, s43
  s_sub_u32 s42, s42, 1
  buffer_load_dwordx4 v1, s[16:19], s43 offen sc1 lds
  buffer_load_dwordx4 v1, s[16:19], s43 offen offset:1024 sc1 lds
  buffer_load_dwordx4 v1, s[16:19], s43 offen offset:2048 sc1 lds
  buffer_load_dwordx4 v1, s[16:19], s43 offen offset:3072 sc1 lds
  s_add_u32 s43, s43, 4096
  s_cmp_eq_u32 s43, 110592
  s_cselect_b32 s43, 0, s43
  s_mov_b32 m0, s43
  s_sub_u32 s42, s42, 1
  buffer_load_dwordx4 v1, s[16:19], s43 offen sc1 lds
  buffer_load_dwordx4 v1, s[16:19], s43 offen offset:1024 sc1 lds
  buffer_load_dwordx4 v1, s[16:19], s43 offen offset:2048 sc1 lds
  buffer_load_dwordx4 v1, s[16:19], s43 offen offset:3072 sc1 lds
  s_add_u32 s43, s43, 4096
  s_cmp_eq_u32 s43, 110592
  s_cselect_b32 s43, 0, s43
  s_mov_b32 m0, s43
  s_sub_u32 s42, s42, 1
  buffer_load_dwordx4 v1, s[16:19], s43 offen sc1 lds
  buffer_load_dwordx4 v1, s[16:19], s43 offen offset:1024 sc1 lds
  buffer_load_dwordx4 v1, s[16:19], s43 offen offset:2048 sc1 lds
  buffer_load_dwordx4 v1, s[16:19], s43 offen offset:3072 sc1 lds
  s_add_u32 s43, s43, 4096
  s_cmp_eq_u32 s43, 110592
  s_cselect_b32 s43, 0, s43
  s_mov_b32 m0, s43
  s_sub_u32 s42, s42, 1
  s_waitcnt vmcnt(16)
  s_barrier
  s_branch o_fill
o_late:
  s_waitcnt vmcnt(0)
  s_barrier
  s_mov_b32 s61, 0x40000
o_prep:
  buffer_load_dword v4, v11, s[12:15], s40 offen sc1
  s_sub_u32 s61, s61, 1
  s_waitcnt vmcnt(0)
  v_cmp_gt_u32 vcc, s41, v4
  s_cbranch_scc1 o_fill
  s_cbranch_vccnz o_prep
o_fill:
  buffer_load_dwordx4 v1, s[16:19], s43 offen sc1 lds
  buffer_load_dwordx4 v1, s[16:19], s43 offen offset:1024 sc1 lds
  buffer_load_dwordx4 v1, s[16:19], s43 offen offset:2048 sc1 lds
  buffer_load_dwordx4 v1, s[16:19], s43 offen offset:3072 sc1 lds
  s_add_u32 s43, s43, 4096
  s_cmp_eq_u32 s43, 110592
  s_cselect_b32 s43, 0, s43
  s_mov_b32 m0, s43
  s_sub_u32 s42, s42, 1
  s_cmp_lg_u32 s42, 0
  s_waitcnt vmcnt(28)
  s_cbranch_scc1 o_fill
  s_branch o_bar
fs0_spin:
  s_mov_b32 s61, 0x80000
fs0_again:
  ds_read_b32 v224, v230
  s_sub_u32 s61, s61, 1
  s_waitcnt lgkmcnt(0)
  v_cmp_gt_u32 vcc, v228, v224
  s_cbranch_scc1 fs0_back
  s_cbranch_vccnz fs0_again
  s_branch fs0_back
fs1_spin:
  s_mov_b32 s61, 0x80000
fs1_again:
  ds_read_b32 v224, v230
  s_sub_u32 s61, s61, 1
  s_waitcnt lgkmcnt(0)
  v_cmp_gt_u32 vcc, v228, v224
  s_cbranch_scc1 fs1_back
  s_cbranch_vccnz fs1_again
  s_branch fs1_back
fs2_spin:
  s_mov_b32 s61, 0x80000
fs2_again:
  ds_read_b32 v224, v230
  s_sub_u32 s61, s61, 1
  s_waitcnt lgkmcnt(0)
  v_cmp_gt_u32 vcc, v228, v224
  s_cbranch_scc1 fs2_back
  s_cbranch_vccnz fs2_again
  s_branch fs2_back
f12_spin:
  s_mov_b32 s61, 0x80000
f12_again:
  buffer_load_dword v72, v74, s[12:15], s41 offen sc1
  s_sub_u32 s61, s61, 1
  s_waitcnt vmcnt(0)
  v_cmp_gt_u32 vcc, 5, v72
  s_cbranch_scc1 f12_back
  s_cbranch_vccnz f12_again
  s_branch f12_back
fs4_spin:
  s_mov_b32 s61, 0x80000
fs4_again:
  ds_read_b32 v224, v230
  s_sub_u32 s61, s61, 1
  s_waitcnt lgkmcnt(0)
  v_cmp_gt_u32 vcc, v228, v224
  s_cbranch_scc1 fs4_back
  s_cbranch_vccnz fs4_again
  s_branch fs4_back
fs5_spin:
  s_mov_b32 s61, 0x80000
fs5_again:
  ds_read_b32 v224, v230
  s_sub_u32 s61, s61, 1
  s_waitcnt lgkmcnt(0)
  v_cmp_gt_u32 vcc, v228, v224
  s_cbranch_scc1 fs5_back
  s_cbranch_vccnz fs5_again
  s_branch fs5_back
fs6_spin:
  s_mov_b32 s61, 0x80000
fs6_again:
  ds_read_b32 v224, v230
  s_sub_u32 s61, s61, 1
  s_waitcnt lgkmcnt(0)
  v_cmp_gt_u32 vcc, v228, v224
  s_cbranch_scc1 fs6_back
  s_cbranch_vccnz fs6_again
  s_branch fs6_back
fs7_spin:
  s_mov_b32 s61, 0x80000
fs7_again:
  ds_read_b32 v224, v230
  s_sub_u32 s61, s61, 1
  s_waitcnt lgkmcnt(0)
  v_cmp_gt_u32 vcc, v228, v224
  s_cbranch_scc1 fs7_back
  s_cbranch_vccnz fs7_again
  s_branch fs7_back
fs8_spin:
  s_mov_b32 s61, 0x80000
fs8_again:
  ds_read_b32 v224, v230
  s_sub_u32 s61, s61, 1
  s_waitcnt lgkmcnt(0)
  v_cmp_gt_u32 vcc, v228, v224
  s_cbranch_scc1 fs8_back
  s_cbranch_vccnz fs8_again
  s_branch fs8_back
f17_spin:
  s_mov_b32 s61, 0x80000
f17_again:
  buffer_load_dword v72, v74, s[12:15], s41 offen sc1
  s_sub_u32 s61, s61, 1
  s_waitcnt vmcnt(0)
  v_cmp_gt_u32 vcc, 8, v72
  s_cbranch_scc1 f17_back
  s_cbranch_vccnz f17_again
  s_branch f17_back
fs10_spin:
  s_mov_b32 s61, 0x80000
fs10_again:
  ds_read_b32 v224, v230
  s_sub_u32 s61, s61, 1
  s_waitcnt lgkmcnt(0)
  v_cmp_gt_u32 vcc, v228, v224
  s_cbranch_scc1 fs10_back
  s_cbranch_vccnz fs10_again
  s_branch fs10_back
fs11_spin:
  s_mov_b32 s61, 0x80000
fs11_again:
  ds_read_b32 v224, v230
  s_sub_u32 s61, s61, 1
  s_waitcnt lgkmcnt(0)
  v_cmp_gt_u32 vcc, v228, v224
  s_cbranch_scc1 fs11_back
  s_cbranch_vccnz fs11_again
  s_branch fs11_back
fs12_spin:
  s_mov_b32 s61, 0x80000
fs12_again:
  ds_read_b32 v224, v230
  s_sub_u32 s61, s61, 1
  s_waitcnt lgkmcnt(0)
  v_cmp_gt_u32 vcc, v228, v224
  s_cbranch_scc1 fs12_back
  s_cbranch_vccnz fs12_again
  s_branch fs12_back
fs13_spin:
  s_mov_b32 s61, 0x80000
fs13_again:
  ds_read_b32 v224, v230
  s_sub_u32 s61, s61, 1
  s_waitcnt lgkmcnt(0)
  v_cmp_gt_u32 vcc, v228, v224
  s_cbranch_scc1 fs13_back
  s_cbranch_vccnz fs13_again
  s_branch fs13_back
f21_spin:
  s_mov_b32 s61, 0x80000
f21_again:
  buffer_load_dword v72, v74, s[12:15], s41 offen sc1
  s_sub_u32 s61, s61, 1
  s_waitcnt vmcnt(0)
  v_cmp_gt_u32 vcc, 10, v72
  s_cbranch_scc1 f21_back
  s_cbranch_vccnz f21_again
  s_branch f21_back
fs15_spin:
  s_mov_b32 s61, 0x80000
fs15_again:
  ds_read_b32 v224, v230
  s_sub_u32 s61, s61, 1
  s_waitcnt lgkmcnt(0)
  v_cmp_gt_u32 vcc, v228, v224
  s_cbranch_scc1 fs15_back
  s_cbranch_vccnz fs15_again
  s_branch fs15_back
fs16_spin:
  s_mov_b32 s61, 0x80000
fs16_again:
  ds_read_b32 v224, v230
  s_sub_u32 s61, s61, 1
  s_waitcnt lgkmcnt(0)
  v_cmp_gt_u32 vcc, v228, v224
  s_cbranch_scc1 fs16_back
  s_cbranch_vccnz fs16_again
  s_branch fs16_back
f23_spin:
  s_mov_b32 s61, 0x80000
f23_again:
  buffer_load_dword v72, v74, s[12:15], s41 offen sc1
  s_sub_u32 s61, s61, 1
  s_waitcnt vmcnt(0)
  v_cmp_gt_u32 vcc, 11, v72
  s_cbranch_scc1 f23_back
  s_cbranch_vccnz f23_again
  s_branch f23_back
fs18_spin:
  s_mov_b32 s61, 0x80000
fs18_again:
  ds_read_b32 v224, v230
  s_sub_u32 s61, s61, 1
  s_waitcnt lgkmcnt(0)
  v_cmp_gt_u32 vcc, v228, v224
  s_cbranch_scc1 fs18_back
  s_cbranch_vccnz fs18_again
  s_branch fs18_back
fs19_spin:
  s_mov_b32 s61, 0x80000
fs19_again:
  ds_read_b32 v224, v230
  s_sub_u32 s61, s61, 1
  s_waitcnt lgkmcnt(0)
  v_cmp_gt_u32 vcc, v228, v224
  s_cbranch_scc1 fs19_back
  s_cbranch_vccnz fs19_again
  s_branch fs19_back
fs20_spin:
  s_mov_b32 s61, 0x80000
fs20_again:
  ds_read_b32 v224, v230
  s_sub_u32 s61, s61, 1
  s_waitcnt lgkmcnt(0)
  v_cmp_gt_u32 vcc, v228, v224
  s_cbranch_scc1 fs20_back
  s_cbranch_vccnz fs20_again
  s_branch fs20_back
r_wq:
  s_cmp_lg_u32 s26, 0
  s_cbranch_scc1 r_exit
  s_and_b32 s44, s24, 7
  s_mul_i32 s44, s44, 16
  s_lshr_b32 s44, s44, 3
  s_lshl_b32 s44, s44, 12
  s_mov_b32 s42, 16
r_fill:
  s_mov_b32 m0, s44
  s_add_u32 s43, s44, 995328
  buffer_load_dwordx4 v1, s[16:19], s43 offen sc1 lds
  buffer_load_dwordx4 v1, s[16:19], s43 offen offset:1024 sc1 lds
  buffer_load_dwordx4 v1, s[16:19], s43 offen offset:2048 sc1 lds
  buffer_load_dwordx4 v1, s[16:19], s43 offen offset:3072 sc1 lds
  s_add_u32 s44, s44, 4096
  s_cmp_eq_u32 s44, 65536
  s_cselect_b32 s44, 0, s44
  s_sub_u32 s42, s42, 1
  s_cmp_lg_u32 s42, 0
  s_waitcnt vmcnt(12)
  s_cbranch_scc1 r_fill
  s_branch r_bar
r_out0:
  buffer_store_dwordx4 v[80:83], v10, s[20:23], s34 offen offset:0
  s_branch r_back0
r_out1:
  buffer_store_dwordx4 v[84:87], v10, s[20:23], s34 offen offset:32
  s_branch r_back1
r_out2:
  buffer_store_dwordx4 v[88:91], v10, s[20:23], s34 offen offset:64
  s_branch r_back2
main_code_end:
.section .rodata,"a"
.p2align 6
.amdhsa_kernel interleave_layers__mha_block__glu_gated_swiglu__prompt_kernel
  .amdhsa_next_free_vgpr 512
  .amdhsa_next_free_sgpr 102
  .amdhsa_accum_offset 256
  .amdhsa_group_segment_fixed_size 0
  .amdhsa_kernarg_size 80
  .amdhsa_user_sgpr_count 2
  .amdhsa_user_sgpr_kernarg_segment_ptr 1
  .amdhsa_system_sgpr_workgroup_id_x 1
.end_amdhsa_kernel
```
